```python
import torch

def _softmax(x, axis=-1):
    return torch.softmax(x, dim=axis)
def _gelu(x):
    return torch.nn.functional.gelu(x, approximate="tanh")
def _silu(x):
    return torch.nn.functional.silu(x)
def _sigmoid(x):
    return torch.sigmoid(x)
def _layernorm(x, axis=-1, eps=1e-5):
    m = x.mean(dim=axis, keepdim=True)
    v = x.var(dim=axis, keepdim=True, unbiased=False)
    return (x - m) / torch.sqrt(v + eps)
def _scatter_add(tgt, idx, src, axis=0):
    return tgt.clone().index_add_(axis, idx, src)
def _segment_sum(src, seg, n):
    out = torch.zeros((n,) + src.shape[1:], dtype=src.dtype)
    return out.index_add_(0, seg, src)
def _pad(x, pw):
    flat = tuple(v for pair in reversed(pw) for v in pair)
    return torch.nn.functional.pad(x, flat)

kernel_name = 'recurrent_scan__sliding_block__dense_activation_relu__prompt'

def setup_inputs():

    _w = (lambda a: (lambda t: t.to(torch.bfloat16) if t.is_floating_point() else t)(torch.as_tensor(a)))
    def _A_setup():
        B, S, D = 1, 2048, 640
        return {
            "x": _w((lambda *s: torch.randn(*s, dtype=torch.bfloat16) * 0.05)(B, S, D)),
            "wqkv": _w((lambda *s: torch.randn(*s, dtype=torch.bfloat16) * 0.05)(D, 3 * D)),
            "wo": _w((lambda *s: torch.randn(*s, dtype=torch.bfloat16) * 0.05)(D, D)),
        }
    _A_in = _A_setup()

    def _B_setup():
        B, S, D, Dff = 1, 2048, 640, 1728
        return {
            "x": _w((lambda *s: torch.randn(*s, dtype=torch.bfloat16) * 0.05)(B, S, D)),
            "w1": _w((lambda *s: torch.randn(*s, dtype=torch.bfloat16) * 0.05)(D, Dff)),
            "w2": _w((lambda *s: torch.randn(*s, dtype=torch.bfloat16) * 0.05)(Dff, D)),
        }
    _B_in = _B_setup()

    return {
        "A_x": _A_in["x"],
        "A_wqkv": _A_in["wqkv"],
        "A_wo": _A_in["wo"],
        "B_x": _B_in["x"],
        "B_w1": _B_in["w1"],
        "B_w2": _B_in["w2"],
    }

def reference(A_x, A_wqkv, A_wo, B_x, B_w1, B_w2):
    def _A_ref(x, wqkv, wo):
        B, S, D = x.shape
        H = 32; Dh = D // H; W = 256
        qkv = (lambda x, *d: x.permute(*d))((x @ wqkv).reshape(B, S, 3, H, Dh), 2, 0, 3, 1, 4)
        q, k, v = qkv[0], qkv[1], qkv[2]
        scores = torch.einsum("bhqd,bhkd->bhqk", q, k) * (Dh ** -0.5)
        idx = torch.arange(S)
        mask = (idx[:, None] - idx[None, :] >= 0) & (idx[:, None] - idx[None, :] < W)
        scores = torch.where(mask[None, None], scores, -1e9)
        p = _softmax(scores, axis=-1)
        o = torch.einsum("bhqk,bhkd->bhqd", p, v)
        return (lambda x, *d: x.permute(*d))(o, 0, 2, 1, 3).reshape(B, S, D) @ wo

    def _B_ref(x, w1, w2):
        h = torch.einsum("bsd,df->bsf", x, w1)
        zero = torch.zeros_like(h)
        h = torch.maximum(h, zero)
        return torch.einsum("bsf,fd->bsd", h, w2)

    x = A_x
    xn = _layernorm(x, axis=-1)
    s = _A_ref(xn, A_wqkv, A_wo)
    g = _silu(_B_ref(xn, B_w1, B_w2))
    return x + s * g
```

```asm
; @launch grid=(256,1,1) block=(512,1,1) lds=163840
.amdgcn_target "amdgcn-amd-amdhsa--gfx950"
.text
.globl recurrent_scan__sliding_block__dense_activation_relu__prompt_kernel
.p2align 8
.type recurrent_scan__sliding_block__dense_activation_relu__prompt_kernel,@function
recurrent_scan__sliding_block__dense_activation_relu__prompt_kernel:
s_cmp_ge_u32 s2, 256
s_cbranch_scc1 L_end
s_load_dwordx2 s[4:5], s[0:1], 0
s_load_dwordx2 s[8:9], s[0:1], 8
s_load_dwordx2 s[16:17], s[0:1], 64
s_load_dwordx2 s[12:13], s[0:1], 32
s_load_dwordx2 s[28:29], s[0:1], 40
s_load_dwordx2 s[32:33], s[0:1], 16
s_load_dwordx2 s[20:21], s[0:1], 48
v_readfirstlane_b32 s36, v0
v_and_b32 v0, 63, v0
s_lshr_b32 s44, s2, 3
s_lshr_b32 s36, s36, 6
s_cmp_lt_u32 s36, 4
s_cselect_b64 vcc, -1, 0
s_cbranch_vccz L_comp0
s_setprio 3
s_and_b32 s45, s44, 7
s_lshl_b32 s39, s2, 1
s_and_b32 s39, s39, 8
s_add_u32 s39, s39, s45
s_lshl_b32 s40, s2, 2
s_and_b32 s40, s40, 12
s_lshr_b32 s46, s2, 6
s_add_u32 s40, s40, s46
s_lshl_b32 s43, s45, 1
s_or_b32 s43, s43, 3
s_sub_u32 s47, s40, 1
s_cmp_gt_u32 s40, s43
s_cselect_b32 s47, s47, s40
s_cmp_eq_u32 s40, s43
s_cselect_b32 s40, 15, s47
s_and_b32 s37, s36, 3
s_lshl_b32 s41, s36, 10
s_lshl_b32 s60, s40, 8
s_mov_b32 s6, 2621440
s_mov_b32 s7, 0x20000
s_mov_b32 s10, 2457600
s_mov_b32 s11, 0x20000
s_cmp_eq_u32 s40, 15
s_cbranch_scc1 L_service
s_lshl_b32 s46, s46, 1
s_add_u32 s45, s45, s46
s_sub_u32 s46, s45, 10
s_cmp_ge_u32 s45, 10
s_cselect_b32 s45, s46, s45
s_lshl_b32 s90, s45, 7
v_lshrrev_b32 v28, 3, v0
v_and_b32 v29, 7, v0
v_lshrrev_b32 v30, 4, v0
s_lshl_b32 s43, s39, 2
s_add_u32 s43, s43, s37
s_lshl_b32 s43, s43, 5
v_add_u32 v31, s43, v28
v_mul_u32_u24 v31, 1280, v31
v_xor_b32 v16, v29, v30
v_lshl_add_u32 v1, v16, 4, v31
v_xor_b32 v16, 4, v16
v_lshl_add_u32 v2, v16, 4, v31
v_add_u32 v2, 10240, v2
s_lshl_b32 s3, s36, 12
s_lshl_b32 s46, s36, 3
v_add_u32 v31, s46, v28
v_and_b32 v16, 1, v30
v_lshlrev_b32 v16, 2, v16
v_xor_b32 v16, v16, v29
v_lshlrev_b32 v16, 4, v16
s_movk_i32 s46, 3840
v_mad_u32_u24 v3, v31, s46, v16
s_waitcnt lgkmcnt(0)
s_add_u32 m0, s3, 73728
s_add_u32 s43, s90, 0
buffer_load_dwordx4 v1, s[4:7], s43 offen  lds
s_add_u32 m0, s3, 74752
s_add_u32 s43, s90, 0
buffer_load_dwordx4 v2, s[4:7], s43 offen  lds
s_add_u32 m0, s3, 75776
s_add_u32 s43, s90, 20480
buffer_load_dwordx4 v1, s[4:7], s43 offen  lds
s_add_u32 m0, s3, 76800
s_add_u32 s43, s90, 20480
buffer_load_dwordx4 v2, s[4:7], s43 offen  lds
s_mul_i32 s43, s90, 1920
s_add_u32 m0, s41, 0
s_add_u32 s43, s43, s60
s_add_u32 s43, s43, 0
buffer_load_dwordx4 v3, s[8:11], s43 offen  lds
s_mul_i32 s43, s90, 1920
s_add_u32 m0, s41, 4096
s_add_u32 s43, s43, s60
s_add_u32 s43, s43, 122880
buffer_load_dwordx4 v3, s[8:11], s43 offen  lds
s_add_u32 s91, s90, 128
s_cmp_eq_u32 s91, 1280
s_cselect_b32 s91, 0, s91
s_add_u32 m0, s3, 90112
s_add_u32 s43, s91, 0
buffer_load_dwordx4 v1, s[4:7], s43 offen  lds
s_add_u32 m0, s3, 91136
s_add_u32 s43, s91, 0
buffer_load_dwordx4 v2, s[4:7], s43 offen  lds
s_add_u32 m0, s3, 92160
s_add_u32 s43, s91, 20480
buffer_load_dwordx4 v1, s[4:7], s43 offen  lds
s_add_u32 m0, s3, 93184
s_add_u32 s43, s91, 20480
buffer_load_dwordx4 v2, s[4:7], s43 offen  lds
s_mul_i32 s43, s91, 1920
s_add_u32 m0, s41, 8192
s_add_u32 s43, s43, s60
s_add_u32 s43, s43, 0
buffer_load_dwordx4 v3, s[8:11], s43 offen  lds
s_mul_i32 s43, s91, 1920
s_add_u32 m0, s41, 12288
s_add_u32 s43, s43, s60
s_add_u32 s43, s43, 122880
buffer_load_dwordx4 v3, s[8:11], s43 offen  lds
s_add_u32 s92, s91, 128
s_cmp_eq_u32 s92, 1280
s_cselect_b32 s92, 0, s92
s_add_u32 s93, s92, 128
s_cmp_eq_u32 s93, 1280
s_cselect_b32 s93, 0, s93
s_add_u32 s94, s93, 128
s_cmp_eq_u32 s94, 1280
s_cselect_b32 s94, 0, s94
s_add_u32 s95, s94, 128
s_cmp_eq_u32 s95, 1280
s_cselect_b32 s95, 0, s95
s_add_u32 s96, s95, 128
s_cmp_eq_u32 s96, 1280
s_cselect_b32 s96, 0, s96
s_add_u32 s97, s96, 128
s_cmp_eq_u32 s97, 1280
s_cselect_b32 s97, 0, s97
s_add_u32 s98, s97, 128
s_cmp_eq_u32 s98, 1280
s_cselect_b32 s98, 0, s98
s_add_u32 s99, s98, 128
s_cmp_eq_u32 s99, 1280
s_cselect_b32 s99, 0, s99
s_and_b32 s43, s2, 3
s_lshl_b32 s53, s43, 2
s_lshr_b32 s43, s39, 2
s_and_b32 s43, s43, 2
s_add_u32 s53, s53, s43
s_and_b32 s43, s39, 1
s_add_u32 s53, s53, s43
s_lshr_b32 s48, s2, 4
s_lshr_b32 s49, s2, 3
s_and_b32 s49, s49, 1
s_and_b32 s43, s2, 7
s_lshl_b32 s43, s43, 1
s_add_u32 s49, s49, s43
s_lshr_b32 s38, s36, 2
s_add_u32 s61, s60, 128
s_cmp_lt_u32 s40, 14
s_cselect_b32 s62, s60, 1073741824
s_cmp_lt_u32 s40, 13
s_cselect_b32 s63, s61, 1073741824
s_mov_b32 s14, 2211840
s_mov_b32 s15, 0x20000
s_mov_b32 s18, 33554432
s_mov_b32 s19, 0x20000
s_mov_b32 s22, 2621440
s_mov_b32 s23, 0x20000
s_mov_b32 s30, 2211840
s_mov_b32 s31, 0x20000
s_mov_b32 s34, 819200
s_mov_b32 s35, 0x20000
s_add_u32 s70, s16, 23265280
s_addc_u32 s71, s17, 0
s_load_dwordx2 s[54:55], s[70:71], 0
s_movk_i32 s46, 3456
v_mad_u32_u24 v4, v31, s46, v16
v_lshlrev_b32 v32, 8, v0
v_mov_b32 v34, 0
v_mov_b32 v35, 0
v_lshlrev_b32 v100, 3, v0
v_add_u32 v101, 141312, v100
v_add_u32 v32, 142336, v32
s_mov_b64 exec, 15
ds_write_b64 v32, v[34:35]
s_mov_b64 exec, -1
v_mov_b32 v32, 143876
ds_write_b32 v32, v34
ds_write_b64 v32, v[34:35] offset:12
ds_write_b64 v32, v[34:35] offset:20
v_bfe_u32 v30, v0, 2, 2
v_lshrrev_b32 v31, 4, v0
v_lshl_add_u32 v31, v31, 2, v30
v_lshlrev_b32 v31, 7, v31
v_lshrrev_b32 v30, 1, v30
s_lshr_b32 s43, s37, 1
v_xor_b32 v30, s43, v30
v_lshl_add_u32 v31, v30, 6, v31
v_and_b32 v30, 3, v0
v_lshl_add_u32 v31, v30, 3, v31
s_and_b32 s43, s37, 1
s_lshl_b32 s43, s43, 5
v_add_u32 v9, s43, v31
v_add_u32 v10, 73728, v9
v_mov_b32 v56, 0x3f803f80
v_mov_b32 v57, 0x3f803f80
v_mov_b32 v58, 0x3f803f80
v_mov_b32 v59, 0x3f803f80
s_waitcnt lgkmcnt(0)
s_mul_i32 s54, s54, 0x9e3779b1
s_add_u32 s54, s54, 0x7f4a7c15
s_mul_i32 s55, s55, 0x85ebca6b
s_add_u32 s55, s55, 0xc2b2ae35
s_setprio 0
s_mul_i32 s43, s39, 15
s_add_u32 s43, s43, s40
s_lshl_b32 s43, s43, 2
s_add_u32 s43, s43, s37
s_mul_i32 s56, s43, 6554
s_lshr_b32 s56, s56, 16
s_mul_i32 s44, s56, 10
s_sub_u32 s57, s43, s44
s_cmp_lt_u32 s56, 54
s_cselect_b32 s28, s28, s32
s_cselect_b32 s29, s29, s33
s_cselect_b32 s30, s30, s34
s_cselect_b32 s44, 16, 20
s_cselect_b32 s45, 32, 40
s_cselect_b32 s46, 0, 54
s_sub_u32 s46, s56, s46
s_mul_i32 s46, s46, s45
s_sub_u32 s47, s56, 70
s_mul_i32 s47, s47, 160
s_add_u32 s47, s47, 16
s_cmp_lt_u32 s56, 70
s_cselect_b32 s46, s46, s47
s_cselect_b32 s44, s44, 80
s_cselect_b32 s45, 4, 40
s_cselect_b32 s47, 8, 20
s_mul_i32 s46, s46, 1280
s_mul_i32 s44, s44, 1280
s_mul_i32 s45, s45, 1280
s_lshl_b32 s43, s57, 7
s_add_u32 s46, s46, s43
s_cmp_lt_u32 s56, 74
s_cselect_b32 s46, s46, 1073741824
v_lshrrev_b32 v112, 5, v0
v_mul_u32_u24 v112, s47, v112
v_bfe_u32 v113, v0, 3, 2
v_add_u32 v112, v112, v113
v_mul_u32_u24 v112, 1280, v112
v_bfe_u32 v113, v0, 4, 1
v_lshlrev_b32 v113, 2, v113
v_and_b32 v114, 7, v0
v_xor_b32 v113, v113, v114
v_lshl_add_u32 v112, v113, 4, v112
s_add_u32 s67, s46, s45
s_add_u32 s68, s46, s44
s_add_u32 s69, s68, s45
s_mov_b32 s66, s46
s_lshl_b32 s3, s37, 12
s_lshl_b32 s43, s57, 2
s_add_u32 s43, s43, 0
s_mul_i32 s44, s43, 52
s_lshr_b32 s44, s44, 8
s_mul_i32 s44, s44, 365
s_add_u32 s43, s43, s44
s_mul_i32 s44, s56, 5
s_add_u32 s43, s43, s44
s_lshl_b32 s43, s43, 10
s_add_u32 s43, s43, 18874368
s_cmp_lt_u32 s56, 74
s_cselect_b32 s32, s43, 1073741824
s_lshl_b32 s43, s57, 2
s_add_u32 s43, s43, 1
s_mul_i32 s44, s43, 52
s_lshr_b32 s44, s44, 8
s_mul_i32 s44, s44, 365
s_add_u32 s43, s43, s44
s_mul_i32 s44, s56, 5
s_add_u32 s43, s43, s44
s_lshl_b32 s43, s43, 10
s_add_u32 s43, s43, 18874368
s_cmp_lt_u32 s56, 74
s_cselect_b32 s33, s43, 1073741824
s_lshl_b32 s43, s57, 2
s_add_u32 s43, s43, 2
s_mul_i32 s44, s43, 52
s_lshr_b32 s44, s44, 8
s_mul_i32 s44, s44, 365
s_add_u32 s43, s43, s44
s_mul_i32 s44, s56, 5
s_add_u32 s43, s43, s44
s_lshl_b32 s43, s43, 10
s_add_u32 s43, s43, 18874368
s_cmp_lt_u32 s56, 74
s_cselect_b32 s34, s43, 1073741824
s_lshl_b32 s43, s57, 2
s_add_u32 s43, s43, 3
s_mul_i32 s44, s43, 52
s_lshr_b32 s44, s44, 8
s_mul_i32 s44, s44, 365
s_add_u32 s43, s43, s44
s_mul_i32 s44, s56, 5
s_add_u32 s43, s43, s44
s_lshl_b32 s43, s43, 10
s_add_u32 s43, s43, 18874368
s_cmp_lt_u32 s56, 74
s_cselect_b32 s35, s43, 1073741824
s_waitcnt vmcnt(6)
s_barrier
ds_read_b64_tr_b16 v[80:81], v9 offset:0
ds_read_b64_tr_b16 v[82:83], v9 offset:2048
ds_read_b64_tr_b16 v[84:85], v9 offset:4096
ds_read_b64_tr_b16 v[86:87], v9 offset:6144
s_add_u32 m0, s3, 106496
s_add_u32 s43, s92, 0
buffer_load_dwordx4 v1, s[4:7], s43 offen  lds
s_add_u32 m0, s3, 107520
s_add_u32 s43, s92, 0
buffer_load_dwordx4 v2, s[4:7], s43 offen  lds
s_add_u32 m0, s3, 108544
s_add_u32 s43, s92, 20480
buffer_load_dwordx4 v1, s[4:7], s43 offen  lds
s_add_u32 m0, s3, 109568
s_add_u32 s43, s92, 20480
buffer_load_dwordx4 v2, s[4:7], s43 offen  lds
s_mul_i32 s43, s92, 1920
s_add_u32 m0, s41, 16384
s_add_u32 s43, s43, s60
s_add_u32 s43, s43, 0
buffer_load_dwordx4 v3, s[8:11], s43 offen  lds
s_mul_i32 s43, s92, 1920
s_add_u32 m0, s41, 20480
s_add_u32 s43, s43, s60
s_add_u32 s43, s43, 122880
buffer_load_dwordx4 v3, s[8:11], s43 offen  lds
s_add_u32 m0, s3, 122880
s_add_u32 s43, s93, 0
buffer_load_dwordx4 v1, s[4:7], s43 offen  lds
s_add_u32 m0, s3, 123904
s_add_u32 s43, s93, 0
buffer_load_dwordx4 v2, s[4:7], s43 offen  lds
s_add_u32 m0, s3, 124928
s_add_u32 s43, s93, 20480
buffer_load_dwordx4 v1, s[4:7], s43 offen  lds
s_add_u32 m0, s3, 125952
s_add_u32 s43, s93, 20480
buffer_load_dwordx4 v2, s[4:7], s43 offen  lds
s_mul_i32 s43, s93, 1920
s_add_u32 m0, s41, 24576
s_add_u32 s43, s43, s60
s_add_u32 s43, s43, 0
buffer_load_dwordx4 v3, s[8:11], s43 offen  lds
s_mul_i32 s43, s93, 1920
s_add_u32 m0, s41, 28672
s_add_u32 s43, s43, s60
s_add_u32 s43, s43, 122880
buffer_load_dwordx4 v3, s[8:11], s43 offen  lds
s_mul_i32 s43, s94, 1920
s_add_u32 m0, s41, 32768
s_add_u32 s43, s43, s60
s_add_u32 s43, s43, 0
buffer_load_dwordx4 v3, s[8:11], s43 offen  lds
s_mul_i32 s43, s94, 1920
s_add_u32 m0, s41, 36864
s_add_u32 s43, s43, s60
s_add_u32 s43, s43, 122880
buffer_load_dwordx4 v3, s[8:11], s43 offen  lds
s_waitcnt lgkmcnt(0)
s_setprio 3
v_mfma_f32_16x16x32_bf16 v[52:55], v[56:59], v[80:83], 0
v_mfma_f32_16x16x32_bf16 v[52:55], v[56:59], v[84:87], v[52:55]
s_setprio 0
s_mul_i32 s43, s95, 1920
s_add_u32 m0, s41, 40960
s_add_u32 s43, s43, s60
s_add_u32 s43, s43, 0
buffer_load_dwordx4 v3, s[8:11], s43 offen  lds
s_mul_i32 s43, s95, 1920
s_add_u32 m0, s41, 45056
s_add_u32 s43, s43, s60
s_add_u32 s43, s43, 122880
buffer_load_dwordx4 v3, s[8:11], s43 offen  lds
s_waitcnt vmcnt(16)
s_barrier
ds_read_b64_tr_b16 v[88:89], v9 offset:8192
ds_read_b64_tr_b16 v[90:91], v9 offset:10240
ds_read_b64_tr_b16 v[92:93], v9 offset:12288
ds_read_b64_tr_b16 v[94:95], v9 offset:14336
s_add_u32 m0, s3, 73728
s_add_u32 s43, s94, 0
buffer_load_dwordx4 v1, s[4:7], s43 offen  lds
s_add_u32 m0, s3, 74752
s_add_u32 s43, s94, 0
buffer_load_dwordx4 v2, s[4:7], s43 offen  lds
s_add_u32 m0, s3, 75776
s_add_u32 s43, s94, 20480
buffer_load_dwordx4 v1, s[4:7], s43 offen  lds
s_add_u32 m0, s3, 76800
s_add_u32 s43, s94, 20480
buffer_load_dwordx4 v2, s[4:7], s43 offen  lds
s_waitcnt lgkmcnt(0)
s_setprio 3
v_mfma_f32_16x16x32_bf16 v[52:55], v[56:59], v[88:91], v[52:55]
v_mfma_f32_16x16x32_bf16 v[52:55], v[56:59], v[92:95], v[52:55]
s_setprio 0
s_mul_i32 s43, s96, 1920
s_add_u32 m0, s41, 49152
s_add_u32 s43, s43, s60
s_add_u32 s43, s43, 0
buffer_load_dwordx4 v3, s[8:11], s43 offen  lds
s_mul_i32 s43, s96, 1920
s_add_u32 m0, s41, 53248
s_add_u32 s43, s43, s60
s_add_u32 s43, s43, 122880
buffer_load_dwordx4 v3, s[8:11], s43 offen  lds
s_waitcnt vmcnt(16)
s_barrier
ds_read_b64_tr_b16 v[80:81], v9 offset:16384
ds_read_b64_tr_b16 v[82:83], v9 offset:18432
ds_read_b64_tr_b16 v[84:85], v9 offset:20480
ds_read_b64_tr_b16 v[86:87], v9 offset:22528
s_add_u32 m0, s3, 90112
s_add_u32 s43, s95, 0
buffer_load_dwordx4 v1, s[4:7], s43 offen  lds
s_add_u32 m0, s3, 91136
s_add_u32 s43, s95, 0
buffer_load_dwordx4 v2, s[4:7], s43 offen  lds
s_add_u32 m0, s3, 92160
s_add_u32 s43, s95, 20480
buffer_load_dwordx4 v1, s[4:7], s43 offen  lds
s_add_u32 m0, s3, 93184
s_add_u32 s43, s95, 20480
buffer_load_dwordx4 v2, s[4:7], s43 offen  lds
s_waitcnt lgkmcnt(0)
s_setprio 3
v_mfma_f32_16x16x32_bf16 v[52:55], v[56:59], v[80:83], v[52:55]
v_mfma_f32_16x16x32_bf16 v[52:55], v[56:59], v[84:87], v[52:55]
s_setprio 0
s_mul_i32 s43, s97, 1920
s_add_u32 m0, s41, 57344
s_add_u32 s43, s43, s60
s_add_u32 s43, s43, 0
buffer_load_dwordx4 v3, s[8:11], s43 offen  lds
s_mul_i32 s43, s97, 1920
s_add_u32 m0, s41, 61440
s_add_u32 s43, s43, s60
s_add_u32 s43, s43, 122880
buffer_load_dwordx4 v3, s[8:11], s43 offen  lds
s_waitcnt vmcnt(16)
s_barrier
ds_read_b64_tr_b16 v[88:89], v9 offset:24576
ds_read_b64_tr_b16 v[90:91], v9 offset:26624
ds_read_b64_tr_b16 v[92:93], v9 offset:28672
ds_read_b64_tr_b16 v[94:95], v9 offset:30720
s_add_u32 m0, s3, 106496
s_add_u32 s43, s96, 0
buffer_load_dwordx4 v1, s[4:7], s43 offen  lds
s_add_u32 m0, s3, 107520
s_add_u32 s43, s96, 0
buffer_load_dwordx4 v2, s[4:7], s43 offen  lds
s_add_u32 m0, s3, 108544
s_add_u32 s43, s96, 20480
buffer_load_dwordx4 v1, s[4:7], s43 offen  lds
s_add_u32 m0, s3, 109568
s_add_u32 s43, s96, 20480
buffer_load_dwordx4 v2, s[4:7], s43 offen  lds
s_waitcnt lgkmcnt(0)
s_setprio 3
v_mfma_f32_16x16x32_bf16 v[52:55], v[56:59], v[88:91], v[52:55]
v_mfma_f32_16x16x32_bf16 v[52:55], v[56:59], v[92:95], v[52:55]
s_setprio 0
s_mul_i32 s43, s98, 1920
s_add_u32 m0, s41, 0
s_add_u32 s43, s43, s60
s_add_u32 s43, s43, 0
buffer_load_dwordx4 v3, s[8:11], s43 offen  lds
s_mul_i32 s43, s98, 1920
s_add_u32 m0, s41, 4096
s_add_u32 s43, s43, s60
s_add_u32 s43, s43, 122880
buffer_load_dwordx4 v3, s[8:11], s43 offen  lds
s_waitcnt vmcnt(14)
s_barrier
ds_read_b64_tr_b16 v[80:81], v9 offset:32768
ds_read_b64_tr_b16 v[82:83], v9 offset:34816
ds_read_b64_tr_b16 v[84:85], v9 offset:36864
ds_read_b64_tr_b16 v[86:87], v9 offset:38912
s_add_u32 m0, s3, 122880
s_add_u32 s43, s97, 0
buffer_load_dwordx4 v1, s[4:7], s43 offen  lds
s_add_u32 m0, s3, 123904
s_add_u32 s43, s97, 0
buffer_load_dwordx4 v2, s[4:7], s43 offen  lds
s_add_u32 m0, s3, 124928
s_add_u32 s43, s97, 20480
buffer_load_dwordx4 v1, s[4:7], s43 offen  lds
s_add_u32 m0, s3, 125952
s_add_u32 s43, s97, 20480
buffer_load_dwordx4 v2, s[4:7], s43 offen  lds
s_waitcnt lgkmcnt(0)
s_setprio 3
v_mfma_f32_16x16x32_bf16 v[52:55], v[56:59], v[80:83], v[52:55]
v_mfma_f32_16x16x32_bf16 v[52:55], v[56:59], v[84:87], v[52:55]
s_setprio 0
s_mul_i32 s43, s99, 1920
s_add_u32 m0, s41, 8192
s_add_u32 s43, s43, s60
s_add_u32 s43, s43, 0
buffer_load_dwordx4 v3, s[8:11], s43 offen  lds
s_mul_i32 s43, s99, 1920
s_add_u32 m0, s41, 12288
s_add_u32 s43, s43, s60
s_add_u32 s43, s43, 122880
buffer_load_dwordx4 v3, s[8:11], s43 offen  lds
s_waitcnt vmcnt(14)
s_barrier
ds_read_b64_tr_b16 v[88:89], v9 offset:40960
ds_read_b64_tr_b16 v[90:91], v9 offset:43008
ds_read_b64_tr_b16 v[92:93], v9 offset:45056
ds_read_b64_tr_b16 v[94:95], v9 offset:47104
s_add_u32 m0, s3, 73728
s_add_u32 s43, s98, 0
buffer_load_dwordx4 v1, s[4:7], s43 offen  lds
s_add_u32 m0, s3, 74752
s_add_u32 s43, s98, 0
buffer_load_dwordx4 v2, s[4:7], s43 offen  lds
s_add_u32 m0, s3, 75776
s_add_u32 s43, s98, 20480
buffer_load_dwordx4 v1, s[4:7], s43 offen  lds
s_add_u32 m0, s3, 76800
s_add_u32 s43, s98, 20480
buffer_load_dwordx4 v2, s[4:7], s43 offen  lds
s_waitcnt lgkmcnt(0)
s_setprio 3
v_mfma_f32_16x16x32_bf16 v[52:55], v[56:59], v[88:91], v[52:55]
v_mfma_f32_16x16x32_bf16 v[52:55], v[56:59], v[92:95], v[52:55]
s_setprio 0
s_mul_i32 s43, s90, 1920
s_add_u32 m0, s41, 16384
s_add_u32 s43, s43, s61
s_add_u32 s43, s43, 0
buffer_load_dwordx4 v3, s[8:11], s43 offen  lds
s_mul_i32 s43, s90, 1920
s_add_u32 m0, s41, 20480
s_add_u32 s43, s43, s61
s_add_u32 s43, s43, 122880
buffer_load_dwordx4 v3, s[8:11], s43 offen  lds
s_waitcnt vmcnt(14)
s_barrier
ds_read_b64_tr_b16 v[80:81], v9 offset:49152
ds_read_b64_tr_b16 v[82:83], v9 offset:51200
ds_read_b64_tr_b16 v[84:85], v9 offset:53248
ds_read_b64_tr_b16 v[86:87], v9 offset:55296
s_add_u32 m0, s3, 90112
s_add_u32 s43, s99, 0
buffer_load_dwordx4 v1, s[4:7], s43 offen  lds
s_add_u32 m0, s3, 91136
s_add_u32 s43, s99, 0
buffer_load_dwordx4 v2, s[4:7], s43 offen  lds
s_add_u32 m0, s3, 92160
s_add_u32 s43, s99, 20480
buffer_load_dwordx4 v1, s[4:7], s43 offen  lds
s_add_u32 m0, s3, 93184
s_add_u32 s43, s99, 20480
buffer_load_dwordx4 v2, s[4:7], s43 offen  lds
s_waitcnt lgkmcnt(0)
s_setprio 3
v_mfma_f32_16x16x32_bf16 v[52:55], v[56:59], v[80:83], v[52:55]
v_mfma_f32_16x16x32_bf16 v[52:55], v[56:59], v[84:87], v[52:55]
s_setprio 0
s_mul_i32 s43, s91, 1920
s_add_u32 m0, s41, 24576
s_add_u32 s43, s43, s61
s_add_u32 s43, s43, 0
buffer_load_dwordx4 v3, s[8:11], s43 offen  lds
s_mul_i32 s43, s91, 1920
s_add_u32 m0, s41, 28672
s_add_u32 s43, s43, s61
s_add_u32 s43, s43, 122880
buffer_load_dwordx4 v3, s[8:11], s43 offen  lds
s_add_u32 m0, s3, 144384
s_nop 0
buffer_load_dwordx4 v112, s[28:31], s66 offen nt lds
s_add_u32 m0, s3, 145408
s_nop 0
buffer_load_dwordx4 v112, s[28:31], s67 offen nt lds
s_add_u32 m0, s3, 146432
s_nop 0
buffer_load_dwordx4 v112, s[28:31], s68 offen nt lds
s_add_u32 m0, s3, 147456
s_nop 0
buffer_load_dwordx4 v112, s[28:31], s69 offen nt lds
s_waitcnt vmcnt(18)
s_barrier
ds_read_b64_tr_b16 v[88:89], v9 offset:57344
ds_read_b64_tr_b16 v[90:91], v9 offset:59392
ds_read_b64_tr_b16 v[92:93], v9 offset:61440
ds_read_b64_tr_b16 v[94:95], v9 offset:63488
s_waitcnt lgkmcnt(0)
s_setprio 3
v_mfma_f32_16x16x32_bf16 v[52:55], v[56:59], v[88:91], v[52:55]
v_mfma_f32_16x16x32_bf16 v[52:55], v[56:59], v[92:95], v[52:55]
s_setprio 0
s_mul_i32 s43, s92, 1920
s_add_u32 m0, s41, 32768
s_add_u32 s43, s43, s61
s_add_u32 s43, s43, 0
buffer_load_dwordx4 v3, s[8:11], s43 offen  lds
s_mul_i32 s43, s92, 1920
s_add_u32 m0, s41, 36864
s_add_u32 s43, s43, s61
s_add_u32 s43, s43, 122880
buffer_load_dwordx4 v3, s[8:11], s43 offen  lds
s_waitcnt vmcnt(14)
s_barrier
ds_read_b64_tr_b16 v[80:81], v9 offset:0
ds_read_b64_tr_b16 v[82:83], v9 offset:2048
ds_read_b64_tr_b16 v[84:85], v9 offset:4096
ds_read_b64_tr_b16 v[86:87], v9 offset:6144
s_waitcnt lgkmcnt(0)
s_setprio 3
v_mfma_f32_16x16x32_bf16 v[52:55], v[56:59], v[80:83], v[52:55]
v_mfma_f32_16x16x32_bf16 v[52:55], v[56:59], v[84:87], v[52:55]
s_setprio 0
s_mul_i32 s43, s93, 1920
s_add_u32 m0, s41, 40960
s_add_u32 s43, s43, s61
s_add_u32 s43, s43, 0
buffer_load_dwordx4 v3, s[8:11], s43 offen  lds
s_mul_i32 s43, s93, 1920
s_add_u32 m0, s41, 45056
s_add_u32 s43, s43, s61
s_add_u32 s43, s43, 122880
buffer_load_dwordx4 v3, s[8:11], s43 offen  lds
s_waitcnt vmcnt(10)
s_barrier
ds_read_b64_tr_b16 v[88:89], v9 offset:8192
ds_read_b64_tr_b16 v[90:91], v9 offset:10240
ds_read_b64_tr_b16 v[92:93], v9 offset:12288
ds_read_b64_tr_b16 v[94:95], v9 offset:14336
s_waitcnt lgkmcnt(0)
s_setprio 3
v_mfma_f32_16x16x32_bf16 v[52:55], v[56:59], v[88:91], v[52:55]
v_mfma_f32_16x16x32_bf16 v[52:55], v[56:59], v[92:95], v[52:55]
s_setprio 0
v_and_b32 v32, 15, v0
s_lshl_b32 s43, s37, 7
s_add_u32 s43, s43, 141312
v_lshl_add_u32 v32, v32, 3, s43
s_nop 2
v_cvt_pk_bf16_f32 v30, v52, v52
v_and_b32 v30, 0xffff0000, v30
v_sub_f32 v52, v52, v30
v_cvt_pk_bf16_f32 v34, v30, v52
v_cvt_pk_bf16_f32 v35, v30, 0
ds_write_b64 v32, v[34:35]
s_mul_i32 s43, s94, 1920
s_add_u32 m0, s41, 49152
s_add_u32 s43, s43, s61
s_add_u32 s43, s43, 0
buffer_load_dwordx4 v3, s[8:11], s43 offen  lds
s_mul_i32 s43, s94, 1920
s_add_u32 m0, s41, 53248
s_add_u32 s43, s43, s61
s_add_u32 s43, s43, 122880
buffer_load_dwordx4 v3, s[8:11], s43 offen  lds
s_waitcnt vmcnt(10) lgkmcnt(0)
s_barrier
s_mul_i32 s43, s95, 1920
s_add_u32 m0, s41, 57344
s_add_u32 s43, s43, s61
s_add_u32 s43, s43, 0
buffer_load_dwordx4 v3, s[8:11], s43 offen  lds
s_mul_i32 s43, s95, 1920
s_add_u32 m0, s41, 61440
s_add_u32 s43, s43, s61
s_add_u32 s43, s43, 122880
buffer_load_dwordx4 v3, s[8:11], s43 offen  lds
s_mul_i32 s43, s96, 1920
s_add_u32 m0, s41, 106496
s_add_u32 s43, s43, s61
s_add_u32 s43, s43, 0
buffer_load_dwordx4 v3, s[8:11], s43 offen  lds
s_mul_i32 s43, s96, 1920
s_add_u32 m0, s41, 110592
s_add_u32 s43, s43, s61
s_add_u32 s43, s43, 122880
buffer_load_dwordx4 v3, s[8:11], s43 offen  lds
s_mul_i32 s43, s97, 1920
s_add_u32 m0, s41, 114688
s_add_u32 s43, s43, s61
s_add_u32 s43, s43, 0
buffer_load_dwordx4 v3, s[8:11], s43 offen  lds
s_mul_i32 s43, s97, 1920
s_add_u32 m0, s41, 118784
s_add_u32 s43, s43, s61
s_add_u32 s43, s43, 122880
buffer_load_dwordx4 v3, s[8:11], s43 offen  lds
v_mbcnt_lo_u32_b32 v115, -1, 0
v_mbcnt_hi_u32_b32 v115, -1, v115
v_bfe_u32 v113, v115, 2, 2
v_lshrrev_b32 v114, 4, v115
v_lshl_add_u32 v114, v114, 3, v113
v_lshlrev_b32 v114, 7, v114
v_lshrrev_b32 v113, 1, v113
v_lshl_add_u32 v114, v113, 6, v114
v_and_b32 v113, 3, v115
v_lshl_add_u32 v114, v113, 3, v114
s_add_u32 s43, s3, 144384
v_add_u32 v113, s43, v114
v_xor_b32 v114, 64, v113
v_lshlrev_b32 v115, 4, v115
s_waitcnt vmcnt(12)
ds_read_b64_tr_b16 v[64:65], v113 offset:0
ds_read_b64_tr_b16 v[66:67], v113 offset:512
ds_read_b64_tr_b16 v[68:69], v113 offset:32
ds_read_b64_tr_b16 v[70:71], v113 offset:544
ds_read_b64_tr_b16 v[72:73], v114 offset:0
ds_read_b64_tr_b16 v[74:75], v114 offset:512
ds_read_b64_tr_b16 v[76:77], v114 offset:32
ds_read_b64_tr_b16 v[78:79], v114 offset:544
s_waitcnt lgkmcnt(6)
buffer_store_dwordx4 v[64:67], v115, s[16:19], s32 offen sc1
s_waitcnt lgkmcnt(4)
buffer_store_dwordx4 v[68:71], v115, s[16:19], s33 offen sc1
s_waitcnt lgkmcnt(2)
buffer_store_dwordx4 v[72:75], v115, s[16:19], s34 offen sc1
s_waitcnt lgkmcnt(0)
buffer_store_dwordx4 v[76:79], v115, s[16:19], s35 offen sc1
s_waitcnt vmcnt(12)
s_barrier
s_lshl_b32 s44, s40, 11
s_add_u32 s44, s44, 23200256
buffer_load_dwordx2 v[104:105], v100, s[16:19], s44 offen sc1
s_mul_i32 s43, s98, 1920
s_add_u32 m0, s41, 122880
s_add_u32 s43, s43, s61
s_add_u32 s43, s43, 0
buffer_load_dwordx4 v3, s[8:11], s43 offen  lds
s_mul_i32 s43, s98, 1920
s_add_u32 m0, s41, 126976
s_add_u32 s43, s43, s61
s_add_u32 s43, s43, 122880
buffer_load_dwordx4 v3, s[8:11], s43 offen  lds
s_mul_i32 s43, s99, 1920
s_add_u32 m0, s41, 131072
s_add_u32 s43, s43, s61
s_add_u32 s43, s43, 0
buffer_load_dwordx4 v3, s[8:11], s43 offen  lds
s_mul_i32 s43, s99, 1920
s_add_u32 m0, s41, 135168
s_add_u32 s43, s43, s61
s_add_u32 s43, s43, 122880
buffer_load_dwordx4 v3, s[8:11], s43 offen  lds
s_mul_i32 s43, s90, 1728
s_add_u32 m0, s41, 73728
s_add_u32 s43, s43, s62
s_add_u32 s43, s43, 0
buffer_load_dwordx4 v4, s[12:15], s43 offen  lds
s_mul_i32 s43, s90, 1728
s_add_u32 m0, s41, 77824
s_add_u32 s43, s43, s62
s_add_u32 s43, s43, 110592
buffer_load_dwordx4 v4, s[12:15], s43 offen  lds
s_waitcnt vmcnt(15)
s_barrier
s_mul_i32 s43, s91, 1728
s_add_u32 m0, s41, 81920
s_add_u32 s43, s43, s62
s_add_u32 s43, s43, 0
buffer_load_dwordx4 v4, s[12:15], s43 offen  lds
s_mul_i32 s43, s91, 1728
s_add_u32 m0, s41, 86016
s_add_u32 s43, s43, s62
s_add_u32 s43, s43, 110592
buffer_load_dwordx4 v4, s[12:15], s43 offen  lds
s_mul_i32 s43, s92, 1728
s_add_u32 m0, s41, 90112
s_add_u32 s43, s43, s62
s_add_u32 s43, s43, 0
buffer_load_dwordx4 v4, s[12:15], s43 offen  lds
s_mul_i32 s43, s92, 1728
s_add_u32 m0, s41, 94208
s_add_u32 s43, s43, s62
s_add_u32 s43, s43, 110592
buffer_load_dwordx4 v4, s[12:15], s43 offen  lds
s_mul_i32 s43, s93, 1728
s_add_u32 m0, s41, 98304
s_add_u32 s43, s43, s62
s_add_u32 s43, s43, 0
buffer_load_dwordx4 v4, s[12:15], s43 offen  lds
s_mul_i32 s43, s93, 1728
s_add_u32 m0, s41, 102400
s_add_u32 s43, s43, s62
s_add_u32 s43, s43, 110592
buffer_load_dwordx4 v4, s[12:15], s43 offen  lds
s_waitcnt vmcnt(12)
s_and_b32 s43, s54, 0xbfffbfff
s_mov_b32 s47, 0
Lcs_1:
v_cmp_ne_u32 s[64:65], s43, v105
s_add_u32 s47, s47, 1
s_cmp_eq_u64 s[64:65], 0
s_cbranch_scc1 Lcs_2
s_cmp_gt_u32 s47, 400000
s_cbranch_scc1 Lcs_2
s_sleep 4
s_lshl_b32 s44, s40, 11
s_add_u32 s44, s44, 23200256
buffer_load_dwordx2 v[104:105], v100, s[16:19], s44 offen sc1
s_waitcnt vmcnt(0)
s_branch Lcs_1
Lcs_2:
ds_write_b64 v101, v[104:105] offset:512
s_waitcnt lgkmcnt(0)
s_barrier
s_mul_i32 s43, s94, 1728
s_add_u32 m0, s41, 0
s_add_u32 s43, s43, s62
s_add_u32 s43, s43, 0
buffer_load_dwordx4 v4, s[12:15], s43 offen  lds
s_mul_i32 s43, s94, 1728
s_add_u32 m0, s41, 4096
s_add_u32 s43, s43, s62
s_add_u32 s43, s43, 110592
buffer_load_dwordx4 v4, s[12:15], s43 offen  lds
s_mul_i32 s43, s95, 1728
s_add_u32 m0, s41, 8192
s_add_u32 s43, s43, s62
s_add_u32 s43, s43, 0
buffer_load_dwordx4 v4, s[12:15], s43 offen  lds
s_mul_i32 s43, s95, 1728
s_add_u32 m0, s41, 12288
s_add_u32 s43, s43, s62
s_add_u32 s43, s43, 110592
buffer_load_dwordx4 v4, s[12:15], s43 offen  lds
s_mul_i32 s43, s96, 1728
s_add_u32 m0, s41, 16384
s_add_u32 s43, s43, s62
s_add_u32 s43, s43, 0
buffer_load_dwordx4 v4, s[12:15], s43 offen  lds
s_mul_i32 s43, s96, 1728
s_add_u32 m0, s41, 20480
s_add_u32 s43, s43, s62
s_add_u32 s43, s43, 110592
buffer_load_dwordx4 v4, s[12:15], s43 offen  lds
s_waitcnt vmcnt(14)
s_barrier
s_mul_i32 s43, s97, 1728
s_add_u32 m0, s41, 24576
s_add_u32 s43, s43, s62
s_add_u32 s43, s43, 0
buffer_load_dwordx4 v4, s[12:15], s43 offen  lds
s_mul_i32 s43, s97, 1728
s_add_u32 m0, s41, 28672
s_add_u32 s43, s43, s62
s_add_u32 s43, s43, 110592
buffer_load_dwordx4 v4, s[12:15], s43 offen  lds
s_mul_i32 s43, s98, 1728
s_add_u32 m0, s41, 32768
s_add_u32 s43, s43, s62
s_add_u32 s43, s43, 0
buffer_load_dwordx4 v4, s[12:15], s43 offen  lds
s_mul_i32 s43, s98, 1728
s_add_u32 m0, s41, 36864
s_add_u32 s43, s43, s62
s_add_u32 s43, s43, 110592
buffer_load_dwordx4 v4, s[12:15], s43 offen  lds
s_mul_i32 s43, s99, 1728
s_add_u32 m0, s41, 40960
s_add_u32 s43, s43, s62
s_add_u32 s43, s43, 0
buffer_load_dwordx4 v4, s[12:15], s43 offen  lds
s_mul_i32 s43, s99, 1728
s_add_u32 m0, s41, 45056
s_add_u32 s43, s43, s62
s_add_u32 s43, s43, 110592
buffer_load_dwordx4 v4, s[12:15], s43 offen  lds
s_waitcnt vmcnt(16)
s_barrier
s_mul_i32 s43, s90, 1728
s_add_u32 m0, s41, 49152
s_add_u32 s43, s43, s63
s_add_u32 s43, s43, 0
buffer_load_dwordx4 v4, s[12:15], s43 offen  lds
s_mul_i32 s43, s90, 1728
s_add_u32 m0, s41, 53248
s_add_u32 s43, s43, s63
s_add_u32 s43, s43, 110592
buffer_load_dwordx4 v4, s[12:15], s43 offen  lds
s_mul_i32 s43, s91, 1728
s_add_u32 m0, s41, 57344
s_add_u32 s43, s43, s63
s_add_u32 s43, s43, 0
buffer_load_dwordx4 v4, s[12:15], s43 offen  lds
s_mul_i32 s43, s91, 1728
s_add_u32 m0, s41, 61440
s_add_u32 s43, s43, s63
s_add_u32 s43, s43, 110592
buffer_load_dwordx4 v4, s[12:15], s43 offen  lds
s_mul_i32 s43, s92, 1728
s_add_u32 m0, s41, 106496
s_add_u32 s43, s43, s63
s_add_u32 s43, s43, 0
buffer_load_dwordx4 v4, s[12:15], s43 offen  lds
s_mul_i32 s43, s92, 1728
s_add_u32 m0, s41, 110592
s_add_u32 s43, s43, s63
s_add_u32 s43, s43, 110592
buffer_load_dwordx4 v4, s[12:15], s43 offen  lds
s_waitcnt vmcnt(18)
s_barrier
s_mul_i32 s43, s93, 1728
s_add_u32 m0, s41, 114688
s_add_u32 s43, s43, s63
s_add_u32 s43, s43, 0
buffer_load_dwordx4 v4, s[12:15], s43 offen  lds
s_mul_i32 s43, s93, 1728
s_add_u32 m0, s41, 118784
s_add_u32 s43, s43, s63
s_add_u32 s43, s43, 110592
buffer_load_dwordx4 v4, s[12:15], s43 offen  lds
s_mul_i32 s43, s94, 1728
s_add_u32 m0, s41, 122880
s_add_u32 s43, s43, s63
s_add_u32 s43, s43, 0
buffer_load_dwordx4 v4, s[12:15], s43 offen  lds
s_mul_i32 s43, s94, 1728
s_add_u32 m0, s41, 126976
s_add_u32 s43, s43, s63
s_add_u32 s43, s43, 110592
buffer_load_dwordx4 v4, s[12:15], s43 offen  lds
s_mul_i32 s43, s95, 1728
s_add_u32 m0, s41, 131072
s_add_u32 s43, s43, s63
s_add_u32 s43, s43, 0
buffer_load_dwordx4 v4, s[12:15], s43 offen  lds
s_mul_i32 s43, s95, 1728
s_add_u32 m0, s41, 135168
s_add_u32 s43, s43, s63
s_add_u32 s43, s43, 110592
buffer_load_dwordx4 v4, s[12:15], s43 offen  lds
s_mul_i32 s43, s57, 80
s_add_u32 s43, s43, s56
s_lshl_b32 s43, s43, 3
s_add_u32 s43, s43, 23175168
s_cmp_lt_u32 s56, 74
s_cselect_b32 s43, s43, 1073741824
v_mov_b32 v116, s54
v_mov_b32 v117, s55
s_mov_b64 exec, 1
buffer_store_dwordx2 v[116:117], off, s[16:19], s43 sc1
s_mov_b64 exec, -1
s_waitcnt vmcnt(20)
s_barrier
s_mul_i32 s43, s96, 1728
s_add_u32 m0, s41, 73728
s_add_u32 s43, s43, s63
s_add_u32 s43, s43, 0
buffer_load_dwordx4 v4, s[12:15], s43 offen  lds
s_mul_i32 s43, s96, 1728
s_add_u32 m0, s41, 77824
s_add_u32 s43, s43, s63
s_add_u32 s43, s43, 110592
buffer_load_dwordx4 v4, s[12:15], s43 offen  lds
s_mul_i32 s43, s97, 1728
s_add_u32 m0, s41, 81920
s_add_u32 s43, s43, s63
s_add_u32 s43, s43, 0
buffer_load_dwordx4 v4, s[12:15], s43 offen  lds
s_mul_i32 s43, s97, 1728
s_add_u32 m0, s41, 86016
s_add_u32 s43, s43, s63
s_add_u32 s43, s43, 110592
buffer_load_dwordx4 v4, s[12:15], s43 offen  lds
s_mul_i32 s43, s98, 1728
s_add_u32 m0, s41, 90112
s_add_u32 s43, s43, s63
s_add_u32 s43, s43, 0
buffer_load_dwordx4 v4, s[12:15], s43 offen  lds
s_mul_i32 s43, s98, 1728
s_add_u32 m0, s41, 94208
s_add_u32 s43, s43, s63
s_add_u32 s43, s43, 110592
buffer_load_dwordx4 v4, s[12:15], s43 offen  lds
s_lshl_b32 s45, s48, 4
s_sub_i32 s45, 32, s45
s_lshl_b32 s43, s37, 6
v_add_u32 v48, s43, v0
v_mov_b32 v49, 1073741824
s_movk_i32 s46, 9600
v_mul_u32_u24 v50, 1639, v48
v_lshlrev_b32 v36, 4, v48
v_lshrrev_b32 v50, 16, v50
v_cmp_gt_i32 s[66:67], s45, v50
v_add_u32 v48, 256, v48
v_mad_u32_u24 v36, v50, s46, v36
v_cndmask_b32 v36, v36, v49, s[66:67]
v_mul_u32_u24 v50, 1639, v48
v_lshlrev_b32 v37, 4, v48
v_lshrrev_b32 v50, 16, v50
v_cmp_gt_i32 s[66:67], s45, v50
v_add_u32 v48, 256, v48
v_mad_u32_u24 v37, v50, s46, v37
v_cndmask_b32 v37, v37, v49, s[66:67]
v_mul_u32_u24 v50, 1639, v48
v_lshlrev_b32 v38, 4, v48
v_lshrrev_b32 v50, 16, v50
v_cmp_gt_i32 s[66:67], s45, v50
v_add_u32 v48, 256, v48
v_mad_u32_u24 v38, v50, s46, v38
v_cndmask_b32 v38, v38, v49, s[66:67]
v_mul_u32_u24 v50, 1639, v48
v_lshlrev_b32 v39, 4, v48
v_lshrrev_b32 v50, 16, v50
v_cmp_gt_i32 s[66:67], s45, v50
v_add_u32 v48, 256, v48
v_mad_u32_u24 v39, v50, s46, v39
v_cndmask_b32 v39, v39, v49, s[66:67]
v_mul_u32_u24 v50, 1639, v48
v_lshlrev_b32 v40, 4, v48
v_lshrrev_b32 v50, 16, v50
v_cmp_gt_i32 s[66:67], s45, v50
v_add_u32 v48, 256, v48
v_mad_u32_u24 v40, v50, s46, v40
v_cndmask_b32 v40, v40, v49, s[66:67]
v_mul_u32_u24 v50, 1639, v48
v_lshlrev_b32 v41, 4, v48
v_lshrrev_b32 v50, 16, v50
v_cmp_gt_i32 s[66:67], s45, v50
v_add_u32 v48, 256, v48
v_mad_u32_u24 v41, v50, s46, v41
v_cndmask_b32 v41, v41, v49, s[66:67]
v_mul_u32_u24 v50, 1639, v48
v_lshlrev_b32 v42, 4, v48
v_lshrrev_b32 v50, 16, v50
v_cmp_gt_i32 s[66:67], s45, v50
v_add_u32 v48, 256, v48
v_mad_u32_u24 v42, v50, s46, v42
v_cndmask_b32 v42, v42, v49, s[66:67]
v_mul_u32_u24 v50, 1639, v48
v_lshlrev_b32 v43, 4, v48
v_lshrrev_b32 v50, 16, v50
v_cmp_gt_i32 s[66:67], s45, v50
v_add_u32 v48, 256, v48
v_mad_u32_u24 v43, v50, s46, v43
v_cndmask_b32 v43, v43, v49, s[66:67]
v_lshlrev_b32 v46, 4, v0
v_and_b32 v50, 31, v0
v_lshrrev_b32 v51, 5, v0
v_lshlrev_b32 v50, 4, v50
v_lshl_add_u32 v47, v51, 15, v50
v_lshlrev_b32 v44, 6, v0
v_mov_b32 v50, 143876
s_waitcnt vmcnt(22)
s_barrier
s_lshl_b32 s44, s40, 11
s_add_u32 s44, s44, 23200768
buffer_load_dwordx2 v[102:103], v100, s[16:19], s44 offen sc1
s_mul_i32 s43, s99, 1728
s_add_u32 m0, s41, 98304
s_add_u32 s43, s43, s63
s_add_u32 s43, s43, 0
buffer_load_dwordx4 v4, s[12:15], s43 offen  lds
s_mul_i32 s43, s99, 1728
s_add_u32 m0, s41, 102400
s_add_u32 s43, s43, s63
s_add_u32 s43, s43, 110592
buffer_load_dwordx4 v4, s[12:15], s43 offen  lds
s_waitcnt vmcnt(21)
s_barrier
s_lshl_b32 s44, s40, 11
s_add_u32 s44, s44, 23201280
buffer_load_dwordx2 v[104:105], v100, s[16:19], s44 offen sc1
s_waitcnt vmcnt(3)
s_and_b32 s43, s54, 0xbfffbfff
s_mov_b32 s47, 0
Lcs_3:
v_cmp_ne_u32 s[64:65], s43, v103
s_add_u32 s47, s47, 1
s_cmp_eq_u64 s[64:65], 0
s_cbranch_scc1 Lcs_4
s_cmp_gt_u32 s47, 400000
s_cbranch_scc1 Lcs_4
s_sleep 4
s_lshl_b32 s44, s40, 11
s_add_u32 s44, s44, 23200768
buffer_load_dwordx2 v[102:103], v100, s[16:19], s44 offen sc1
s_waitcnt vmcnt(0)
s_branch Lcs_3
Lcs_4:
ds_write_b64 v101, v[102:103] offset:0
s_waitcnt lgkmcnt(0)
s_barrier
s_waitcnt vmcnt(0)
s_and_b32 s43, s54, 0xbfffbfff
s_mov_b32 s47, 0
Lcs_5:
v_cmp_ne_u32 s[64:65], s43, v105
s_add_u32 s47, s47, 1
s_cmp_eq_u64 s[64:65], 0
s_cbranch_scc1 Lcs_6
s_cmp_gt_u32 s47, 400000
s_cbranch_scc1 Lcs_6
s_sleep 4
s_lshl_b32 s44, s40, 11
s_add_u32 s44, s44, 23201280
buffer_load_dwordx2 v[104:105], v100, s[16:19], s44 offen sc1
s_waitcnt vmcnt(0)
s_branch Lcs_5
Lcs_6:
ds_write_b64 v101, v[104:105] offset:512
s_waitcnt lgkmcnt(0)
s_barrier
L_hjoin:
s_mov_b32 s47, 0
Lgx_9:
ds_read_b32 v51, v50
s_add_u32 s47, s47, 1
s_cmp_gt_u32 s47, 3200000
s_cbranch_scc1 Lgo_7
s_waitcnt lgkmcnt(0)
v_readfirstlane_b32 s43, v51
s_nop 0
s_cmp_eq_u32 s43, 1
s_cbranch_scc1 Lgo_7
s_cmp_eq_u32 s36, 0
s_cbranch_scc1 Lgw_8
s_sleep 1
s_branch Lgx_9
Lgw_8:
s_mul_i32 s43, s49, 40
s_add_u32 s44, s43, 39
s_lshr_b32 s43, s43, 7
s_lshr_b32 s44, s44, 7
s_lshl_b32 s43, 1, s43
s_lshl_b32 s44, 1, s44
s_or_b32 s43, s43, s44
s_mul_i32 s44, s43, 0x420
s_or_b32 s46, s43, s44
s_lshl_b32 s43, s44, 16
s_cmp_ge_u32 s48, 1
s_cselect_b32 s43, s43, 0
s_cmp_ge_u32 s48, 2
s_cselect_b32 s44, s44, 0
s_or_b32 s43, s43, s44
s_lshl_b32 s44, s48, 10
s_add_u32 s44, s44, 23066624
s_mov_b32 s47, 0
Lpoll_10:
s_mov_b32 exec_lo, s43
s_mov_b32 exec_hi, s46
buffer_load_dwordx2 v[52:53], v44, s[16:19], s44 offen sc1
s_add_u32 s47, s47, 1
s_cmp_gt_u32 s47, 400000
s_cbranch_scc1 Lpd_11
s_waitcnt vmcnt(0)
v_cmp_ne_u64 s[64:65], s[54:55], v[52:53]
s_mov_b64 exec, -1
s_cmp_lg_u64 s[64:65], 0
s_cbranch_scc0 Lpd_11
s_sleep 4
s_branch Lpoll_10
Lpd_11:
s_mov_b64 exec, -1
v_mov_b32 v51, 1
ds_write_b32 v50, v51
Lgo_7:
s_mul_i32 s46, s49, 163840
s_lshl_b32 s45, s48, 11
s_add_u32 s46, s46, s45
s_mul_i32 s45, s37, 2560
s_add_u32 m0, s45, 30720
s_lshl_b32 s43, s37, 9
s_add_u32 s43, s43, s46
buffer_load_dwordx4 v47, s[16:19], s43 offen offset:0 sc1 lds
s_add_u32 m0, s45, 31744
s_add_u32 s43, s43, 65536
buffer_load_dwordx4 v47, s[16:19], s43 offen offset:0 sc1 lds
s_add_u32 m0, s45, 32768
s_add_u32 s43, s43, 65536
s_mov_b32 exec_hi, 0
buffer_load_dwordx4 v47, s[16:19], s43 offen offset:0 sc1 lds
s_mov_b32 exec_hi, -1
s_add_u32 s46, s46, 2617344
s_mul_i32 s45, s37, 6144
s_mov_b32 m0, s45
s_lshl_b32 s43, s37, 15
s_add_u32 s43, s43, s46
buffer_load_dwordx4 v46, s[16:19], s43 offen offset:0 sc1 lds
buffer_load_dwordx4 v46, s[16:19], s43 offen offset:1024 sc1 lds
buffer_load_dwordx4 v46, s[16:19], s43 offen offset:2048 sc1 lds
buffer_load_dwordx4 v46, s[16:19], s43 offen offset:3072 sc1 lds
s_add_u32 m0, s45, 4096
s_add_u32 s43, s43, 4096
buffer_load_dwordx4 v46, s[16:19], s43 offen offset:0 sc1 lds
buffer_load_dwordx4 v46, s[16:19], s43 offen offset:1024 sc1 lds
s_add_u32 m0, s41, 24576
s_add_u32 s43, s46, s41
s_add_u32 s43, s43, 131072
buffer_load_dwordx4 v46, s[16:19], s43 offen offset:0 sc1 lds
s_cmp_ge_u32 s37, 2
s_cbranch_scc1 Lk_12
s_add_u32 m0, s41, 28672
s_add_u32 s43, s43, 4096
buffer_load_dwordx4 v46, s[16:19], s43 offen offset:0 sc1 lds
Lk_12:
s_mul_i32 s46, s48, 163840
s_mul_i32 s45, s49, 640
s_add_u32 s46, s46, s45
s_add_u32 s46, s46, 4915200
s_add_u32 m0, s41, 40960
s_nop 0
buffer_load_dwordx4 v36, s[16:19], s46 offen offset:0 sc1 lds
s_add_u32 m0, s41, 45056
s_nop 0
buffer_load_dwordx4 v37, s[16:19], s46 offen offset:0 sc1 lds
s_add_u32 m0, s41, 49152
s_nop 0
buffer_load_dwordx4 v38, s[16:19], s46 offen offset:0 sc1 lds
s_add_u32 m0, s41, 53248
s_nop 0
buffer_load_dwordx4 v39, s[16:19], s46 offen offset:0 sc1 lds
s_add_u32 m0, s41, 57344
s_nop 0
buffer_load_dwordx4 v40, s[16:19], s46 offen offset:0 sc1 lds
s_add_u32 m0, s41, 61440
s_nop 0
buffer_load_dwordx4 v41, s[16:19], s46 offen offset:0 sc1 lds
s_add_u32 m0, s41, 65536
s_nop 0
buffer_load_dwordx4 v42, s[16:19], s46 offen offset:0 sc1 lds
s_cmp_ge_u32 s37, 2
s_cbranch_scc1 Lk_13
s_add_u32 m0, s41, 69632
s_nop 0
buffer_load_dwordx4 v43, s[16:19], s46 offen offset:0 sc1 lds
Lk_13:
v_and_b32 v14, 31, v0
v_lshrrev_b32 v15, 5, v0
s_lshl_b32 s43, s37, 9
v_lshl_add_u32 v6, v14, 4, s43
v_add_u32 v5, 0, v15
v_mul_u32_u24 v1, 6144, v5
v_add_u32 v1, v1, v6
v_add_u32 v2, 12288, v6
s_mul_i32 s44, s37, 2560
s_add_u32 s45, s44, 30720
v_lshl_add_u32 v6, v14, 4, s45
v_lshl_add_u32 v34, v5, 9, v6
v_add_u32 v35, 1024, v6
s_and_b32 s43, s2, 6
s_lshl_b32 s28, s43, 2
s_lshr_b32 s44, s2, 3
s_and_b32 s44, s44, 7
s_add_u32 s28, s28, s44
s_and_b32 s29, s2, 1
s_lshl_b32 s29, s29, 2
s_lshr_b32 s44, s2, 6
s_add_u32 s29, s29, s44
v_mul_u32_u24 v6, 40, v15
v_add_u32 v6, v6, v14
s_mul_i32 s44, s37, 2560
s_add_u32 s43, s44, 40960
v_lshl_add_u32 v3, v6, 4, s43
s_mov_b32 s56, 0xfffff
s_mov_b32 s57, 0xfffff
v_mov_b32 v76, 0x3f803f80
v_mov_b32 v77, 0x3f803f80
v_mov_b32 v78, 0x3f803f80
v_mov_b32 v79, 0x3f803f80
v_mov_b32 v80, 0x3f803f80
v_mov_b32 v81, 0x3f803f80
v_mov_b32 v82, 0x3f803f80
v_mov_b32 v83, 0x3f803f80
v_mov_b32 v84, 0x3f803f80
v_mov_b32 v85, 0x3f803f80
v_mov_b32 v86, 0x3f803f80
v_mov_b32 v87, 0x3f803f80
v_mov_b32 v88, 0x3f803f80
v_mov_b32 v89, 0x3f803f80
v_mov_b32 v90, 0x3f803f80
v_mov_b32 v91, 0x3f803f80
v_mov_b32 v60, 0
v_mov_b32 v61, 0
s_mov_b32 exec_hi, 0
v_mov_b32 v60, 0x3f803f80
v_mov_b32 v61, 0x3f80
s_mov_b32 exec_hi, -1
v_bfe_u32 v12, v0, 4, 1
v_lshlrev_b32 v12, 10, v12
v_and_b32 v13, 15, v0
v_lshl_add_u32 v6, v15, 4, v13
v_lshl_add_u32 v13, v13, 3, v12
v_lshl_add_u32 v12, v6, 4, v12
v_lshl_add_u32 v13, v15, 30, v13
s_mul_i32 s30, s28, 303104
s_add_u32 s30, s30, 8388608
s_mul_i32 s31, s29, 378880
s_add_u32 s31, s31, 18874368
s_and_b32 s51, s36, 1
s_add_u32 s51, s51, 8
s_lshl_b32 s51, s51, 10
s_lshr_b32 s52, s36, 1
s_mov_b32 s42, 0
v_lshlrev_b32 v33, 4, v0
v_add_u32 v8, s41, v33
v_add_u32 v9, s51, v33
v_lshlrev_b32 v32, 6, v0
v_mov_b32 v7, 0xffff
s_mov_b32 s64, 0xffffffff
s_mov_b32 s65, 0xfffffff0
v_cndmask_b32 v16, 0, v7, s[64:65]
s_mov_b32 s66, 0xfffffffe
s_mov_b32 s67, 0xffffffe0
v_cndmask_b32 v16, v16, -1, s[66:67]
s_mov_b32 s64, 0xfffffffc
s_mov_b32 s65, 0xffffffc0
v_cndmask_b32 v17, 0, v7, s[64:65]
s_mov_b32 s66, 0xfffffff8
s_mov_b32 s67, 0xffffff80
v_cndmask_b32 v17, v17, -1, s[66:67]
s_mov_b32 s64, 0xffffff00
s_mov_b32 s65, 0xfffff000
v_cndmask_b32 v18, 0, v7, s[64:65]
s_mov_b32 s66, 0xfffffe00
s_mov_b32 s67, 0xffffe000
v_cndmask_b32 v18, v18, -1, s[66:67]
s_mov_b32 s64, 0xfffffc00
s_mov_b32 s65, 0xffffc000
v_cndmask_b32 v19, 0, v7, s[64:65]
s_mov_b32 s66, 0xfffff800
s_mov_b32 s67, 0xffff8000
v_cndmask_b32 v19, v19, -1, s[66:67]
s_mov_b32 s64, 0xffff0000
s_mov_b32 s65, 0xfff00000
v_cndmask_b32 v20, 0, v7, s[64:65]
s_mov_b32 s66, 0xfffe0000
s_mov_b32 s67, 0xffe00000
v_cndmask_b32 v20, v20, -1, s[66:67]
s_mov_b32 s64, 0xfffc0000
s_mov_b32 s65, 0xffc00000
v_cndmask_b32 v21, 0, v7, s[64:65]
s_mov_b32 s66, 0xfff80000
s_mov_b32 s67, 0xff800000
v_cndmask_b32 v21, v21, -1, s[66:67]
s_mov_b32 s64, 0xff000000
s_mov_b32 s65, 0xf0000000
v_cndmask_b32 v22, 0, v7, s[64:65]
s_mov_b32 s66, 0xfe000000
s_mov_b32 s67, 0xe0000000
v_cndmask_b32 v22, v22, -1, s[66:67]
s_mov_b32 s64, 0xfc000000
s_mov_b32 s65, 0xc0000000
v_cndmask_b32 v23, 0, v7, s[64:65]
s_mov_b32 s66, 0xf8000000
s_mov_b32 s67, 0x80000000
v_cndmask_b32 v23, v23, -1, s[66:67]
v_add_u32 v6, 161792, v33
ds_write_b128 v6, v[16:19] offset:0
ds_write_b128 v6, v[20:23] offset:1024
v_mov_b32 v68, 0
v_mov_b32 v69, 0
v_mov_b32 v55, 0
s_lshl_b32 s53, s48, 2
s_add_u32 s53, s53, s37
s_mov_b32 s68, 0xffffffff
s_mov_b32 s69, 0xfffffff0
s_mov_b32 s8, 0xfffffffe
s_mov_b32 s9, 0xffffffe0
s_mov_b32 s10, 0xfffffffc
s_mov_b32 s11, 0xffffffc0
s_mov_b32 s12, 0xfffffff8
s_mov_b32 s13, 0xffffff80
s_mov_b32 s14, 0xffffff00
s_mov_b32 s15, 0xfffff000
s_mov_b32 s24, 0xfffffe00
s_mov_b32 s25, 0xffffe000
s_mov_b32 s26, 0xfffffc00
s_mov_b32 s27, 0xffffc000
s_mov_b32 s32, 0xfffff800
s_mov_b32 s33, 0xffff8000
s_mov_b32 s34, 0xffff0000
s_mov_b32 s35, 0xfff00000
s_mov_b32 s60, 0xfffe0000
s_mov_b32 s61, 0xffe00000
s_mov_b32 s62, 0xfffc0000
s_mov_b32 s63, 0xffc00000
s_mov_b32 s0, 0xfff80000
s_mov_b32 s1, 0xff800000
s_mov_b32 s70, 0xff000000
s_mov_b32 s71, 0xf0000000
s_mov_b32 s64, 0xfe000000
s_mov_b32 s65, 0xe0000000
s_mov_b32 s66, 0xfc000000
s_mov_b32 s67, 0xc0000000
s_waitcnt lgkmcnt(0)
s_branch L_att2
L_comp0:
s_lshr_b32 s44, s2, 3
s_and_b32 s45, s44, 7
s_lshl_b32 s39, s2, 1
s_and_b32 s39, s39, 8
s_add_u32 s39, s39, s45
s_lshl_b32 s40, s2, 2
s_and_b32 s40, s40, 12
s_lshr_b32 s46, s2, 6
s_add_u32 s40, s40, s46
s_lshl_b32 s43, s45, 1
s_or_b32 s43, s43, 3
s_sub_u32 s47, s40, 1
s_cmp_gt_u32 s40, s43
s_cselect_b32 s47, s47, s40
s_cmp_eq_u32 s40, s43
s_cselect_b32 s40, 15, s47
s_and_b32 s37, s36, 3
s_lshl_b32 s41, s36, 10
s_lshl_b32 s60, s40, 8
s_mov_b32 s6, 2621440
s_mov_b32 s7, 0x20000
s_mov_b32 s10, 2457600
s_mov_b32 s11, 0x20000
s_cmp_eq_u32 s40, 15
s_cbranch_scc1 L_service
s_and_b32 s43, s2, 3
s_lshl_b32 s53, s43, 2
s_lshr_b32 s43, s39, 2
s_and_b32 s43, s43, 2
s_add_u32 s53, s53, s43
s_and_b32 s43, s39, 1
s_add_u32 s53, s53, s43
s_lshr_b32 s48, s2, 4
s_lshr_b32 s49, s2, 3
s_and_b32 s49, s49, 1
s_and_b32 s43, s2, 7
s_lshl_b32 s43, s43, 1
s_add_u32 s49, s49, s43
s_lshr_b32 s38, s36, 2
s_add_u32 s61, s60, 128
s_cmp_lt_u32 s40, 14
s_cselect_b32 s62, s60, 1073741824
s_cmp_lt_u32 s40, 13
s_cselect_b32 s63, s61, 1073741824
s_mov_b32 s14, 2211840
s_mov_b32 s15, 0x20000
s_mov_b32 s18, 33554432
s_mov_b32 s19, 0x20000
s_mov_b32 s22, 2621440
s_mov_b32 s23, 0x20000
s_mov_b32 s30, 2211840
s_mov_b32 s31, 0x20000
s_mov_b32 s34, 819200
s_mov_b32 s35, 0x20000
s_getpc_b64 s[64:65]
L_pc:
s_lshr_b32 s45, s2, 3
s_lshl_b32 s45, s45, 11
v_lshlrev_b32 v2, 7, v0
v_add_u32 v2, s45, v2
s_sub_u32 s64, s64, L_pc-recurrent_scan__sliding_block__dense_activation_relu__prompt_kernel
s_subb_u32 s65, s65, 0
v_min_u32 v2, L_end-recurrent_scan__sliding_block__dense_activation_relu__prompt_kernel, v2
s_mov_b64 exec, 0xffff
global_load_dword v249, v2, s[64:65]
s_mov_b64 exec, -1
s_setprio 2
v_and_b32 v28, 31, v0
v_lshrrev_b32 v29, 5, v0
s_lshl_b32 s43, s37, 12
s_add_u32 s43, s43, 73728
v_lshl_add_u32 v30, v28, 7, s43
v_bfe_u32 v31, v0, 1, 3
v_xor_b32 v31, v31, v29
v_lshl_add_u32 v64, v31, 4, v30
v_xor_b32 v65, 32, v64
v_xor_b32 v66, 64, v64
v_xor_b32 v67, 96, v64
s_waitcnt lgkmcnt(0)
v_bfe_u32 v30, v0, 4, 1
v_and_b32 v31, 15, v0
v_cmp_eq_u32 s[64:65], v30, v31
v_mov_b32 v68, 0x3f803f80
s_nop 0
v_cndmask_b32 v68, 0, v68, s[64:65]
v_mov_b32 v69, v68
v_mov_b32 v70, v68
v_mov_b32 v71, v68
v_bfe_u32 v30, v0, 2, 2
v_lshlrev_b32 v31, 7, v30
v_lshl_add_u32 v31, v29, 10, v31
v_lshrrev_b32 v30, 1, v30
v_lshl_add_u32 v31, v30, 6, v31
v_bfe_u32 v30, v0, 4, 1
v_lshl_add_u32 v31, v30, 5, v31
v_and_b32 v30, 3, v0
v_lshl_add_u32 v0, v30, 3, v31
v_xor_b32 v1, 64, v0
v_add_u32 v2, 73728, v0
v_add_u32 v3, 73728, v1
s_waitcnt lgkmcnt(0)
s_add_u32 s70, s16, 23265280
s_addc_u32 s71, s17, 0
s_load_dwordx2 s[54:55], s[70:71], 0
s_lshl_b32 s44, s39, 2
s_add_u32 s44, s44, s37
s_lshl_b32 s43, s40, 19
s_lshl_b32 s45, s44, 9
s_add_u32 s43, s43, s45
s_lshl_b32 s45, s40, 11
s_mul_i32 s46, s44, 40960
s_add_u32 s45, s45, s46
s_add_u32 s45, s45, 5222400
s_cmp_ge_u32 s40, 10
s_cselect_b32 s50, s45, s43
s_lshr_b32 s43, s44, 1
s_mul_i32 s43, s43, 148
s_and_b32 s44, s44, 1
s_add_u32 s43, s43, s44
s_lshl_b32 s43, s43, 11
s_add_u32 s43, s43, 8388608
s_lshl_b32 s44, s62, 6
s_cmp_ge_u32 s62, 1073741824
s_cselect_b32 s44, 1073741824, s44
s_add_u32 s51, s43, s44
s_lshl_b32 s44, s63, 6
s_cmp_ge_u32 s63, 1073741824
s_cselect_b32 s44, 1073741824, s44
s_add_u32 s52, s43, s44
s_waitcnt lgkmcnt(0)
s_mul_i32 s54, s54, 0x9e3779b1
s_add_u32 s54, s54, 0x7f4a7c15
s_mul_i32 s55, s55, 0x85ebca6b
s_add_u32 s55, s55, 0xc2b2ae35
s_cmp_ge_u32 s40, 10
s_cbranch_scc1 L_vpath
.p2align 3
s_barrier
ds_read_b128 v[96:99], v64 offset:0
ds_read_b64_tr_b16 v[12:13], v0 offset:0
ds_read_b64_tr_b16 v[14:15], v0 offset:512
ds_read_b64_tr_b16 v[16:17], v1 offset:0
ds_read_b64_tr_b16 v[18:19], v1 offset:512
ds_read_b64_tr_b16 v[20:21], v0 offset:2048
ds_read_b64_tr_b16 v[22:23], v0 offset:2560
ds_read_b64_tr_b16 v[24:25], v1 offset:2048
ds_read_b64_tr_b16 v[26:27], v1 offset:2560
ds_read_b128 v[100:103], v65 offset:0
ds_read_b128 v[104:107], v66 offset:0
ds_read_b128 v[108:111], v67 offset:0
s_waitcnt lgkmcnt(7)
v_mfma_f32_32x32x16_bf16 v[32:47], v[12:15], v[96:99], 0
ds_read_b64_tr_b16 v[28:29], v0 offset:4096
ds_read_b64_tr_b16 v[30:31], v0 offset:4608
v_mfma_f32_4x4x4_16b_bf16 v[76:79], v[96:97], v[96:97], 0
v_mfma_f32_4x4x4_16b_bf16 v[80:83], v[98:99], v[98:99], 0
v_mfma_f32_16x16x32_bf16 v[72:75], v[68:71], v[96:99], 0
v_mfma_f32_32x32x16_bf16 v[48:63], v[16:19], v[96:99], 0
ds_read_b64_tr_b16 v[12:13], v1 offset:4096
ds_read_b64_tr_b16 v[14:15], v1 offset:4608
s_waitcnt lgkmcnt(6)
v_mfma_f32_32x32x16_bf16 v[32:47], v[20:23], v[100:103], v[32:47]
ds_read_b64_tr_b16 v[16:17], v0 offset:6144
ds_read_b64_tr_b16 v[18:19], v0 offset:6656
v_mfma_f32_4x4x4_16b_bf16 v[76:79], v[100:101], v[100:101], v[76:79]
v_mfma_f32_4x4x4_16b_bf16 v[80:83], v[102:103], v[102:103], v[80:83]
v_mfma_f32_16x16x32_bf16 v[72:75], v[68:71], v[100:103], v[72:75]
v_mfma_f32_32x32x16_bf16 v[48:63], v[24:27], v[100:103], v[48:63]
ds_read_b64_tr_b16 v[20:21], v1 offset:6144
ds_read_b64_tr_b16 v[22:23], v1 offset:6656
s_waitcnt lgkmcnt(4)
v_mfma_f32_32x32x16_bf16 v[32:47], v[28:31], v[104:107], v[32:47]
s_barrier
ds_read_b64_tr_b16 v[24:25], v0 offset:8192
ds_read_b64_tr_b16 v[26:27], v0 offset:8704
ds_read_b128 v[112:115], v64 offset:16384
v_mfma_f32_4x4x4_16b_bf16 v[76:79], v[104:105], v[104:105], v[76:79]
v_mfma_f32_4x4x4_16b_bf16 v[80:83], v[106:107], v[106:107], v[80:83]
v_mfma_f32_16x16x32_bf16 v[72:75], v[68:71], v[104:107], v[72:75]
v_mfma_f32_32x32x16_bf16 v[48:63], v[12:15], v[104:107], v[48:63]
ds_read_b64_tr_b16 v[28:29], v1 offset:8192
ds_read_b64_tr_b16 v[30:31], v1 offset:8704
ds_read_b128 v[116:119], v65 offset:16384
s_waitcnt lgkmcnt(6)
v_mfma_f32_32x32x16_bf16 v[32:47], v[16:19], v[108:111], v[32:47]
ds_read_b64_tr_b16 v[12:13], v0 offset:10240
ds_read_b64_tr_b16 v[14:15], v0 offset:10752
ds_read_b128 v[120:123], v66 offset:16384
v_mfma_f32_4x4x4_16b_bf16 v[76:79], v[108:109], v[108:109], v[76:79]
v_mfma_f32_4x4x4_16b_bf16 v[80:83], v[110:111], v[110:111], v[80:83]
v_mfma_f32_16x16x32_bf16 v[72:75], v[68:71], v[108:111], v[72:75]
v_mfma_f32_32x32x16_bf16 v[48:63], v[20:23], v[108:111], v[48:63]
ds_read_b64_tr_b16 v[16:17], v1 offset:10240
ds_read_b64_tr_b16 v[18:19], v1 offset:10752
ds_read_b128 v[124:127], v67 offset:16384
s_waitcnt lgkmcnt(7)
v_mfma_f32_32x32x16_bf16 v[32:47], v[24:27], v[112:115], v[32:47]
ds_read_b64_tr_b16 v[20:21], v0 offset:12288
ds_read_b64_tr_b16 v[22:23], v0 offset:12800
v_mfma_f32_4x4x4_16b_bf16 v[76:79], v[112:113], v[112:113], v[76:79]
v_mfma_f32_4x4x4_16b_bf16 v[80:83], v[114:115], v[114:115], v[80:83]
v_mfma_f32_16x16x32_bf16 v[72:75], v[68:71], v[112:115], v[72:75]
v_mfma_f32_32x32x16_bf16 v[48:63], v[28:31], v[112:115], v[48:63]
ds_read_b64_tr_b16 v[24:25], v1 offset:12288
ds_read_b64_tr_b16 v[26:27], v1 offset:12800
s_waitcnt lgkmcnt(5)
v_mfma_f32_32x32x16_bf16 v[32:47], v[12:15], v[116:119], v[32:47]
ds_read_b64_tr_b16 v[28:29], v0 offset:14336
ds_read_b64_tr_b16 v[30:31], v0 offset:14848
v_mfma_f32_4x4x4_16b_bf16 v[76:79], v[116:117], v[116:117], v[76:79]
v_mfma_f32_4x4x4_16b_bf16 v[80:83], v[118:119], v[118:119], v[80:83]
v_mfma_f32_16x16x32_bf16 v[72:75], v[68:71], v[116:119], v[72:75]
v_mfma_f32_32x32x16_bf16 v[48:63], v[16:19], v[116:119], v[48:63]
ds_read_b64_tr_b16 v[12:13], v1 offset:14336
ds_read_b64_tr_b16 v[14:15], v1 offset:14848
s_waitcnt lgkmcnt(4)
v_mfma_f32_32x32x16_bf16 v[32:47], v[20:23], v[120:123], v[32:47]
s_barrier
ds_read_b64_tr_b16 v[16:17], v0 offset:16384
ds_read_b64_tr_b16 v[18:19], v0 offset:16896
ds_read_b128 v[128:131], v64 offset:32768
v_mfma_f32_4x4x4_16b_bf16 v[76:79], v[120:121], v[120:121], v[76:79]
v_mfma_f32_4x4x4_16b_bf16 v[80:83], v[122:123], v[122:123], v[80:83]
v_mfma_f32_16x16x32_bf16 v[72:75], v[68:71], v[120:123], v[72:75]
v_mfma_f32_32x32x16_bf16 v[48:63], v[24:27], v[120:123], v[48:63]
ds_read_b64_tr_b16 v[20:21], v1 offset:16384
ds_read_b64_tr_b16 v[22:23], v1 offset:16896
ds_read_b128 v[132:135], v65 offset:32768
s_waitcnt lgkmcnt(6)
v_mfma_f32_32x32x16_bf16 v[32:47], v[28:31], v[124:127], v[32:47]
ds_read_b64_tr_b16 v[24:25], v0 offset:18432
ds_read_b64_tr_b16 v[26:27], v0 offset:18944
ds_read_b128 v[136:139], v66 offset:32768
v_mfma_f32_4x4x4_16b_bf16 v[76:79], v[124:125], v[124:125], v[76:79]
v_mfma_f32_4x4x4_16b_bf16 v[80:83], v[126:127], v[126:127], v[80:83]
v_mfma_f32_16x16x32_bf16 v[72:75], v[68:71], v[124:127], v[72:75]
v_mfma_f32_32x32x16_bf16 v[48:63], v[12:15], v[124:127], v[48:63]
ds_read_b64_tr_b16 v[28:29], v1 offset:18432
ds_read_b64_tr_b16 v[30:31], v1 offset:18944
ds_read_b128 v[140:143], v67 offset:32768
s_waitcnt lgkmcnt(7)
v_mfma_f32_32x32x16_bf16 v[32:47], v[16:19], v[128:131], v[32:47]
ds_read_b64_tr_b16 v[12:13], v0 offset:20480
ds_read_b64_tr_b16 v[14:15], v0 offset:20992
v_mfma_f32_4x4x4_16b_bf16 v[76:79], v[128:129], v[128:129], v[76:79]
v_mfma_f32_4x4x4_16b_bf16 v[80:83], v[130:131], v[130:131], v[80:83]
v_mfma_f32_16x16x32_bf16 v[72:75], v[68:71], v[128:131], v[72:75]
v_mfma_f32_32x32x16_bf16 v[48:63], v[20:23], v[128:131], v[48:63]
ds_read_b64_tr_b16 v[16:17], v1 offset:20480
ds_read_b64_tr_b16 v[18:19], v1 offset:20992
s_waitcnt lgkmcnt(5)
v_mfma_f32_32x32x16_bf16 v[32:47], v[24:27], v[132:135], v[32:47]
ds_read_b64_tr_b16 v[20:21], v0 offset:22528
ds_read_b64_tr_b16 v[22:23], v0 offset:23040
v_mfma_f32_4x4x4_16b_bf16 v[76:79], v[132:133], v[132:133], v[76:79]
v_mfma_f32_4x4x4_16b_bf16 v[80:83], v[134:135], v[134:135], v[80:83]
v_mfma_f32_16x16x32_bf16 v[72:75], v[68:71], v[132:135], v[72:75]
v_mfma_f32_32x32x16_bf16 v[48:63], v[28:31], v[132:135], v[48:63]
ds_read_b64_tr_b16 v[24:25], v1 offset:22528
ds_read_b64_tr_b16 v[26:27], v1 offset:23040
s_waitcnt lgkmcnt(4)
v_mfma_f32_32x32x16_bf16 v[32:47], v[12:15], v[136:139], v[32:47]
s_barrier
ds_read_b64_tr_b16 v[28:29], v0 offset:24576
ds_read_b64_tr_b16 v[30:31], v0 offset:25088
ds_read_b128 v[144:147], v64 offset:49152
v_mfma_f32_4x4x4_16b_bf16 v[76:79], v[136:137], v[136:137], v[76:79]
v_mfma_f32_4x4x4_16b_bf16 v[80:83], v[138:139], v[138:139], v[80:83]
v_mfma_f32_16x16x32_bf16 v[72:75], v[68:71], v[136:139], v[72:75]
v_mfma_f32_32x32x16_bf16 v[48:63], v[16:19], v[136:139], v[48:63]
ds_read_b64_tr_b16 v[12:13], v1 offset:24576
ds_read_b64_tr_b16 v[14:15], v1 offset:25088
ds_read_b128 v[148:151], v65 offset:49152
s_waitcnt lgkmcnt(6)
v_mfma_f32_32x32x16_bf16 v[32:47], v[20:23], v[140:143], v[32:47]
ds_read_b64_tr_b16 v[16:17], v0 offset:26624
ds_read_b64_tr_b16 v[18:19], v0 offset:27136
ds_read_b128 v[152:155], v66 offset:49152
v_mfma_f32_4x4x4_16b_bf16 v[76:79], v[140:141], v[140:141], v[76:79]
v_mfma_f32_4x4x4_16b_bf16 v[80:83], v[142:143], v[142:143], v[80:83]
v_mfma_f32_16x16x32_bf16 v[72:75], v[68:71], v[140:143], v[72:75]
v_mfma_f32_32x32x16_bf16 v[48:63], v[24:27], v[140:143], v[48:63]
ds_read_b64_tr_b16 v[20:21], v1 offset:26624
ds_read_b64_tr_b16 v[22:23], v1 offset:27136
ds_read_b128 v[156:159], v67 offset:49152
s_waitcnt lgkmcnt(7)
v_mfma_f32_32x32x16_bf16 v[32:47], v[28:31], v[144:147], v[32:47]
ds_read_b64_tr_b16 v[24:25], v0 offset:28672
ds_read_b64_tr_b16 v[26:27], v0 offset:29184
v_mfma_f32_4x4x4_16b_bf16 v[76:79], v[144:145], v[144:145], v[76:79]
v_mfma_f32_4x4x4_16b_bf16 v[80:83], v[146:147], v[146:147], v[80:83]
v_mfma_f32_16x16x32_bf16 v[72:75], v[68:71], v[144:147], v[72:75]
v_mfma_f32_32x32x16_bf16 v[48:63], v[12:15], v[144:147], v[48:63]
ds_read_b64_tr_b16 v[28:29], v1 offset:28672
ds_read_b64_tr_b16 v[30:31], v1 offset:29184
s_waitcnt lgkmcnt(5)
v_mfma_f32_32x32x16_bf16 v[32:47], v[16:19], v[148:151], v[32:47]
ds_read_b64_tr_b16 v[12:13], v0 offset:30720
ds_read_b64_tr_b16 v[14:15], v0 offset:31232
v_mfma_f32_4x4x4_16b_bf16 v[76:79], v[148:149], v[148:149], v[76:79]
v_mfma_f32_4x4x4_16b_bf16 v[80:83], v[150:151], v[150:151], v[80:83]
v_mfma_f32_16x16x32_bf16 v[72:75], v[68:71], v[148:151], v[72:75]
v_mfma_f32_32x32x16_bf16 v[48:63], v[20:23], v[148:151], v[48:63]
ds_read_b64_tr_b16 v[16:17], v1 offset:30720
ds_read_b64_tr_b16 v[18:19], v1 offset:31232
s_waitcnt lgkmcnt(4)
v_mfma_f32_32x32x16_bf16 v[32:47], v[24:27], v[152:155], v[32:47]
s_barrier
ds_read_b64_tr_b16 v[20:21], v0 offset:32768
ds_read_b64_tr_b16 v[22:23], v0 offset:33280
ds_read_b128 v[160:163], v64 offset:0
v_mfma_f32_4x4x4_16b_bf16 v[76:79], v[152:153], v[152:153], v[76:79]
v_mfma_f32_4x4x4_16b_bf16 v[80:83], v[154:155], v[154:155], v[80:83]
v_mfma_f32_16x16x32_bf16 v[72:75], v[68:71], v[152:155], v[72:75]
v_mfma_f32_32x32x16_bf16 v[48:63], v[28:31], v[152:155], v[48:63]
ds_read_b64_tr_b16 v[24:25], v1 offset:32768
ds_read_b64_tr_b16 v[26:27], v1 offset:33280
ds_read_b128 v[164:167], v65 offset:0
s_waitcnt lgkmcnt(6)
v_mfma_f32_32x32x16_bf16 v[32:47], v[12:15], v[156:159], v[32:47]
ds_read_b64_tr_b16 v[28:29], v0 offset:34816
ds_read_b64_tr_b16 v[30:31], v0 offset:35328
ds_read_b128 v[168:171], v66 offset:0
v_mfma_f32_4x4x4_16b_bf16 v[76:79], v[156:157], v[156:157], v[76:79]
v_mfma_f32_4x4x4_16b_bf16 v[80:83], v[158:159], v[158:159], v[80:83]
v_mfma_f32_16x16x32_bf16 v[72:75], v[68:71], v[156:159], v[72:75]
v_mfma_f32_32x32x16_bf16 v[48:63], v[16:19], v[156:159], v[48:63]
ds_read_b64_tr_b16 v[12:13], v1 offset:34816
ds_read_b64_tr_b16 v[14:15], v1 offset:35328
ds_read_b128 v[172:175], v67 offset:0
s_waitcnt lgkmcnt(7)
v_mfma_f32_32x32x16_bf16 v[32:47], v[20:23], v[160:163], v[32:47]
ds_read_b64_tr_b16 v[16:17], v0 offset:36864
ds_read_b64_tr_b16 v[18:19], v0 offset:37376
v_mfma_f32_4x4x4_16b_bf16 v[76:79], v[160:161], v[160:161], v[76:79]
v_mfma_f32_4x4x4_16b_bf16 v[80:83], v[162:163], v[162:163], v[80:83]
v_mfma_f32_16x16x32_bf16 v[72:75], v[68:71], v[160:163], v[72:75]
v_mfma_f32_32x32x16_bf16 v[48:63], v[24:27], v[160:163], v[48:63]
ds_read_b64_tr_b16 v[20:21], v1 offset:36864
ds_read_b64_tr_b16 v[22:23], v1 offset:37376
s_waitcnt lgkmcnt(5)
v_mfma_f32_32x32x16_bf16 v[32:47], v[28:31], v[164:167], v[32:47]
ds_read_b64_tr_b16 v[24:25], v0 offset:38912
ds_read_b64_tr_b16 v[26:27], v0 offset:39424
v_mfma_f32_4x4x4_16b_bf16 v[76:79], v[164:165], v[164:165], v[76:79]
v_mfma_f32_4x4x4_16b_bf16 v[80:83], v[166:167], v[166:167], v[80:83]
v_mfma_f32_16x16x32_bf16 v[72:75], v[68:71], v[164:167], v[72:75]
v_mfma_f32_32x32x16_bf16 v[48:63], v[12:15], v[164:167], v[48:63]
ds_read_b64_tr_b16 v[28:29], v1 offset:38912
ds_read_b64_tr_b16 v[30:31], v1 offset:39424
s_waitcnt lgkmcnt(4)
v_mfma_f32_32x32x16_bf16 v[32:47], v[16:19], v[168:171], v[32:47]
s_barrier
ds_read_b64_tr_b16 v[12:13], v0 offset:40960
ds_read_b64_tr_b16 v[14:15], v0 offset:41472
ds_read_b128 v[176:179], v64 offset:16384
v_mfma_f32_4x4x4_16b_bf16 v[76:79], v[168:169], v[168:169], v[76:79]
v_mfma_f32_4x4x4_16b_bf16 v[80:83], v[170:171], v[170:171], v[80:83]
v_mfma_f32_16x16x32_bf16 v[72:75], v[68:71], v[168:171], v[72:75]
v_mfma_f32_32x32x16_bf16 v[48:63], v[20:23], v[168:171], v[48:63]
ds_read_b64_tr_b16 v[16:17], v1 offset:40960
ds_read_b64_tr_b16 v[18:19], v1 offset:41472
ds_read_b128 v[180:183], v65 offset:16384
s_waitcnt lgkmcnt(6)
v_mfma_f32_32x32x16_bf16 v[32:47], v[24:27], v[172:175], v[32:47]
ds_read_b64_tr_b16 v[20:21], v0 offset:43008
ds_read_b64_tr_b16 v[22:23], v0 offset:43520
ds_read_b128 v[184:187], v66 offset:16384
v_mfma_f32_4x4x4_16b_bf16 v[76:79], v[172:173], v[172:173], v[76:79]
v_mfma_f32_4x4x4_16b_bf16 v[80:83], v[174:175], v[174:175], v[80:83]
v_mfma_f32_16x16x32_bf16 v[72:75], v[68:71], v[172:175], v[72:75]
v_mfma_f32_32x32x16_bf16 v[48:63], v[28:31], v[172:175], v[48:63]
ds_read_b64_tr_b16 v[24:25], v1 offset:43008
ds_read_b64_tr_b16 v[26:27], v1 offset:43520
ds_read_b128 v[188:191], v67 offset:16384
s_waitcnt lgkmcnt(7)
v_mfma_f32_32x32x16_bf16 v[32:47], v[12:15], v[176:179], v[32:47]
ds_read_b64_tr_b16 v[28:29], v0 offset:45056
ds_read_b64_tr_b16 v[30:31], v0 offset:45568
v_mfma_f32_4x4x4_16b_bf16 v[76:79], v[176:177], v[176:177], v[76:79]
v_mfma_f32_4x4x4_16b_bf16 v[80:83], v[178:179], v[178:179], v[80:83]
v_mfma_f32_16x16x32_bf16 v[72:75], v[68:71], v[176:179], v[72:75]
v_mfma_f32_32x32x16_bf16 v[48:63], v[16:19], v[176:179], v[48:63]
ds_read_b64_tr_b16 v[12:13], v1 offset:45056
ds_read_b64_tr_b16 v[14:15], v1 offset:45568
s_waitcnt lgkmcnt(5)
v_mfma_f32_32x32x16_bf16 v[32:47], v[20:23], v[180:183], v[32:47]
ds_read_b64_tr_b16 v[16:17], v0 offset:47104
ds_read_b64_tr_b16 v[18:19], v0 offset:47616
v_mfma_f32_4x4x4_16b_bf16 v[76:79], v[180:181], v[180:181], v[76:79]
v_mfma_f32_4x4x4_16b_bf16 v[80:83], v[182:183], v[182:183], v[80:83]
v_mfma_f32_16x16x32_bf16 v[72:75], v[68:71], v[180:183], v[72:75]
v_mfma_f32_32x32x16_bf16 v[48:63], v[24:27], v[180:183], v[48:63]
ds_read_b64_tr_b16 v[20:21], v1 offset:47104
ds_read_b64_tr_b16 v[22:23], v1 offset:47616
s_waitcnt lgkmcnt(4)
v_mfma_f32_32x32x16_bf16 v[32:47], v[28:31], v[184:187], v[32:47]
s_barrier
ds_read_b64_tr_b16 v[24:25], v0 offset:49152
ds_read_b64_tr_b16 v[26:27], v0 offset:49664
ds_read_b128 v[192:195], v64 offset:32768
v_mfma_f32_4x4x4_16b_bf16 v[76:79], v[184:185], v[184:185], v[76:79]
v_mfma_f32_4x4x4_16b_bf16 v[80:83], v[186:187], v[186:187], v[80:83]
v_mfma_f32_16x16x32_bf16 v[72:75], v[68:71], v[184:187], v[72:75]
v_mfma_f32_32x32x16_bf16 v[48:63], v[12:15], v[184:187], v[48:63]
ds_read_b64_tr_b16 v[28:29], v1 offset:49152
ds_read_b64_tr_b16 v[30:31], v1 offset:49664
ds_read_b128 v[196:199], v65 offset:32768
s_waitcnt lgkmcnt(6)
v_mfma_f32_32x32x16_bf16 v[32:47], v[16:19], v[188:191], v[32:47]
ds_read_b64_tr_b16 v[12:13], v0 offset:51200
ds_read_b64_tr_b16 v[14:15], v0 offset:51712
ds_read_b128 v[200:203], v66 offset:32768
v_mfma_f32_4x4x4_16b_bf16 v[76:79], v[188:189], v[188:189], v[76:79]
v_mfma_f32_4x4x4_16b_bf16 v[80:83], v[190:191], v[190:191], v[80:83]
v_mfma_f32_16x16x32_bf16 v[72:75], v[68:71], v[188:191], v[72:75]
v_mfma_f32_32x32x16_bf16 v[48:63], v[20:23], v[188:191], v[48:63]
ds_read_b64_tr_b16 v[16:17], v1 offset:51200
ds_read_b64_tr_b16 v[18:19], v1 offset:51712
ds_read_b128 v[204:207], v67 offset:32768
s_waitcnt lgkmcnt(7)
v_mfma_f32_32x32x16_bf16 v[32:47], v[24:27], v[192:195], v[32:47]
ds_read_b64_tr_b16 v[20:21], v0 offset:53248
ds_read_b64_tr_b16 v[22:23], v0 offset:53760
v_mfma_f32_4x4x4_16b_bf16 v[76:79], v[192:193], v[192:193], v[76:79]
v_mfma_f32_4x4x4_16b_bf16 v[80:83], v[194:195], v[194:195], v[80:83]
v_mfma_f32_16x16x32_bf16 v[72:75], v[68:71], v[192:195], v[72:75]
v_mfma_f32_32x32x16_bf16 v[48:63], v[28:31], v[192:195], v[48:63]
ds_read_b64_tr_b16 v[24:25], v1 offset:53248
ds_read_b64_tr_b16 v[26:27], v1 offset:53760
s_waitcnt lgkmcnt(5)
v_mfma_f32_32x32x16_bf16 v[32:47], v[12:15], v[196:199], v[32:47]
ds_read_b64_tr_b16 v[28:29], v0 offset:55296
ds_read_b64_tr_b16 v[30:31], v0 offset:55808
v_mfma_f32_4x4x4_16b_bf16 v[76:79], v[196:197], v[196:197], v[76:79]
v_mfma_f32_4x4x4_16b_bf16 v[80:83], v[198:199], v[198:199], v[80:83]
v_mfma_f32_16x16x32_bf16 v[72:75], v[68:71], v[196:199], v[72:75]
v_mfma_f32_32x32x16_bf16 v[48:63], v[16:19], v[196:199], v[48:63]
ds_read_b64_tr_b16 v[12:13], v1 offset:55296
ds_read_b64_tr_b16 v[14:15], v1 offset:55808
s_waitcnt lgkmcnt(4)
v_mfma_f32_32x32x16_bf16 v[32:47], v[20:23], v[200:203], v[32:47]
s_barrier
ds_read_b64_tr_b16 v[16:17], v0 offset:57344
ds_read_b64_tr_b16 v[18:19], v0 offset:57856
ds_read_b128 v[208:211], v64 offset:49152
v_mfma_f32_4x4x4_16b_bf16 v[76:79], v[200:201], v[200:201], v[76:79]
v_mfma_f32_4x4x4_16b_bf16 v[80:83], v[202:203], v[202:203], v[80:83]
v_mfma_f32_16x16x32_bf16 v[72:75], v[68:71], v[200:203], v[72:75]
v_mfma_f32_32x32x16_bf16 v[48:63], v[24:27], v[200:203], v[48:63]
ds_read_b64_tr_b16 v[20:21], v1 offset:57344
ds_read_b64_tr_b16 v[22:23], v1 offset:57856
ds_read_b128 v[212:215], v65 offset:49152
s_waitcnt lgkmcnt(6)
v_mfma_f32_32x32x16_bf16 v[32:47], v[28:31], v[204:207], v[32:47]
ds_read_b64_tr_b16 v[24:25], v0 offset:59392
ds_read_b64_tr_b16 v[26:27], v0 offset:59904
ds_read_b128 v[216:219], v66 offset:49152
v_mfma_f32_4x4x4_16b_bf16 v[76:79], v[204:205], v[204:205], v[76:79]
v_mfma_f32_4x4x4_16b_bf16 v[80:83], v[206:207], v[206:207], v[80:83]
v_mfma_f32_16x16x32_bf16 v[72:75], v[68:71], v[204:207], v[72:75]
v_mfma_f32_32x32x16_bf16 v[48:63], v[12:15], v[204:207], v[48:63]
ds_read_b64_tr_b16 v[28:29], v1 offset:59392
ds_read_b64_tr_b16 v[30:31], v1 offset:59904
ds_read_b128 v[220:223], v67 offset:49152
s_waitcnt lgkmcnt(7)
v_mfma_f32_32x32x16_bf16 v[32:47], v[16:19], v[208:211], v[32:47]
ds_read_b64_tr_b16 v[12:13], v0 offset:61440
ds_read_b64_tr_b16 v[14:15], v0 offset:61952
v_mfma_f32_4x4x4_16b_bf16 v[76:79], v[208:209], v[208:209], v[76:79]
v_mfma_f32_4x4x4_16b_bf16 v[80:83], v[210:211], v[210:211], v[80:83]
v_mfma_f32_16x16x32_bf16 v[72:75], v[68:71], v[208:211], v[72:75]
v_mfma_f32_32x32x16_bf16 v[48:63], v[20:23], v[208:211], v[48:63]
ds_read_b64_tr_b16 v[16:17], v1 offset:61440
ds_read_b64_tr_b16 v[18:19], v1 offset:61952
s_waitcnt lgkmcnt(5)
v_mfma_f32_32x32x16_bf16 v[32:47], v[24:27], v[212:215], v[32:47]
ds_read_b64_tr_b16 v[20:21], v0 offset:63488
ds_read_b64_tr_b16 v[22:23], v0 offset:64000
v_mfma_f32_4x4x4_16b_bf16 v[76:79], v[212:213], v[212:213], v[76:79]
v_mfma_f32_4x4x4_16b_bf16 v[80:83], v[214:215], v[214:215], v[80:83]
v_mfma_f32_16x16x32_bf16 v[72:75], v[68:71], v[212:215], v[72:75]
v_mfma_f32_32x32x16_bf16 v[48:63], v[28:31], v[212:215], v[48:63]
ds_read_b64_tr_b16 v[24:25], v1 offset:63488
ds_read_b64_tr_b16 v[26:27], v1 offset:64000
s_waitcnt lgkmcnt(4)
v_mfma_f32_32x32x16_bf16 v[32:47], v[12:15], v[216:219], v[32:47]
s_barrier
ds_read_b64_tr_b16 v[28:29], v0 offset:0
ds_read_b64_tr_b16 v[30:31], v0 offset:512
ds_read_b128 v[224:227], v64 offset:0
v_mfma_f32_4x4x4_16b_bf16 v[76:79], v[216:217], v[216:217], v[76:79]
v_mfma_f32_4x4x4_16b_bf16 v[80:83], v[218:219], v[218:219], v[80:83]
v_mfma_f32_16x16x32_bf16 v[72:75], v[68:71], v[216:219], v[72:75]
v_mfma_f32_32x32x16_bf16 v[48:63], v[16:19], v[216:219], v[48:63]
ds_read_b64_tr_b16 v[12:13], v1 offset:0
ds_read_b64_tr_b16 v[14:15], v1 offset:512
ds_read_b128 v[228:231], v65 offset:0
s_waitcnt lgkmcnt(6)
v_mfma_f32_32x32x16_bf16 v[32:47], v[20:23], v[220:223], v[32:47]
ds_read_b64_tr_b16 v[16:17], v0 offset:2048
ds_read_b64_tr_b16 v[18:19], v0 offset:2560
ds_read_b128 v[232:235], v66 offset:0
v_mfma_f32_4x4x4_16b_bf16 v[76:79], v[220:221], v[220:221], v[76:79]
v_mfma_f32_4x4x4_16b_bf16 v[80:83], v[222:223], v[222:223], v[80:83]
v_mfma_f32_16x16x32_bf16 v[72:75], v[68:71], v[220:223], v[72:75]
v_mfma_f32_32x32x16_bf16 v[48:63], v[24:27], v[220:223], v[48:63]
ds_read_b64_tr_b16 v[20:21], v1 offset:2048
ds_read_b64_tr_b16 v[22:23], v1 offset:2560
ds_read_b128 v[236:239], v67 offset:0
s_waitcnt lgkmcnt(7)
v_mfma_f32_32x32x16_bf16 v[32:47], v[28:31], v[224:227], v[32:47]
ds_read_b64_tr_b16 v[24:25], v0 offset:4096
ds_read_b64_tr_b16 v[26:27], v0 offset:4608
v_mfma_f32_4x4x4_16b_bf16 v[76:79], v[224:225], v[224:225], v[76:79]
v_mfma_f32_4x4x4_16b_bf16 v[80:83], v[226:227], v[226:227], v[80:83]
v_mfma_f32_16x16x32_bf16 v[72:75], v[68:71], v[224:227], v[72:75]
v_mfma_f32_32x32x16_bf16 v[48:63], v[12:15], v[224:227], v[48:63]
ds_read_b64_tr_b16 v[28:29], v1 offset:4096
ds_read_b64_tr_b16 v[30:31], v1 offset:4608
s_waitcnt lgkmcnt(5)
v_mfma_f32_32x32x16_bf16 v[32:47], v[16:19], v[228:231], v[32:47]
ds_read_b64_tr_b16 v[12:13], v0 offset:6144
ds_read_b64_tr_b16 v[14:15], v0 offset:6656
v_mfma_f32_4x4x4_16b_bf16 v[76:79], v[228:229], v[228:229], v[76:79]
v_mfma_f32_4x4x4_16b_bf16 v[80:83], v[230:231], v[230:231], v[80:83]
v_mfma_f32_16x16x32_bf16 v[72:75], v[68:71], v[228:231], v[72:75]
v_mfma_f32_32x32x16_bf16 v[48:63], v[20:23], v[228:231], v[48:63]
ds_read_b64_tr_b16 v[16:17], v1 offset:6144
ds_read_b64_tr_b16 v[18:19], v1 offset:6656
s_waitcnt lgkmcnt(4)
v_mfma_f32_32x32x16_bf16 v[32:47], v[24:27], v[232:235], v[32:47]
s_waitcnt vmcnt(0)
s_barrier
ds_read_b64_tr_b16 v[20:21], v0 offset:8192
ds_read_b64_tr_b16 v[22:23], v0 offset:8704
ds_read_b128 v[240:243], v64 offset:16384
v_mfma_f32_4x4x4_16b_bf16 v[76:79], v[232:233], v[232:233], v[76:79]
v_mfma_f32_4x4x4_16b_bf16 v[80:83], v[234:235], v[234:235], v[80:83]
v_mfma_f32_16x16x32_bf16 v[72:75], v[68:71], v[232:235], v[72:75]
v_mfma_f32_32x32x16_bf16 v[48:63], v[28:31], v[232:235], v[48:63]
ds_read_b64_tr_b16 v[24:25], v1 offset:8192
ds_read_b64_tr_b16 v[26:27], v1 offset:8704
ds_read_b128 v[244:247], v65 offset:16384
s_waitcnt lgkmcnt(6)
v_mfma_f32_32x32x16_bf16 v[32:47], v[12:15], v[236:239], v[32:47]
ds_read_b64_tr_b16 v[28:29], v0 offset:10240
ds_read_b64_tr_b16 v[30:31], v0 offset:10752
ds_read_b128 v[248:251], v66 offset:16384
v_mfma_f32_4x4x4_16b_bf16 v[76:79], v[236:237], v[236:237], v[76:79]
v_mfma_f32_4x4x4_16b_bf16 v[80:83], v[238:239], v[238:239], v[80:83]
v_mfma_f32_16x16x32_bf16 v[72:75], v[68:71], v[236:239], v[72:75]
v_mfma_f32_32x32x16_bf16 v[48:63], v[16:19], v[236:239], v[48:63]
ds_read_b64_tr_b16 v[12:13], v1 offset:10240
ds_read_b64_tr_b16 v[14:15], v1 offset:10752
ds_read_b128 v[252:255], v67 offset:16384
s_waitcnt lgkmcnt(7)
v_mfma_f32_32x32x16_bf16 v[32:47], v[20:23], v[240:243], v[32:47]
ds_read_b64_tr_b16 v[16:17], v0 offset:12288
ds_read_b64_tr_b16 v[18:19], v0 offset:12800
v_mfma_f32_4x4x4_16b_bf16 v[76:79], v[240:241], v[240:241], v[76:79]
v_mfma_f32_4x4x4_16b_bf16 v[80:83], v[242:243], v[242:243], v[80:83]
v_mfma_f32_16x16x32_bf16 v[72:75], v[68:71], v[240:243], v[72:75]
v_mfma_f32_32x32x16_bf16 v[48:63], v[24:27], v[240:243], v[48:63]
ds_read_b64_tr_b16 v[20:21], v1 offset:12288
ds_read_b64_tr_b16 v[22:23], v1 offset:12800
s_waitcnt lgkmcnt(5)
v_mfma_f32_32x32x16_bf16 v[32:47], v[28:31], v[244:247], v[32:47]
ds_read_b64_tr_b16 v[24:25], v0 offset:14336
ds_read_b64_tr_b16 v[26:27], v0 offset:14848
v_mfma_f32_4x4x4_16b_bf16 v[76:79], v[244:245], v[244:245], v[76:79]
v_mfma_f32_4x4x4_16b_bf16 v[80:83], v[246:247], v[246:247], v[80:83]
v_mfma_f32_16x16x32_bf16 v[72:75], v[68:71], v[244:247], v[72:75]
v_mfma_f32_32x32x16_bf16 v[48:63], v[12:15], v[244:247], v[48:63]
ds_read_b64_tr_b16 v[28:29], v1 offset:14336
ds_read_b64_tr_b16 v[30:31], v1 offset:14848
s_waitcnt lgkmcnt(4)
v_mfma_f32_32x32x16_bf16 v[32:47], v[16:19], v[248:251], v[32:47]
s_barrier
ds_read_b64_tr_b16 v[12:13], v0 offset:16384
ds_read_b64_tr_b16 v[14:15], v0 offset:16896
v_mfma_f32_4x4x4_16b_bf16 v[76:79], v[248:249], v[248:249], v[76:79]
v_mfma_f32_4x4x4_16b_bf16 v[80:83], v[250:251], v[250:251], v[80:83]
v_mfma_f32_16x16x32_bf16 v[72:75], v[68:71], v[248:251], v[72:75]
v_mfma_f32_32x32x16_bf16 v[48:63], v[20:23], v[248:251], v[48:63]
ds_read_b64_tr_b16 v[16:17], v1 offset:16384
ds_read_b64_tr_b16 v[18:19], v1 offset:16896
s_waitcnt lgkmcnt(4)
v_mfma_f32_32x32x16_bf16 v[32:47], v[24:27], v[252:255], v[32:47]
ds_read_b64_tr_b16 v[20:21], v0 offset:18432
ds_read_b64_tr_b16 v[22:23], v0 offset:18944
v_mfma_f32_4x4x4_16b_bf16 v[76:79], v[252:253], v[252:253], v[76:79]
v_mfma_f32_4x4x4_16b_bf16 v[80:83], v[254:255], v[254:255], v[80:83]
v_mfma_f32_16x16x32_bf16 v[72:75], v[68:71], v[252:255], v[72:75]
v_mfma_f32_32x32x16_bf16 v[48:63], v[28:31], v[252:255], v[48:63]
ds_read_b64_tr_b16 v[24:25], v1 offset:18432
ds_read_b64_tr_b16 v[26:27], v1 offset:18944
s_nop 0
v_add_f32 v8, v76, v80
v_add_f32 v9, v77, v81
v_add_f32 v10, v78, v82
v_add_f32 v11, v79, v83
v_permlane16_swap_b32 v72, v73
v_mov_b32 v4, v72
v_mov_b32 v6, v72
s_waitcnt lgkmcnt(4)
v_mfma_f32_32x32x16_bf16 v[64:79], v[12:15], v[96:99], 0
ds_read_b64_tr_b16 v[28:29], v0 offset:20480
ds_read_b64_tr_b16 v[30:31], v0 offset:20992
s_mov_b32 s66, 0x22222222
s_mov_b32 s67, 0x22222222
v_cndmask_b32 v8, v8, v9, s[66:67]
s_mov_b32 s66, 0x44444444
s_mov_b32 s67, 0x44444444
v_cndmask_b32 v8, v8, v10, s[66:67]
s_mov_b32 s66, 0x88888888
s_mov_b32 s67, 0x88888888
v_cndmask_b32 v8, v8, v11, s[66:67]
v_mfma_f32_32x32x16_bf16 v[80:95], v[16:19], v[96:99], 0
ds_read_b64_tr_b16 v[12:13], v1 offset:20480
ds_read_b64_tr_b16 v[14:15], v1 offset:20992
v_permlane32_swap_b32 v6, v4
v_mov_b32 v9, v8
v_mul_f32 v6, 0x3acccccd, v6
s_waitcnt lgkmcnt(4)
v_mfma_f32_32x32x16_bf16 v[64:79], v[20:23], v[100:103], v[64:79]
ds_read_b64_tr_b16 v[16:17], v0 offset:22528
ds_read_b64_tr_b16 v[18:19], v0 offset:23040
v_permlane32_swap_b32 v9, v8
v_add_f32 v8, v8, v9
v_mul_f32 v8, 0x3acccccd, v8
v_mfma_f32_32x32x16_bf16 v[80:95], v[24:27], v[100:103], v[80:95]
ds_read_b64_tr_b16 v[20:21], v1 offset:22528
ds_read_b64_tr_b16 v[22:23], v1 offset:23040
v_fma_f32 v8, -v6, v6, v8
v_max_f32 v8, 0, v8
v_sub_f32 v6, 0, v6
s_waitcnt lgkmcnt(4)
v_mfma_f32_32x32x16_bf16 v[64:79], v[28:31], v[104:107], v[64:79]
ds_read_b64_tr_b16 v[24:25], v0 offset:24576
ds_read_b64_tr_b16 v[26:27], v0 offset:25088
v_cvt_pk_bf16_f32 v8, v8, v8
v_and_b32 v8, 0xffff0000, v8
v_add_f32 v8, 0x3727c5ac, v8
v_mfma_f32_32x32x16_bf16 v[80:95], v[12:15], v[104:107], v[80:95]
ds_read_b64_tr_b16 v[28:29], v1 offset:24576
ds_read_b64_tr_b16 v[30:31], v1 offset:25088
v_cvt_pk_bf16_f32 v4, v6, v6
v_cvt_pk_bf16_f32 v8, v8, v8
v_and_b32 v8, 0xffff0000, v8
s_waitcnt lgkmcnt(4)
v_mfma_f32_32x32x16_bf16 v[64:79], v[16:19], v[108:111], v[64:79]
ds_read_b64_tr_b16 v[12:13], v0 offset:26624
ds_read_b64_tr_b16 v[14:15], v0 offset:27136
v_sqrt_f32 v8, v8
v_mov_b32 v5, 0
v_cvt_pk_bf16_f32 v8, v8, v8
v_mfma_f32_32x32x16_bf16 v[80:95], v[20:23], v[108:111], v[80:95]
ds_read_b64_tr_b16 v[16:17], v1 offset:26624
ds_read_b64_tr_b16 v[18:19], v1 offset:27136
v_and_b32 v8, 0xffff0000, v8
v_rcp_f32 v7, v8
s_cmp_lt_u32 s40, 5
s_cselect_b32 s43, 0x3ea52b5c, 1.0
v_mul_f32 v6, s43, v7
s_waitcnt lgkmcnt(4)
v_mfma_f32_32x32x16_bf16 v[64:79], v[24:27], v[112:115], v[64:79]
ds_read_b64_tr_b16 v[20:21], v0 offset:28672
ds_read_b64_tr_b16 v[22:23], v0 offset:29184
v_mfma_f32_32x32x16_bf16 v[80:95], v[28:31], v[112:115], v[80:95]
ds_read_b64_tr_b16 v[24:25], v1 offset:28672
ds_read_b64_tr_b16 v[26:27], v1 offset:29184
s_waitcnt lgkmcnt(4)
v_mfma_f32_32x32x16_bf16 v[64:79], v[12:15], v[116:119], v[64:79]
ds_read_b64_tr_b16 v[28:29], v0 offset:30720
ds_read_b64_tr_b16 v[30:31], v0 offset:31232
v_mbcnt_lo_u32_b32 v8, -1, 0
v_mbcnt_hi_u32_b32 v8, -1, v8
v_lshlrev_b32 v9, 3, v8
v_cmp_gt_u32 s[64:65], 32, v8
v_mov_b32 v8, 142336
v_mfma_f32_32x32x16_bf16 v[80:95], v[16:19], v[116:119], v[80:95]
ds_read_b64_tr_b16 v[12:13], v1 offset:30720
ds_read_b64_tr_b16 v[14:15], v1 offset:31232
v_add_u32 v9, 141312, v9
v_cndmask_b32 v8, v8, v9, s[64:65]
s_waitcnt lgkmcnt(4)
v_mfma_f32_32x32x16_bf16 v[64:79], v[20:23], v[120:123], v[64:79]
s_barrier
ds_read_b64_tr_b16 v[16:17], v0 offset:32768
ds_read_b64_tr_b16 v[18:19], v0 offset:33280
ds_read_b64 v[10:11], v8 offset:256
ds_read_b64 v[8:9], v8 offset:0
v_mfma_f32_32x32x16_bf16 v[80:95], v[24:27], v[120:123], v[80:95]
ds_read_b64_tr_b16 v[20:21], v1 offset:32768
ds_read_b64_tr_b16 v[22:23], v1 offset:33280
s_waitcnt lgkmcnt(6)
v_mfma_f32_32x32x16_bf16 v[64:79], v[28:31], v[124:127], v[64:79]
ds_read_b64_tr_b16 v[24:25], v0 offset:34816
ds_read_b64_tr_b16 v[26:27], v0 offset:35328
s_waitcnt lgkmcnt(4)
v_mfma_f32_32x32x8_bf16 v[32:47], v[8:9], v[4:5], v[32:47]
v_mfma_f32_32x32x8_bf16 v[48:63], v[10:11], v[4:5], v[48:63]
v_mfma_f32_32x32x16_bf16 v[80:95], v[12:15], v[124:127], v[80:95]
ds_read_b64_tr_b16 v[28:29], v1 offset:34816
ds_read_b64_tr_b16 v[30:31], v1 offset:35328
s_waitcnt lgkmcnt(4)
v_mfma_f32_32x32x16_bf16 v[64:79], v[16:19], v[128:131], v[64:79]
ds_read_b64_tr_b16 v[12:13], v0 offset:36864
ds_read_b64_tr_b16 v[14:15], v0 offset:37376
v_mfma_f32_32x32x16_bf16 v[80:95], v[20:23], v[128:131], v[80:95]
ds_read_b64_tr_b16 v[16:17], v1 offset:36864
ds_read_b64_tr_b16 v[18:19], v1 offset:37376
s_waitcnt lgkmcnt(4)
v_mfma_f32_32x32x16_bf16 v[64:79], v[24:27], v[132:135], v[64:79]
ds_read_b64_tr_b16 v[20:21], v0 offset:38912
ds_read_b64_tr_b16 v[22:23], v0 offset:39424
v_mbcnt_lo_u32_b32 v8, -1, 0
v_mbcnt_hi_u32_b32 v8, -1, v8
v_lshrrev_b32 v9, 5, v8
v_lshlrev_b32 v8, 4, v8
v_mfma_f32_32x32x16_bf16 v[80:95], v[28:31], v[132:135], v[80:95]
ds_read_b64_tr_b16 v[24:25], v1 offset:38912
ds_read_b64_tr_b16 v[26:27], v1 offset:39424
v_mul_u32_u24 v9, 32256, v9
v_add_u32 v8, v8, v9
v_mul_f32 v32, v32, v6
s_waitcnt lgkmcnt(4)
v_mfma_f32_32x32x16_bf16 v[64:79], v[12:15], v[136:139], v[64:79]
ds_read_b64_tr_b16 v[28:29], v0 offset:40960
ds_read_b64_tr_b16 v[30:31], v0 offset:41472
v_mul_f32 v33, v33, v6
v_cvt_pk_bf16_f32 v32, v32, v33
v_mul_f32 v34, v34, v6
v_mfma_f32_32x32x16_bf16 v[80:95], v[16:19], v[136:139], v[80:95]
ds_read_b64_tr_b16 v[12:13], v1 offset:40960
ds_read_b64_tr_b16 v[14:15], v1 offset:41472
v_mul_f32 v35, v35, v6
v_cvt_pk_bf16_f32 v33, v34, v35
v_mul_f32 v36, v36, v6
s_waitcnt lgkmcnt(4)
v_mfma_f32_32x32x16_bf16 v[64:79], v[20:23], v[140:143], v[64:79]
ds_read_b64_tr_b16 v[16:17], v0 offset:43008
ds_read_b64_tr_b16 v[18:19], v0 offset:43520
v_mul_f32 v37, v37, v6
v_cvt_pk_bf16_f32 v34, v36, v37
v_mul_f32 v38, v38, v6
v_mfma_f32_32x32x16_bf16 v[80:95], v[24:27], v[140:143], v[80:95]
ds_read_b64_tr_b16 v[20:21], v1 offset:43008
ds_read_b64_tr_b16 v[22:23], v1 offset:43520
v_mul_f32 v39, v39, v6
v_cvt_pk_bf16_f32 v35, v38, v39
v_mul_f32 v40, v40, v6
s_waitcnt lgkmcnt(4)
v_mfma_f32_32x32x16_bf16 v[64:79], v[28:31], v[144:147], v[64:79]
ds_read_b64_tr_b16 v[24:25], v0 offset:45056
ds_read_b64_tr_b16 v[26:27], v0 offset:45568
v_mul_f32 v41, v41, v6
v_cvt_pk_bf16_f32 v36, v40, v41
v_mul_f32 v42, v42, v6
v_mfma_f32_32x32x16_bf16 v[80:95], v[12:15], v[144:147], v[80:95]
ds_read_b64_tr_b16 v[28:29], v1 offset:45056
ds_read_b64_tr_b16 v[30:31], v1 offset:45568
v_mul_f32 v43, v43, v6
v_cvt_pk_bf16_f32 v37, v42, v43
v_mul_f32 v44, v44, v6
s_waitcnt lgkmcnt(4)
v_mfma_f32_32x32x16_bf16 v[64:79], v[16:19], v[148:151], v[64:79]
ds_read_b64_tr_b16 v[12:13], v0 offset:47104
ds_read_b64_tr_b16 v[14:15], v0 offset:47616
v_mul_f32 v45, v45, v6
v_cvt_pk_bf16_f32 v38, v44, v45
v_mul_f32 v46, v46, v6
v_mfma_f32_32x32x16_bf16 v[80:95], v[20:23], v[148:151], v[80:95]
ds_read_b64_tr_b16 v[16:17], v1 offset:47104
ds_read_b64_tr_b16 v[18:19], v1 offset:47616
v_mul_f32 v47, v47, v6
v_cvt_pk_bf16_f32 v39, v46, v47
v_permlane32_swap_b32 v32, v34
s_waitcnt lgkmcnt(4)
v_mfma_f32_32x32x16_bf16 v[64:79], v[24:27], v[152:155], v[64:79]
s_barrier
ds_read_b64_tr_b16 v[20:21], v0 offset:49152
ds_read_b64_tr_b16 v[22:23], v0 offset:49664
v_permlane32_swap_b32 v33, v35
v_permlane32_swap_b32 v36, v38
v_permlane32_swap_b32 v37, v39
v_mfma_f32_32x32x16_bf16 v[80:95], v[28:31], v[152:155], v[80:95]
ds_read_b64_tr_b16 v[24:25], v1 offset:49152
ds_read_b64_tr_b16 v[26:27], v1 offset:49664
s_add_u32 s43, s50, 0
buffer_store_dwordx4 v[32:35], v8, s[16:19], s43 offen sc1
s_add_u32 s43, s50, 65536
buffer_store_dwordx4 v[36:39], v8, s[16:19], s43 offen sc1
v_mul_f32 v48, v48, v6
v_mul_f32 v49, v49, v6
s_waitcnt lgkmcnt(4)
v_mfma_f32_32x32x16_bf16 v[64:79], v[12:15], v[156:159], v[64:79]
ds_read_b64_tr_b16 v[28:29], v0 offset:51200
ds_read_b64_tr_b16 v[30:31], v0 offset:51712
v_cvt_pk_bf16_f32 v48, v48, v49
v_mul_f32 v50, v50, v6
v_mul_f32 v51, v51, v6
v_mfma_f32_32x32x16_bf16 v[80:95], v[16:19], v[156:159], v[80:95]
ds_read_b64_tr_b16 v[12:13], v1 offset:51200
ds_read_b64_tr_b16 v[14:15], v1 offset:51712
v_cvt_pk_bf16_f32 v49, v50, v51
v_mul_f32 v52, v52, v6
v_mul_f32 v53, v53, v6
s_waitcnt lgkmcnt(4)
v_mfma_f32_32x32x16_bf16 v[64:79], v[20:23], v[160:163], v[64:79]
ds_read_b64_tr_b16 v[16:17], v0 offset:53248
ds_read_b64_tr_b16 v[18:19], v0 offset:53760
v_cvt_pk_bf16_f32 v50, v52, v53
v_mul_f32 v54, v54, v6
v_mul_f32 v55, v55, v6
v_mfma_f32_32x32x16_bf16 v[80:95], v[24:27], v[160:163], v[80:95]
ds_read_b64_tr_b16 v[20:21], v1 offset:53248
ds_read_b64_tr_b16 v[22:23], v1 offset:53760
v_cvt_pk_bf16_f32 v51, v54, v55
v_mul_f32 v56, v56, v6
v_mul_f32 v57, v57, v6
s_waitcnt lgkmcnt(4)
v_mfma_f32_32x32x16_bf16 v[64:79], v[28:31], v[164:167], v[64:79]
ds_read_b64_tr_b16 v[24:25], v0 offset:55296
ds_read_b64_tr_b16 v[26:27], v0 offset:55808
v_cvt_pk_bf16_f32 v52, v56, v57
v_mul_f32 v58, v58, v6
v_mul_f32 v59, v59, v6
v_mfma_f32_32x32x16_bf16 v[80:95], v[12:15], v[164:167], v[80:95]
ds_read_b64_tr_b16 v[28:29], v1 offset:55296
ds_read_b64_tr_b16 v[30:31], v1 offset:55808
v_cvt_pk_bf16_f32 v53, v58, v59
v_mul_f32 v60, v60, v6
v_mul_f32 v61, v61, v6
s_waitcnt lgkmcnt(4)
v_mfma_f32_32x32x16_bf16 v[64:79], v[16:19], v[168:171], v[64:79]
ds_read_b64_tr_b16 v[12:13], v0 offset:57344
ds_read_b64_tr_b16 v[14:15], v0 offset:57856
v_cvt_pk_bf16_f32 v54, v60, v61
v_mul_f32 v62, v62, v6
v_mul_f32 v63, v63, v6
v_mfma_f32_32x32x16_bf16 v[80:95], v[20:23], v[168:171], v[80:95]
ds_read_b64_tr_b16 v[16:17], v1 offset:57344
ds_read_b64_tr_b16 v[18:19], v1 offset:57856
v_cvt_pk_bf16_f32 v55, v62, v63
v_permlane32_swap_b32 v48, v50
v_permlane32_swap_b32 v49, v51
s_waitcnt lgkmcnt(4)
v_mfma_f32_32x32x16_bf16 v[64:79], v[24:27], v[172:175], v[64:79]
ds_read_b64_tr_b16 v[20:21], v0 offset:59392
ds_read_b64_tr_b16 v[22:23], v0 offset:59904
v_permlane32_swap_b32 v52, v54
v_permlane32_swap_b32 v53, v55
s_add_u32 s43, s50, 131072
buffer_store_dwordx4 v[48:51], v8, s[16:19], s43 offen sc1
s_add_u32 s43, s50, 196608
buffer_store_dwordx4 v[52:55], v8, s[16:19], s43 offen sc1
v_mfma_f32_32x32x16_bf16 v[80:95], v[28:31], v[172:175], v[80:95]
ds_read_b64_tr_b16 v[24:25], v1 offset:59392
ds_read_b64_tr_b16 v[26:27], v1 offset:59904
s_waitcnt lgkmcnt(4)
v_mfma_f32_32x32x16_bf16 v[64:79], v[12:15], v[176:179], v[64:79]
ds_read_b64_tr_b16 v[28:29], v0 offset:61440
ds_read_b64_tr_b16 v[30:31], v0 offset:61952
v_mfma_f32_32x32x16_bf16 v[80:95], v[16:19], v[176:179], v[80:95]
ds_read_b64_tr_b16 v[12:13], v1 offset:61440
ds_read_b64_tr_b16 v[14:15], v1 offset:61952
s_waitcnt lgkmcnt(4)
v_mfma_f32_32x32x16_bf16 v[64:79], v[20:23], v[180:183], v[64:79]
ds_read_b64_tr_b16 v[16:17], v0 offset:63488
ds_read_b64_tr_b16 v[18:19], v0 offset:64000
v_mfma_f32_32x32x16_bf16 v[80:95], v[24:27], v[180:183], v[80:95]
ds_read_b64_tr_b16 v[20:21], v1 offset:63488
ds_read_b64_tr_b16 v[22:23], v1 offset:64000
s_waitcnt lgkmcnt(4)
v_mfma_f32_32x32x16_bf16 v[64:79], v[28:31], v[184:187], v[64:79]
s_barrier
ds_read_b64_tr_b16 v[24:25], v2 offset:32768
ds_read_b64_tr_b16 v[26:27], v2 offset:33280
v_mfma_f32_32x32x16_bf16 v[80:95], v[12:15], v[184:187], v[80:95]
ds_read_b64_tr_b16 v[28:29], v3 offset:32768
ds_read_b64_tr_b16 v[30:31], v3 offset:33280
s_waitcnt lgkmcnt(4)
v_mfma_f32_32x32x16_bf16 v[64:79], v[16:19], v[188:191], v[64:79]
ds_read_b64_tr_b16 v[12:13], v2 offset:34816
ds_read_b64_tr_b16 v[14:15], v2 offset:35328
v_mfma_f32_32x32x16_bf16 v[80:95], v[20:23], v[188:191], v[80:95]
ds_read_b64_tr_b16 v[16:17], v3 offset:34816
ds_read_b64_tr_b16 v[18:19], v3 offset:35328
s_waitcnt lgkmcnt(4)
v_mfma_f32_32x32x16_bf16 v[64:79], v[24:27], v[192:195], v[64:79]
ds_read_b64_tr_b16 v[20:21], v2 offset:36864
ds_read_b64_tr_b16 v[22:23], v2 offset:37376
v_mfma_f32_32x32x16_bf16 v[80:95], v[28:31], v[192:195], v[80:95]
ds_read_b64_tr_b16 v[24:25], v3 offset:36864
ds_read_b64_tr_b16 v[26:27], v3 offset:37376
s_waitcnt lgkmcnt(4)
v_mfma_f32_32x32x16_bf16 v[64:79], v[12:15], v[196:199], v[64:79]
ds_read_b64_tr_b16 v[28:29], v2 offset:38912
ds_read_b64_tr_b16 v[30:31], v2 offset:39424
v_mfma_f32_32x32x16_bf16 v[80:95], v[16:19], v[196:199], v[80:95]
ds_read_b64_tr_b16 v[12:13], v3 offset:38912
ds_read_b64_tr_b16 v[14:15], v3 offset:39424
s_waitcnt lgkmcnt(4)
v_mfma_f32_32x32x16_bf16 v[64:79], v[20:23], v[200:203], v[64:79]
ds_read_b64_tr_b16 v[16:17], v2 offset:40960
ds_read_b64_tr_b16 v[18:19], v2 offset:41472
v_mfma_f32_32x32x16_bf16 v[80:95], v[24:27], v[200:203], v[80:95]
ds_read_b64_tr_b16 v[20:21], v3 offset:40960
ds_read_b64_tr_b16 v[22:23], v3 offset:41472
s_waitcnt lgkmcnt(4)
v_mfma_f32_32x32x16_bf16 v[64:79], v[28:31], v[204:207], v[64:79]
ds_read_b64_tr_b16 v[24:25], v2 offset:43008
ds_read_b64_tr_b16 v[26:27], v2 offset:43520
v_mfma_f32_32x32x16_bf16 v[80:95], v[12:15], v[204:207], v[80:95]
ds_read_b64_tr_b16 v[28:29], v3 offset:43008
ds_read_b64_tr_b16 v[30:31], v3 offset:43520
s_waitcnt lgkmcnt(4)
v_mfma_f32_32x32x16_bf16 v[64:79], v[16:19], v[208:211], v[64:79]
ds_read_b64_tr_b16 v[12:13], v2 offset:45056
ds_read_b64_tr_b16 v[14:15], v2 offset:45568
v_mfma_f32_32x32x16_bf16 v[80:95], v[20:23], v[208:211], v[80:95]
ds_read_b64_tr_b16 v[16:17], v3 offset:45056
ds_read_b64_tr_b16 v[18:19], v3 offset:45568
s_waitcnt lgkmcnt(4)
v_mfma_f32_32x32x16_bf16 v[64:79], v[24:27], v[212:215], v[64:79]
ds_read_b64_tr_b16 v[20:21], v2 offset:47104
ds_read_b64_tr_b16 v[22:23], v2 offset:47616
v_mfma_f32_32x32x16_bf16 v[80:95], v[28:31], v[212:215], v[80:95]
ds_read_b64_tr_b16 v[24:25], v3 offset:47104
ds_read_b64_tr_b16 v[26:27], v3 offset:47616
s_waitcnt lgkmcnt(4)
v_mfma_f32_32x32x16_bf16 v[64:79], v[12:15], v[216:219], v[64:79]
s_barrier
ds_read_b64_tr_b16 v[28:29], v2 offset:49152
ds_read_b64_tr_b16 v[30:31], v2 offset:49664
v_mfma_f32_32x32x16_bf16 v[80:95], v[16:19], v[216:219], v[80:95]
ds_read_b64_tr_b16 v[12:13], v3 offset:49152
ds_read_b64_tr_b16 v[14:15], v3 offset:49664
s_waitcnt lgkmcnt(4)
v_mfma_f32_32x32x16_bf16 v[64:79], v[20:23], v[220:223], v[64:79]
ds_read_b64_tr_b16 v[16:17], v2 offset:51200
ds_read_b64_tr_b16 v[18:19], v2 offset:51712
v_mfma_f32_32x32x16_bf16 v[80:95], v[24:27], v[220:223], v[80:95]
ds_read_b64_tr_b16 v[20:21], v3 offset:51200
ds_read_b64_tr_b16 v[22:23], v3 offset:51712
s_waitcnt lgkmcnt(4)
v_mfma_f32_32x32x16_bf16 v[64:79], v[28:31], v[224:227], v[64:79]
ds_read_b64_tr_b16 v[24:25], v2 offset:53248
ds_read_b64_tr_b16 v[26:27], v2 offset:53760
v_mfma_f32_32x32x16_bf16 v[80:95], v[12:15], v[224:227], v[80:95]
ds_read_b64_tr_b16 v[28:29], v3 offset:53248
ds_read_b64_tr_b16 v[30:31], v3 offset:53760
s_waitcnt lgkmcnt(4)
v_mfma_f32_32x32x16_bf16 v[64:79], v[16:19], v[228:231], v[64:79]
ds_read_b64_tr_b16 v[12:13], v2 offset:55296
ds_read_b64_tr_b16 v[14:15], v2 offset:55808
v_mfma_f32_32x32x16_bf16 v[80:95], v[20:23], v[228:231], v[80:95]
ds_read_b64_tr_b16 v[16:17], v3 offset:55296
ds_read_b64_tr_b16 v[18:19], v3 offset:55808
s_waitcnt lgkmcnt(4)
v_mfma_f32_32x32x16_bf16 v[64:79], v[24:27], v[232:235], v[64:79]
ds_read_b64_tr_b16 v[20:21], v2 offset:57344
ds_read_b64_tr_b16 v[22:23], v2 offset:57856
v_mfma_f32_32x32x16_bf16 v[80:95], v[28:31], v[232:235], v[80:95]
ds_read_b64_tr_b16 v[24:25], v3 offset:57344
ds_read_b64_tr_b16 v[26:27], v3 offset:57856
s_waitcnt lgkmcnt(4)
v_mfma_f32_32x32x16_bf16 v[64:79], v[12:15], v[236:239], v[64:79]
ds_read_b64_tr_b16 v[28:29], v2 offset:59392
ds_read_b64_tr_b16 v[30:31], v2 offset:59904
v_mfma_f32_32x32x16_bf16 v[80:95], v[16:19], v[236:239], v[80:95]
ds_read_b64_tr_b16 v[12:13], v3 offset:59392
ds_read_b64_tr_b16 v[14:15], v3 offset:59904
s_waitcnt lgkmcnt(4)
v_mfma_f32_32x32x16_bf16 v[64:79], v[20:23], v[240:243], v[64:79]
ds_read_b64_tr_b16 v[16:17], v2 offset:61440
ds_read_b64_tr_b16 v[18:19], v2 offset:61952
v_mbcnt_lo_u32_b32 v8, -1, 0
v_mbcnt_hi_u32_b32 v8, -1, v8
v_lshlrev_b32 v9, 3, v8
v_cmp_gt_u32 s[64:65], 32, v8
v_mov_b32 v8, 142336
v_mfma_f32_32x32x16_bf16 v[80:95], v[24:27], v[240:243], v[80:95]
ds_read_b64_tr_b16 v[20:21], v3 offset:61440
ds_read_b64_tr_b16 v[22:23], v3 offset:61952
v_add_u32 v9, 141312, v9
v_cndmask_b32 v8, v8, v9, s[64:65]
s_waitcnt lgkmcnt(4)
v_mfma_f32_32x32x16_bf16 v[64:79], v[28:31], v[244:247], v[64:79]
ds_read_b64_tr_b16 v[24:25], v2 offset:63488
ds_read_b64_tr_b16 v[26:27], v2 offset:64000
ds_read_b64 v[10:11], v8 offset:768
ds_read_b64 v[8:9], v8 offset:512
v_mfma_f32_32x32x16_bf16 v[80:95], v[12:15], v[244:247], v[80:95]
ds_read_b64_tr_b16 v[28:29], v3 offset:63488
ds_read_b64_tr_b16 v[30:31], v3 offset:64000
s_waitcnt lgkmcnt(6)
v_mfma_f32_32x32x16_bf16 v[64:79], v[16:19], v[248:251], v[64:79]
s_barrier
ds_read_b64_tr_b16 v[12:13], v2 offset:0
ds_read_b64_tr_b16 v[14:15], v2 offset:512
v_mfma_f32_32x32x16_bf16 v[80:95], v[20:23], v[248:251], v[80:95]
ds_read_b64_tr_b16 v[16:17], v3 offset:0
ds_read_b64_tr_b16 v[18:19], v3 offset:512
s_waitcnt lgkmcnt(4)
v_mfma_f32_32x32x16_bf16 v[64:79], v[24:27], v[252:255], v[64:79]
ds_read_b64_tr_b16 v[20:21], v2 offset:2048
ds_read_b64_tr_b16 v[22:23], v2 offset:2560
v_mfma_f32_32x32x16_bf16 v[80:95], v[28:31], v[252:255], v[80:95]
ds_read_b64_tr_b16 v[24:25], v3 offset:2048
ds_read_b64_tr_b16 v[26:27], v3 offset:2560
v_mfma_f32_32x32x8_bf16 v[64:79], v[8:9], v[4:5], v[64:79]
v_mfma_f32_32x32x8_bf16 v[80:95], v[10:11], v[4:5], v[80:95]
s_waitcnt lgkmcnt(4)
v_mfma_f32_32x32x16_bf16 v[32:47], v[12:15], v[96:99], 0
ds_read_b64_tr_b16 v[28:29], v2 offset:4096
ds_read_b64_tr_b16 v[30:31], v2 offset:4608
v_mfma_f32_32x32x16_bf16 v[48:63], v[16:19], v[96:99], 0
ds_read_b64_tr_b16 v[12:13], v3 offset:4096
ds_read_b64_tr_b16 v[14:15], v3 offset:4608
s_waitcnt lgkmcnt(4)
v_mfma_f32_32x32x16_bf16 v[32:47], v[20:23], v[100:103], v[32:47]
ds_read_b64_tr_b16 v[16:17], v2 offset:6144
ds_read_b64_tr_b16 v[18:19], v2 offset:6656
v_mfma_f32_32x32x16_bf16 v[48:63], v[24:27], v[100:103], v[48:63]
ds_read_b64_tr_b16 v[20:21], v3 offset:6144
ds_read_b64_tr_b16 v[22:23], v3 offset:6656
v_mbcnt_lo_u32_b32 v8, -1, 0
v_mbcnt_hi_u32_b32 v8, -1, v8
v_lshrrev_b32 v9, 5, v8
v_lshlrev_b32 v8, 4, v8
s_waitcnt lgkmcnt(4)
v_mfma_f32_32x32x16_bf16 v[32:47], v[28:31], v[104:107], v[32:47]
ds_read_b64_tr_b16 v[24:25], v2 offset:8192
ds_read_b64_tr_b16 v[26:27], v2 offset:8704
v_mul_u32_u24 v9, 32256, v9
v_add_u32 v8, v8, v9
v_mul_f32 v64, v64, v6
v_mfma_f32_32x32x16_bf16 v[48:63], v[12:15], v[104:107], v[48:63]
ds_read_b64_tr_b16 v[28:29], v3 offset:8192
ds_read_b64_tr_b16 v[30:31], v3 offset:8704
v_mul_f32 v65, v65, v6
v_cvt_pk_bf16_f32 v64, v64, v65
v_mul_f32 v66, v66, v6
s_waitcnt lgkmcnt(4)
v_mfma_f32_32x32x16_bf16 v[32:47], v[16:19], v[108:111], v[32:47]
ds_read_b64_tr_b16 v[12:13], v2 offset:10240
ds_read_b64_tr_b16 v[14:15], v2 offset:10752
v_mul_f32 v67, v67, v6
v_cvt_pk_bf16_f32 v65, v66, v67
v_mul_f32 v68, v68, v6
v_mfma_f32_32x32x16_bf16 v[48:63], v[20:23], v[108:111], v[48:63]
ds_read_b64_tr_b16 v[16:17], v3 offset:10240
ds_read_b64_tr_b16 v[18:19], v3 offset:10752
v_mul_f32 v69, v69, v6
v_cvt_pk_bf16_f32 v66, v68, v69
v_mul_f32 v70, v70, v6
s_waitcnt lgkmcnt(4)
v_mfma_f32_32x32x16_bf16 v[32:47], v[24:27], v[112:115], v[32:47]
ds_read_b64_tr_b16 v[20:21], v2 offset:12288
ds_read_b64_tr_b16 v[22:23], v2 offset:12800
v_mul_f32 v71, v71, v6
v_cvt_pk_bf16_f32 v67, v70, v71
v_mul_f32 v72, v72, v6
v_mfma_f32_32x32x16_bf16 v[48:63], v[28:31], v[112:115], v[48:63]
ds_read_b64_tr_b16 v[24:25], v3 offset:12288
ds_read_b64_tr_b16 v[26:27], v3 offset:12800
v_mul_f32 v73, v73, v6
v_cvt_pk_bf16_f32 v68, v72, v73
v_mul_f32 v74, v74, v6
s_waitcnt lgkmcnt(4)
v_mfma_f32_32x32x16_bf16 v[32:47], v[12:15], v[116:119], v[32:47]
ds_read_b64_tr_b16 v[28:29], v2 offset:14336
ds_read_b64_tr_b16 v[30:31], v2 offset:14848
v_mul_f32 v75, v75, v6
v_cvt_pk_bf16_f32 v69, v74, v75
v_mul_f32 v76, v76, v6
v_mfma_f32_32x32x16_bf16 v[48:63], v[16:19], v[116:119], v[48:63]
ds_read_b64_tr_b16 v[12:13], v3 offset:14336
ds_read_b64_tr_b16 v[14:15], v3 offset:14848
v_mul_f32 v77, v77, v6
v_cvt_pk_bf16_f32 v70, v76, v77
v_mul_f32 v78, v78, v6
s_waitcnt lgkmcnt(4)
v_mfma_f32_32x32x16_bf16 v[32:47], v[20:23], v[120:123], v[32:47]
s_barrier
ds_read_b64_tr_b16 v[16:17], v2 offset:16384
ds_read_b64_tr_b16 v[18:19], v2 offset:16896
v_mul_f32 v79, v79, v6
v_cvt_pk_bf16_f32 v71, v78, v79
v_permlane32_swap_b32 v64, v66
v_mfma_f32_32x32x16_bf16 v[48:63], v[24:27], v[120:123], v[48:63]
ds_read_b64_tr_b16 v[20:21], v3 offset:16384
ds_read_b64_tr_b16 v[22:23], v3 offset:16896
v_permlane32_swap_b32 v65, v67
v_permlane32_swap_b32 v68, v70
v_permlane32_swap_b32 v69, v71
s_waitcnt lgkmcnt(4)
v_mfma_f32_32x32x16_bf16 v[32:47], v[28:31], v[124:127], v[32:47]
ds_read_b64_tr_b16 v[24:25], v2 offset:18432
ds_read_b64_tr_b16 v[26:27], v2 offset:18944
s_add_u32 s43, s50, 262144
buffer_store_dwordx4 v[64:67], v8, s[16:19], s43 offen sc1
s_add_u32 s43, s50, 327680
buffer_store_dwordx4 v[68:71], v8, s[16:19], s43 offen sc1
v_mul_f32 v80, v80, v6
v_mul_f32 v81, v81, v6
v_mfma_f32_32x32x16_bf16 v[48:63], v[12:15], v[124:127], v[48:63]
ds_read_b64_tr_b16 v[28:29], v3 offset:18432
ds_read_b64_tr_b16 v[30:31], v3 offset:18944
v_cvt_pk_bf16_f32 v80, v80, v81
v_mul_f32 v82, v82, v6
v_mul_f32 v83, v83, v6
s_waitcnt lgkmcnt(4)
v_mfma_f32_32x32x16_bf16 v[32:47], v[16:19], v[128:131], v[32:47]
ds_read_b64_tr_b16 v[12:13], v2 offset:20480
ds_read_b64_tr_b16 v[14:15], v2 offset:20992
v_cvt_pk_bf16_f32 v81, v82, v83
v_mul_f32 v84, v84, v6
v_mul_f32 v85, v85, v6
v_mfma_f32_32x32x16_bf16 v[48:63], v[20:23], v[128:131], v[48:63]
ds_read_b64_tr_b16 v[16:17], v3 offset:20480
ds_read_b64_tr_b16 v[18:19], v3 offset:20992
v_cvt_pk_bf16_f32 v82, v84, v85
v_mul_f32 v86, v86, v6
v_mul_f32 v87, v87, v6
s_waitcnt lgkmcnt(4)
v_mfma_f32_32x32x16_bf16 v[32:47], v[24:27], v[132:135], v[32:47]
ds_read_b64_tr_b16 v[20:21], v2 offset:22528
ds_read_b64_tr_b16 v[22:23], v2 offset:23040
v_cvt_pk_bf16_f32 v83, v86, v87
v_mul_f32 v88, v88, v6
v_mul_f32 v89, v89, v6
v_mfma_f32_32x32x16_bf16 v[48:63], v[28:31], v[132:135], v[48:63]
ds_read_b64_tr_b16 v[24:25], v3 offset:22528
ds_read_b64_tr_b16 v[26:27], v3 offset:23040
v_cvt_pk_bf16_f32 v84, v88, v89
v_mul_f32 v90, v90, v6
v_mul_f32 v91, v91, v6
s_waitcnt lgkmcnt(4)
v_mfma_f32_32x32x16_bf16 v[32:47], v[12:15], v[136:139], v[32:47]
ds_read_b64_tr_b16 v[28:29], v2 offset:24576
ds_read_b64_tr_b16 v[30:31], v2 offset:25088
v_cvt_pk_bf16_f32 v85, v90, v91
v_mul_f32 v92, v92, v6
v_mul_f32 v93, v93, v6
v_mfma_f32_32x32x16_bf16 v[48:63], v[16:19], v[136:139], v[48:63]
ds_read_b64_tr_b16 v[12:13], v3 offset:24576
ds_read_b64_tr_b16 v[14:15], v3 offset:25088
v_cvt_pk_bf16_f32 v86, v92, v93
v_mul_f32 v94, v94, v6
v_mul_f32 v95, v95, v6
s_waitcnt lgkmcnt(4)
v_mfma_f32_32x32x16_bf16 v[32:47], v[20:23], v[140:143], v[32:47]
ds_read_b64_tr_b16 v[16:17], v2 offset:26624
ds_read_b64_tr_b16 v[18:19], v2 offset:27136
v_cvt_pk_bf16_f32 v87, v94, v95
v_permlane32_swap_b32 v80, v82
v_permlane32_swap_b32 v81, v83
v_mfma_f32_32x32x16_bf16 v[48:63], v[24:27], v[140:143], v[48:63]
ds_read_b64_tr_b16 v[20:21], v3 offset:26624
ds_read_b64_tr_b16 v[22:23], v3 offset:27136
v_permlane32_swap_b32 v84, v86
v_permlane32_swap_b32 v85, v87
s_add_u32 s43, s50, 393216
buffer_store_dwordx4 v[80:83], v8, s[16:19], s43 offen sc1
s_add_u32 s43, s50, 458752
buffer_store_dwordx4 v[84:87], v8, s[16:19], s43 offen sc1
s_waitcnt lgkmcnt(4)
v_mfma_f32_32x32x16_bf16 v[32:47], v[28:31], v[144:147], v[32:47]
ds_read_b64_tr_b16 v[24:25], v2 offset:28672
ds_read_b64_tr_b16 v[26:27], v2 offset:29184
v_mfma_f32_32x32x16_bf16 v[48:63], v[12:15], v[144:147], v[48:63]
ds_read_b64_tr_b16 v[28:29], v3 offset:28672
ds_read_b64_tr_b16 v[30:31], v3 offset:29184
s_waitcnt lgkmcnt(4)
v_mfma_f32_32x32x16_bf16 v[32:47], v[16:19], v[148:151], v[32:47]
ds_read_b64_tr_b16 v[12:13], v2 offset:30720
ds_read_b64_tr_b16 v[14:15], v2 offset:31232
v_mfma_f32_32x32x16_bf16 v[48:63], v[20:23], v[148:151], v[48:63]
ds_read_b64_tr_b16 v[16:17], v3 offset:30720
ds_read_b64_tr_b16 v[18:19], v3 offset:31232
s_waitcnt lgkmcnt(4)
v_mfma_f32_32x32x16_bf16 v[32:47], v[24:27], v[152:155], v[32:47]
s_barrier
ds_read_b64_tr_b16 v[20:21], v0 offset:0
ds_read_b64_tr_b16 v[22:23], v0 offset:512
v_mfma_f32_32x32x16_bf16 v[48:63], v[28:31], v[152:155], v[48:63]
ds_read_b64_tr_b16 v[24:25], v1 offset:0
ds_read_b64_tr_b16 v[26:27], v1 offset:512
s_waitcnt lgkmcnt(4)
v_mfma_f32_32x32x16_bf16 v[32:47], v[12:15], v[156:159], v[32:47]
ds_read_b64_tr_b16 v[28:29], v0 offset:2048
ds_read_b64_tr_b16 v[30:31], v0 offset:2560
v_mfma_f32_32x32x16_bf16 v[48:63], v[16:19], v[156:159], v[48:63]
ds_read_b64_tr_b16 v[12:13], v1 offset:2048
ds_read_b64_tr_b16 v[14:15], v1 offset:2560
s_waitcnt lgkmcnt(4)
v_mfma_f32_32x32x16_bf16 v[32:47], v[20:23], v[160:163], v[32:47]
ds_read_b64_tr_b16 v[16:17], v0 offset:4096
ds_read_b64_tr_b16 v[18:19], v0 offset:4608
v_mfma_f32_32x32x16_bf16 v[48:63], v[24:27], v[160:163], v[48:63]
ds_read_b64_tr_b16 v[20:21], v1 offset:4096
ds_read_b64_tr_b16 v[22:23], v1 offset:4608
s_waitcnt lgkmcnt(4)
v_mfma_f32_32x32x16_bf16 v[32:47], v[28:31], v[164:167], v[32:47]
ds_read_b64_tr_b16 v[24:25], v0 offset:6144
ds_read_b64_tr_b16 v[26:27], v0 offset:6656
v_mfma_f32_32x32x16_bf16 v[48:63], v[12:15], v[164:167], v[48:63]
ds_read_b64_tr_b16 v[28:29], v1 offset:6144
ds_read_b64_tr_b16 v[30:31], v1 offset:6656
s_waitcnt lgkmcnt(4)
v_mfma_f32_32x32x16_bf16 v[32:47], v[16:19], v[168:171], v[32:47]
ds_read_b64_tr_b16 v[12:13], v0 offset:8192
ds_read_b64_tr_b16 v[14:15], v0 offset:8704
v_mfma_f32_32x32x16_bf16 v[48:63], v[20:23], v[168:171], v[48:63]
ds_read_b64_tr_b16 v[16:17], v1 offset:8192
ds_read_b64_tr_b16 v[18:19], v1 offset:8704
s_waitcnt lgkmcnt(4)
v_mfma_f32_32x32x16_bf16 v[32:47], v[24:27], v[172:175], v[32:47]
ds_read_b64_tr_b16 v[20:21], v0 offset:10240
ds_read_b64_tr_b16 v[22:23], v0 offset:10752
v_mfma_f32_32x32x16_bf16 v[48:63], v[28:31], v[172:175], v[48:63]
ds_read_b64_tr_b16 v[24:25], v1 offset:10240
ds_read_b64_tr_b16 v[26:27], v1 offset:10752
s_waitcnt lgkmcnt(4)
v_mfma_f32_32x32x16_bf16 v[32:47], v[12:15], v[176:179], v[32:47]
ds_read_b64_tr_b16 v[28:29], v0 offset:12288
ds_read_b64_tr_b16 v[30:31], v0 offset:12800
v_mfma_f32_32x32x16_bf16 v[48:63], v[16:19], v[176:179], v[48:63]
ds_read_b64_tr_b16 v[12:13], v1 offset:12288
ds_read_b64_tr_b16 v[14:15], v1 offset:12800
s_waitcnt lgkmcnt(4)
v_mfma_f32_32x32x16_bf16 v[32:47], v[20:23], v[180:183], v[32:47]
ds_read_b64_tr_b16 v[16:17], v0 offset:14336
ds_read_b64_tr_b16 v[18:19], v0 offset:14848
v_mfma_f32_32x32x16_bf16 v[48:63], v[24:27], v[180:183], v[48:63]
ds_read_b64_tr_b16 v[20:21], v1 offset:14336
ds_read_b64_tr_b16 v[22:23], v1 offset:14848
s_waitcnt lgkmcnt(4)
v_mfma_f32_32x32x16_bf16 v[32:47], v[28:31], v[184:187], v[32:47]
s_waitcnt vmcnt(0)
s_barrier
s_cmp_lg_u32 s36, 4
s_cbranch_scc1 Lk_14
s_lshl_b32 s43, s39, 4
s_add_u32 s43, s43, s40
s_lshl_b32 s43, s43, 6
s_add_u32 s43, s43, 23068672
v_mov_b32 v10, s54
v_mov_b32 v11, s55
s_mov_b64 exec, 1
buffer_store_dwordx2 v[10:11], off, s[16:19], s43 sc1
s_mov_b64 exec, -1
Lk_14:
ds_read_b64_tr_b16 v[24:25], v0 offset:16384
ds_read_b64_tr_b16 v[26:27], v0 offset:16896
v_mfma_f32_32x32x16_bf16 v[48:63], v[12:15], v[184:187], v[48:63]
ds_read_b64_tr_b16 v[28:29], v1 offset:16384
ds_read_b64_tr_b16 v[30:31], v1 offset:16896
s_waitcnt lgkmcnt(4)
v_mfma_f32_32x32x16_bf16 v[32:47], v[16:19], v[188:191], v[32:47]
ds_read_b64_tr_b16 v[12:13], v0 offset:18432
ds_read_b64_tr_b16 v[14:15], v0 offset:18944
v_mfma_f32_32x32x16_bf16 v[48:63], v[20:23], v[188:191], v[48:63]
ds_read_b64_tr_b16 v[16:17], v1 offset:18432
ds_read_b64_tr_b16 v[18:19], v1 offset:18944
L_join:
s_waitcnt lgkmcnt(4)
v_mfma_f32_32x32x16_bf16 v[32:47], v[24:27], v[192:195], v[32:47]
ds_read_b64_tr_b16 v[20:21], v0 offset:20480
ds_read_b64_tr_b16 v[22:23], v0 offset:20992
v_mfma_f32_32x32x16_bf16 v[48:63], v[28:31], v[192:195], v[48:63]
ds_read_b64_tr_b16 v[24:25], v1 offset:20480
ds_read_b64_tr_b16 v[26:27], v1 offset:20992
s_waitcnt lgkmcnt(4)
v_mfma_f32_32x32x16_bf16 v[32:47], v[12:15], v[196:199], v[32:47]
ds_read_b64_tr_b16 v[28:29], v0 offset:22528
ds_read_b64_tr_b16 v[30:31], v0 offset:23040
v_mfma_f32_32x32x16_bf16 v[48:63], v[16:19], v[196:199], v[48:63]
ds_read_b64_tr_b16 v[12:13], v1 offset:22528
ds_read_b64_tr_b16 v[14:15], v1 offset:23040
s_waitcnt lgkmcnt(4)
v_mfma_f32_32x32x16_bf16 v[32:47], v[20:23], v[200:203], v[32:47]
ds_read_b64_tr_b16 v[16:17], v0 offset:24576
ds_read_b64_tr_b16 v[18:19], v0 offset:25088
v_mfma_f32_32x32x16_bf16 v[48:63], v[24:27], v[200:203], v[48:63]
ds_read_b64_tr_b16 v[20:21], v1 offset:24576
ds_read_b64_tr_b16 v[22:23], v1 offset:25088
s_waitcnt lgkmcnt(4)
v_mfma_f32_32x32x16_bf16 v[32:47], v[28:31], v[204:207], v[32:47]
ds_read_b64_tr_b16 v[24:25], v0 offset:26624
ds_read_b64_tr_b16 v[26:27], v0 offset:27136
v_mfma_f32_32x32x16_bf16 v[48:63], v[12:15], v[204:207], v[48:63]
ds_read_b64_tr_b16 v[28:29], v1 offset:26624
ds_read_b64_tr_b16 v[30:31], v1 offset:27136
s_waitcnt lgkmcnt(4)
v_mfma_f32_32x32x16_bf16 v[32:47], v[16:19], v[208:211], v[32:47]
ds_read_b64_tr_b16 v[12:13], v0 offset:28672
ds_read_b64_tr_b16 v[14:15], v0 offset:29184
v_mfma_f32_32x32x16_bf16 v[48:63], v[20:23], v[208:211], v[48:63]
ds_read_b64_tr_b16 v[16:17], v1 offset:28672
ds_read_b64_tr_b16 v[18:19], v1 offset:29184
s_waitcnt lgkmcnt(4)
v_mfma_f32_32x32x16_bf16 v[32:47], v[24:27], v[212:215], v[32:47]
ds_read_b64_tr_b16 v[20:21], v0 offset:30720
ds_read_b64_tr_b16 v[22:23], v0 offset:31232
v_mfma_f32_32x32x16_bf16 v[48:63], v[28:31], v[212:215], v[48:63]
ds_read_b64_tr_b16 v[24:25], v1 offset:30720
ds_read_b64_tr_b16 v[26:27], v1 offset:31232
s_waitcnt lgkmcnt(4)
v_mfma_f32_32x32x16_bf16 v[32:47], v[12:15], v[216:219], v[32:47]
s_barrier
ds_read_b64_tr_b16 v[28:29], v0 offset:32768
ds_read_b64_tr_b16 v[30:31], v0 offset:33280
v_mfma_f32_32x32x16_bf16 v[48:63], v[16:19], v[216:219], v[48:63]
ds_read_b64_tr_b16 v[12:13], v1 offset:32768
ds_read_b64_tr_b16 v[14:15], v1 offset:33280
s_waitcnt lgkmcnt(4)
v_mfma_f32_32x32x16_bf16 v[32:47], v[20:23], v[220:223], v[32:47]
ds_read_b64_tr_b16 v[16:17], v0 offset:34816
ds_read_b64_tr_b16 v[18:19], v0 offset:35328
v_mfma_f32_32x32x16_bf16 v[48:63], v[24:27], v[220:223], v[48:63]
ds_read_b64_tr_b16 v[20:21], v1 offset:34816
ds_read_b64_tr_b16 v[22:23], v1 offset:35328
s_waitcnt lgkmcnt(4)
v_mfma_f32_32x32x16_bf16 v[32:47], v[28:31], v[224:227], v[32:47]
ds_read_b64_tr_b16 v[24:25], v0 offset:36864
ds_read_b64_tr_b16 v[26:27], v0 offset:37376
v_mfma_f32_32x32x16_bf16 v[48:63], v[12:15], v[224:227], v[48:63]
ds_read_b64_tr_b16 v[28:29], v1 offset:36864
ds_read_b64_tr_b16 v[30:31], v1 offset:37376
s_waitcnt lgkmcnt(4)
v_mfma_f32_32x32x16_bf16 v[32:47], v[16:19], v[228:231], v[32:47]
ds_read_b64_tr_b16 v[12:13], v0 offset:38912
ds_read_b64_tr_b16 v[14:15], v0 offset:39424
v_mfma_f32_32x32x16_bf16 v[48:63], v[20:23], v[228:231], v[48:63]
ds_read_b64_tr_b16 v[16:17], v1 offset:38912
ds_read_b64_tr_b16 v[18:19], v1 offset:39424
s_waitcnt lgkmcnt(4)
v_mfma_f32_32x32x16_bf16 v[32:47], v[24:27], v[232:235], v[32:47]
ds_read_b64_tr_b16 v[20:21], v0 offset:40960
ds_read_b64_tr_b16 v[22:23], v0 offset:41472
v_mfma_f32_32x32x16_bf16 v[48:63], v[28:31], v[232:235], v[48:63]
ds_read_b64_tr_b16 v[24:25], v1 offset:40960
ds_read_b64_tr_b16 v[26:27], v1 offset:41472
s_waitcnt lgkmcnt(4)
v_mfma_f32_32x32x16_bf16 v[32:47], v[12:15], v[236:239], v[32:47]
ds_read_b64_tr_b16 v[28:29], v0 offset:43008
ds_read_b64_tr_b16 v[30:31], v0 offset:43520
v_mfma_f32_32x32x16_bf16 v[48:63], v[16:19], v[236:239], v[48:63]
ds_read_b64_tr_b16 v[12:13], v1 offset:43008
ds_read_b64_tr_b16 v[14:15], v1 offset:43520
s_waitcnt lgkmcnt(4)
v_mfma_f32_32x32x16_bf16 v[32:47], v[20:23], v[240:243], v[32:47]
ds_read_b64_tr_b16 v[16:17], v0 offset:45056
ds_read_b64_tr_b16 v[18:19], v0 offset:45568
v_mbcnt_lo_u32_b32 v8, -1, 0
v_mbcnt_hi_u32_b32 v8, -1, v8
v_lshlrev_b32 v9, 3, v8
v_cmp_gt_u32 s[64:65], 32, v8
v_mov_b32 v8, 142336
v_mfma_f32_32x32x16_bf16 v[48:63], v[24:27], v[240:243], v[48:63]
ds_read_b64_tr_b16 v[20:21], v1 offset:45056
ds_read_b64_tr_b16 v[22:23], v1 offset:45568
v_add_u32 v9, 141312, v9
v_cndmask_b32 v8, v8, v9, s[64:65]
s_waitcnt lgkmcnt(4)
v_mfma_f32_32x32x16_bf16 v[32:47], v[28:31], v[244:247], v[32:47]
ds_read_b64_tr_b16 v[24:25], v0 offset:47104
ds_read_b64_tr_b16 v[26:27], v0 offset:47616
v_mfma_f32_32x32x16_bf16 v[48:63], v[12:15], v[244:247], v[48:63]
ds_read_b64_tr_b16 v[28:29], v1 offset:47104
ds_read_b64_tr_b16 v[30:31], v1 offset:47616
s_waitcnt lgkmcnt(4)
v_mfma_f32_32x32x16_bf16 v[32:47], v[16:19], v[248:251], v[32:47]
s_barrier
ds_read_b64_tr_b16 v[12:13], v0 offset:49152
ds_read_b64_tr_b16 v[14:15], v0 offset:49664
ds_read_b64 v[10:11], v8 offset:256
ds_read_b64 v[8:9], v8 offset:0
v_mfma_f32_32x32x16_bf16 v[48:63], v[20:23], v[248:251], v[48:63]
ds_read_b64_tr_b16 v[16:17], v1 offset:49152
ds_read_b64_tr_b16 v[18:19], v1 offset:49664
s_waitcnt lgkmcnt(6)
v_mfma_f32_32x32x16_bf16 v[32:47], v[24:27], v[252:255], v[32:47]
ds_read_b64_tr_b16 v[20:21], v0 offset:51200
ds_read_b64_tr_b16 v[22:23], v0 offset:51712
v_mfma_f32_32x32x16_bf16 v[48:63], v[28:31], v[252:255], v[48:63]
ds_read_b64_tr_b16 v[24:25], v1 offset:51200
ds_read_b64_tr_b16 v[26:27], v1 offset:51712
s_waitcnt lgkmcnt(6)
v_mfma_f32_32x32x8_bf16 v[32:47], v[8:9], v[4:5], v[32:47]
v_mfma_f32_32x32x8_bf16 v[48:63], v[10:11], v[4:5], v[48:63]
s_waitcnt lgkmcnt(4)
v_mfma_f32_32x32x16_bf16 v[64:79], v[12:15], v[96:99], 0
ds_read_b64_tr_b16 v[28:29], v0 offset:53248
ds_read_b64_tr_b16 v[30:31], v0 offset:53760
v_mfma_f32_32x32x16_bf16 v[80:95], v[16:19], v[96:99], 0
ds_read_b64_tr_b16 v[12:13], v1 offset:53248
ds_read_b64_tr_b16 v[14:15], v1 offset:53760
s_waitcnt lgkmcnt(4)
v_mfma_f32_32x32x16_bf16 v[64:79], v[20:23], v[100:103], v[64:79]
ds_read_b64_tr_b16 v[16:17], v0 offset:55296
ds_read_b64_tr_b16 v[18:19], v0 offset:55808
v_mfma_f32_32x32x16_bf16 v[80:95], v[24:27], v[100:103], v[80:95]
ds_read_b64_tr_b16 v[20:21], v1 offset:55296
ds_read_b64_tr_b16 v[22:23], v1 offset:55808
v_mbcnt_lo_u32_b32 v8, -1, 0
v_mbcnt_hi_u32_b32 v8, -1, v8
v_bfe_u32 v9, v8, 4, 1
v_and_b32 v10, 15, v8
s_waitcnt lgkmcnt(4)
v_mfma_f32_32x32x16_bf16 v[64:79], v[28:31], v[104:107], v[64:79]
ds_read_b64_tr_b16 v[24:25], v0 offset:57344
ds_read_b64_tr_b16 v[26:27], v0 offset:57856
v_lshrrev_b32 v8, 5, v8
v_lshl_add_u32 v8, v8, 4, v10
v_lshlrev_b32 v9, 10, v9
v_mfma_f32_32x32x16_bf16 v[80:95], v[12:15], v[104:107], v[80:95]
ds_read_b64_tr_b16 v[28:29], v1 offset:57344
ds_read_b64_tr_b16 v[30:31], v1 offset:57856
v_lshl_add_u32 v8, v8, 4, v9
v_mul_f32 v32, v32, v7
v_mul_f32 v33, v33, v7
s_waitcnt lgkmcnt(4)
v_mfma_f32_32x32x16_bf16 v[64:79], v[16:19], v[108:111], v[64:79]
ds_read_b64_tr_b16 v[12:13], v0 offset:59392
ds_read_b64_tr_b16 v[14:15], v0 offset:59904
v_cvt_pk_bf16_f32 v32, v32, v33
v_pk_max_i16 v32, v32, 0
v_mul_f32 v34, v34, v7
v_mfma_f32_32x32x16_bf16 v[80:95], v[20:23], v[108:111], v[80:95]
ds_read_b64_tr_b16 v[16:17], v1 offset:59392
ds_read_b64_tr_b16 v[18:19], v1 offset:59904
v_mul_f32 v35, v35, v7
v_cvt_pk_bf16_f32 v33, v34, v35
v_pk_max_i16 v33, v33, 0
s_waitcnt lgkmcnt(4)
v_mfma_f32_32x32x16_bf16 v[64:79], v[24:27], v[112:115], v[64:79]
ds_read_b64_tr_b16 v[20:21], v0 offset:61440
ds_read_b64_tr_b16 v[22:23], v0 offset:61952
v_mul_f32 v36, v36, v7
v_mul_f32 v37, v37, v7
v_cvt_pk_bf16_f32 v34, v36, v37
v_mfma_f32_32x32x16_bf16 v[80:95], v[28:31], v[112:115], v[80:95]
ds_read_b64_tr_b16 v[24:25], v1 offset:61440
ds_read_b64_tr_b16 v[26:27], v1 offset:61952
v_pk_max_i16 v34, v34, 0
v_mul_f32 v38, v38, v7
v_mul_f32 v39, v39, v7
s_waitcnt lgkmcnt(4)
v_mfma_f32_32x32x16_bf16 v[64:79], v[12:15], v[116:119], v[64:79]
ds_read_b64_tr_b16 v[28:29], v0 offset:63488
ds_read_b64_tr_b16 v[30:31], v0 offset:64000
v_cvt_pk_bf16_f32 v35, v38, v39
v_pk_max_i16 v35, v35, 0
v_mul_f32 v40, v40, v7
v_mfma_f32_32x32x16_bf16 v[80:95], v[16:19], v[116:119], v[80:95]
ds_read_b64_tr_b16 v[12:13], v1 offset:63488
ds_read_b64_tr_b16 v[14:15], v1 offset:64000
v_mul_f32 v41, v41, v7
v_cvt_pk_bf16_f32 v36, v40, v41
v_pk_max_i16 v36, v36, 0
s_waitcnt lgkmcnt(4)
v_mfma_f32_32x32x16_bf16 v[64:79], v[20:23], v[120:123], v[64:79]
ds_read_b64_tr_b16 v[16:17], v2 offset:32768
ds_read_b64_tr_b16 v[18:19], v2 offset:33280
v_mul_f32 v42, v42, v7
v_mul_f32 v43, v43, v7
v_cvt_pk_bf16_f32 v37, v42, v43
v_mfma_f32_32x32x16_bf16 v[80:95], v[24:27], v[120:123], v[80:95]
ds_read_b64_tr_b16 v[20:21], v3 offset:32768
ds_read_b64_tr_b16 v[22:23], v3 offset:33280
v_pk_max_i16 v37, v37, 0
v_mul_f32 v44, v44, v7
v_mul_f32 v45, v45, v7
s_waitcnt lgkmcnt(4)
v_mfma_f32_32x32x16_bf16 v[64:79], v[28:31], v[124:127], v[64:79]
ds_read_b64_tr_b16 v[24:25], v2 offset:34816
ds_read_b64_tr_b16 v[26:27], v2 offset:35328
v_cvt_pk_bf16_f32 v38, v44, v45
v_pk_max_i16 v38, v38, 0
v_mul_f32 v46, v46, v7
v_mfma_f32_32x32x16_bf16 v[80:95], v[12:15], v[124:127], v[80:95]
ds_read_b64_tr_b16 v[28:29], v3 offset:34816
ds_read_b64_tr_b16 v[30:31], v3 offset:35328
v_mul_f32 v47, v47, v7
v_cvt_pk_bf16_f32 v39, v46, v47
v_pk_max_i16 v39, v39, 0
s_waitcnt lgkmcnt(4)
v_mfma_f32_32x32x16_bf16 v[64:79], v[16:19], v[128:131], v[64:79]
ds_read_b64_tr_b16 v[12:13], v2 offset:36864
ds_read_b64_tr_b16 v[14:15], v2 offset:37376
s_add_u32 s43, s51, 0
buffer_store_dwordx4 v[32:35], v8, s[16:19], s43 offen sc1
s_add_u32 s43, s51, 512
buffer_store_dwordx4 v[36:39], v8, s[16:19], s43 offen sc1
v_mul_f32 v48, v48, v7
v_mul_f32 v49, v49, v7
v_mfma_f32_32x32x16_bf16 v[80:95], v[20:23], v[128:131], v[80:95]
ds_read_b64_tr_b16 v[16:17], v3 offset:36864
ds_read_b64_tr_b16 v[18:19], v3 offset:37376
v_cvt_pk_bf16_f32 v48, v48, v49
v_pk_max_i16 v48, v48, 0
v_mul_f32 v50, v50, v7
s_waitcnt lgkmcnt(4)
v_mfma_f32_32x32x16_bf16 v[64:79], v[24:27], v[132:135], v[64:79]
ds_read_b64_tr_b16 v[20:21], v2 offset:38912
ds_read_b64_tr_b16 v[22:23], v2 offset:39424
v_mul_f32 v51, v51, v7
v_cvt_pk_bf16_f32 v49, v50, v51
v_pk_max_i16 v49, v49, 0
v_mfma_f32_32x32x16_bf16 v[80:95], v[28:31], v[132:135], v[80:95]
ds_read_b64_tr_b16 v[24:25], v3 offset:38912
ds_read_b64_tr_b16 v[26:27], v3 offset:39424
v_mul_f32 v52, v52, v7
v_mul_f32 v53, v53, v7
v_cvt_pk_bf16_f32 v50, v52, v53
s_waitcnt lgkmcnt(4)
v_mfma_f32_32x32x16_bf16 v[64:79], v[12:15], v[136:139], v[64:79]
s_barrier
ds_read_b64_tr_b16 v[28:29], v2 offset:40960
ds_read_b64_tr_b16 v[30:31], v2 offset:41472
v_pk_max_i16 v50, v50, 0
v_mul_f32 v54, v54, v7
v_mul_f32 v55, v55, v7
v_mfma_f32_32x32x16_bf16 v[80:95], v[16:19], v[136:139], v[80:95]
ds_read_b64_tr_b16 v[12:13], v3 offset:40960
ds_read_b64_tr_b16 v[14:15], v3 offset:41472
v_cvt_pk_bf16_f32 v51, v54, v55
v_pk_max_i16 v51, v51, 0
v_mul_f32 v56, v56, v7
s_waitcnt lgkmcnt(4)
v_mfma_f32_32x32x16_bf16 v[64:79], v[20:23], v[140:143], v[64:79]
ds_read_b64_tr_b16 v[16:17], v2 offset:43008
ds_read_b64_tr_b16 v[18:19], v2 offset:43520
v_mul_f32 v57, v57, v7
v_cvt_pk_bf16_f32 v52, v56, v57
v_pk_max_i16 v52, v52, 0
v_mfma_f32_32x32x16_bf16 v[80:95], v[24:27], v[140:143], v[80:95]
ds_read_b64_tr_b16 v[20:21], v3 offset:43008
ds_read_b64_tr_b16 v[22:23], v3 offset:43520
v_mul_f32 v58, v58, v7
v_mul_f32 v59, v59, v7
v_cvt_pk_bf16_f32 v53, v58, v59
s_waitcnt lgkmcnt(4)
v_mfma_f32_32x32x16_bf16 v[64:79], v[28:31], v[144:147], v[64:79]
ds_read_b64_tr_b16 v[24:25], v2 offset:45056
ds_read_b64_tr_b16 v[26:27], v2 offset:45568
v_pk_max_i16 v53, v53, 0
v_mul_f32 v60, v60, v7
v_mul_f32 v61, v61, v7
v_mfma_f32_32x32x16_bf16 v[80:95], v[12:15], v[144:147], v[80:95]
ds_read_b64_tr_b16 v[28:29], v3 offset:45056
ds_read_b64_tr_b16 v[30:31], v3 offset:45568
v_cvt_pk_bf16_f32 v54, v60, v61
v_pk_max_i16 v54, v54, 0
v_mul_f32 v62, v62, v7
s_waitcnt lgkmcnt(4)
v_mfma_f32_32x32x16_bf16 v[64:79], v[16:19], v[148:151], v[64:79]
ds_read_b64_tr_b16 v[12:13], v2 offset:47104
ds_read_b64_tr_b16 v[14:15], v2 offset:47616
v_mul_f32 v63, v63, v7
v_cvt_pk_bf16_f32 v55, v62, v63
v_pk_max_i16 v55, v55, 0
v_mfma_f32_32x32x16_bf16 v[80:95], v[20:23], v[148:151], v[80:95]
ds_read_b64_tr_b16 v[16:17], v3 offset:47104
ds_read_b64_tr_b16 v[18:19], v3 offset:47616
s_add_u32 s43, s51, 4096
buffer_store_dwordx4 v[48:51], v8, s[16:19], s43 offen sc1
s_add_u32 s43, s51, 4608
buffer_store_dwordx4 v[52:55], v8, s[16:19], s43 offen sc1
s_waitcnt lgkmcnt(4)
v_mfma_f32_32x32x16_bf16 v[64:79], v[24:27], v[152:155], v[64:79]
ds_read_b64_tr_b16 v[20:21], v2 offset:49152
ds_read_b64_tr_b16 v[22:23], v2 offset:49664
v_mfma_f32_32x32x16_bf16 v[80:95], v[28:31], v[152:155], v[80:95]
ds_read_b64_tr_b16 v[24:25], v3 offset:49152
ds_read_b64_tr_b16 v[26:27], v3 offset:49664
s_waitcnt lgkmcnt(4)
v_mfma_f32_32x32x16_bf16 v[64:79], v[12:15], v[156:159], v[64:79]
ds_read_b64_tr_b16 v[28:29], v2 offset:51200
ds_read_b64_tr_b16 v[30:31], v2 offset:51712
v_mfma_f32_32x32x16_bf16 v[80:95], v[16:19], v[156:159], v[80:95]
ds_read_b64_tr_b16 v[12:13], v3 offset:51200
ds_read_b64_tr_b16 v[14:15], v3 offset:51712
s_waitcnt lgkmcnt(4)
v_mfma_f32_32x32x16_bf16 v[64:79], v[20:23], v[160:163], v[64:79]
ds_read_b64_tr_b16 v[16:17], v2 offset:53248
ds_read_b64_tr_b16 v[18:19], v2 offset:53760
v_mfma_f32_32x32x16_bf16 v[80:95], v[24:27], v[160:163], v[80:95]
ds_read_b64_tr_b16 v[20:21], v3 offset:53248
ds_read_b64_tr_b16 v[22:23], v3 offset:53760
s_waitcnt lgkmcnt(4)
v_mfma_f32_32x32x16_bf16 v[64:79], v[28:31], v[164:167], v[64:79]
ds_read_b64_tr_b16 v[24:25], v2 offset:55296
ds_read_b64_tr_b16 v[26:27], v2 offset:55808
v_mfma_f32_32x32x16_bf16 v[80:95], v[12:15], v[164:167], v[80:95]
ds_read_b64_tr_b16 v[28:29], v3 offset:55296
ds_read_b64_tr_b16 v[30:31], v3 offset:55808
s_waitcnt lgkmcnt(4)
v_mfma_f32_32x32x16_bf16 v[64:79], v[16:19], v[168:171], v[64:79]
ds_read_b64_tr_b16 v[12:13], v2 offset:57344
ds_read_b64_tr_b16 v[14:15], v2 offset:57856
v_mfma_f32_32x32x16_bf16 v[80:95], v[20:23], v[168:171], v[80:95]
ds_read_b64_tr_b16 v[16:17], v3 offset:57344
ds_read_b64_tr_b16 v[18:19], v3 offset:57856
s_waitcnt lgkmcnt(4)
v_mfma_f32_32x32x16_bf16 v[64:79], v[24:27], v[172:175], v[64:79]
ds_read_b64_tr_b16 v[20:21], v2 offset:59392
ds_read_b64_tr_b16 v[22:23], v2 offset:59904
v_mfma_f32_32x32x16_bf16 v[80:95], v[28:31], v[172:175], v[80:95]
ds_read_b64_tr_b16 v[24:25], v3 offset:59392
ds_read_b64_tr_b16 v[26:27], v3 offset:59904
s_waitcnt lgkmcnt(4)
v_mfma_f32_32x32x16_bf16 v[64:79], v[12:15], v[176:179], v[64:79]
ds_read_b64_tr_b16 v[28:29], v2 offset:61440
ds_read_b64_tr_b16 v[30:31], v2 offset:61952
v_mfma_f32_32x32x16_bf16 v[80:95], v[16:19], v[176:179], v[80:95]
ds_read_b64_tr_b16 v[12:13], v3 offset:61440
ds_read_b64_tr_b16 v[14:15], v3 offset:61952
s_waitcnt lgkmcnt(4)
v_mfma_f32_32x32x16_bf16 v[64:79], v[20:23], v[180:183], v[64:79]
ds_read_b64_tr_b16 v[16:17], v2 offset:63488
ds_read_b64_tr_b16 v[18:19], v2 offset:64000
v_mfma_f32_32x32x16_bf16 v[80:95], v[24:27], v[180:183], v[80:95]
ds_read_b64_tr_b16 v[20:21], v3 offset:63488
ds_read_b64_tr_b16 v[22:23], v3 offset:64000
s_waitcnt lgkmcnt(4)
v_mfma_f32_32x32x16_bf16 v[64:79], v[28:31], v[184:187], v[64:79]
ds_read_b64_tr_b16 v[24:25], v2 offset:0
ds_read_b64_tr_b16 v[26:27], v2 offset:512
v_mfma_f32_32x32x16_bf16 v[80:95], v[12:15], v[184:187], v[80:95]
ds_read_b64_tr_b16 v[28:29], v3 offset:0
ds_read_b64_tr_b16 v[30:31], v3 offset:512
s_waitcnt lgkmcnt(4)
v_mfma_f32_32x32x16_bf16 v[64:79], v[16:19], v[188:191], v[64:79]
ds_read_b64_tr_b16 v[12:13], v2 offset:2048
ds_read_b64_tr_b16 v[14:15], v2 offset:2560
v_mfma_f32_32x32x16_bf16 v[80:95], v[20:23], v[188:191], v[80:95]
ds_read_b64_tr_b16 v[16:17], v3 offset:2048
ds_read_b64_tr_b16 v[18:19], v3 offset:2560
s_waitcnt lgkmcnt(4)
v_mfma_f32_32x32x16_bf16 v[64:79], v[24:27], v[192:195], v[64:79]
ds_read_b64_tr_b16 v[20:21], v2 offset:4096
ds_read_b64_tr_b16 v[22:23], v2 offset:4608
v_mfma_f32_32x32x16_bf16 v[80:95], v[28:31], v[192:195], v[80:95]
ds_read_b64_tr_b16 v[24:25], v3 offset:4096
ds_read_b64_tr_b16 v[26:27], v3 offset:4608
s_waitcnt lgkmcnt(4)
v_mfma_f32_32x32x16_bf16 v[64:79], v[12:15], v[196:199], v[64:79]
ds_read_b64_tr_b16 v[28:29], v2 offset:6144
ds_read_b64_tr_b16 v[30:31], v2 offset:6656
v_mfma_f32_32x32x16_bf16 v[80:95], v[16:19], v[196:199], v[80:95]
ds_read_b64_tr_b16 v[12:13], v3 offset:6144
ds_read_b64_tr_b16 v[14:15], v3 offset:6656
s_waitcnt lgkmcnt(4)
v_mfma_f32_32x32x16_bf16 v[64:79], v[20:23], v[200:203], v[64:79]
ds_read_b64_tr_b16 v[16:17], v2 offset:8192
ds_read_b64_tr_b16 v[18:19], v2 offset:8704
v_mfma_f32_32x32x16_bf16 v[80:95], v[24:27], v[200:203], v[80:95]
ds_read_b64_tr_b16 v[20:21], v3 offset:8192
ds_read_b64_tr_b16 v[22:23], v3 offset:8704
s_waitcnt lgkmcnt(4)
v_mfma_f32_32x32x16_bf16 v[64:79], v[28:31], v[204:207], v[64:79]
ds_read_b64_tr_b16 v[24:25], v2 offset:10240
ds_read_b64_tr_b16 v[26:27], v2 offset:10752
v_mfma_f32_32x32x16_bf16 v[80:95], v[12:15], v[204:207], v[80:95]
ds_read_b64_tr_b16 v[28:29], v3 offset:10240
ds_read_b64_tr_b16 v[30:31], v3 offset:10752
s_waitcnt lgkmcnt(4)
v_mfma_f32_32x32x16_bf16 v[64:79], v[16:19], v[208:211], v[64:79]
ds_read_b64_tr_b16 v[12:13], v2 offset:12288
ds_read_b64_tr_b16 v[14:15], v2 offset:12800
v_mfma_f32_32x32x16_bf16 v[80:95], v[20:23], v[208:211], v[80:95]
ds_read_b64_tr_b16 v[16:17], v3 offset:12288
ds_read_b64_tr_b16 v[18:19], v3 offset:12800
s_waitcnt lgkmcnt(4)
v_mfma_f32_32x32x16_bf16 v[64:79], v[24:27], v[212:215], v[64:79]
ds_read_b64_tr_b16 v[20:21], v2 offset:14336
ds_read_b64_tr_b16 v[22:23], v2 offset:14848
v_mfma_f32_32x32x16_bf16 v[80:95], v[28:31], v[212:215], v[80:95]
ds_read_b64_tr_b16 v[24:25], v3 offset:14336
ds_read_b64_tr_b16 v[26:27], v3 offset:14848
s_waitcnt lgkmcnt(4)
v_mfma_f32_32x32x16_bf16 v[64:79], v[12:15], v[216:219], v[64:79]
ds_read_b64_tr_b16 v[28:29], v2 offset:16384
ds_read_b64_tr_b16 v[30:31], v2 offset:16896
v_mfma_f32_32x32x16_bf16 v[80:95], v[16:19], v[216:219], v[80:95]
ds_read_b64_tr_b16 v[12:13], v3 offset:16384
ds_read_b64_tr_b16 v[14:15], v3 offset:16896
s_waitcnt lgkmcnt(4)
v_mfma_f32_32x32x16_bf16 v[64:79], v[20:23], v[220:223], v[64:79]
ds_read_b64_tr_b16 v[16:17], v2 offset:18432
ds_read_b64_tr_b16 v[18:19], v2 offset:18944
v_mfma_f32_32x32x16_bf16 v[80:95], v[24:27], v[220:223], v[80:95]
ds_read_b64_tr_b16 v[20:21], v3 offset:18432
ds_read_b64_tr_b16 v[22:23], v3 offset:18944
s_waitcnt lgkmcnt(4)
v_mfma_f32_32x32x16_bf16 v[64:79], v[28:31], v[224:227], v[64:79]
ds_read_b64_tr_b16 v[24:25], v2 offset:20480
ds_read_b64_tr_b16 v[26:27], v2 offset:20992
v_mfma_f32_32x32x16_bf16 v[80:95], v[12:15], v[224:227], v[80:95]
ds_read_b64_tr_b16 v[28:29], v3 offset:20480
ds_read_b64_tr_b16 v[30:31], v3 offset:20992
s_waitcnt lgkmcnt(4)
v_mfma_f32_32x32x16_bf16 v[64:79], v[16:19], v[228:231], v[64:79]
ds_read_b64_tr_b16 v[12:13], v2 offset:22528
ds_read_b64_tr_b16 v[14:15], v2 offset:23040
v_mfma_f32_32x32x16_bf16 v[80:95], v[20:23], v[228:231], v[80:95]
ds_read_b64_tr_b16 v[16:17], v3 offset:22528
ds_read_b64_tr_b16 v[18:19], v3 offset:23040
s_waitcnt lgkmcnt(4)
v_mfma_f32_32x32x16_bf16 v[64:79], v[24:27], v[232:235], v[64:79]
ds_read_b64_tr_b16 v[20:21], v2 offset:24576
ds_read_b64_tr_b16 v[22:23], v2 offset:25088
v_mfma_f32_32x32x16_bf16 v[80:95], v[28:31], v[232:235], v[80:95]
ds_read_b64_tr_b16 v[24:25], v3 offset:24576
ds_read_b64_tr_b16 v[26:27], v3 offset:25088
s_waitcnt lgkmcnt(4)
v_mfma_f32_32x32x16_bf16 v[64:79], v[12:15], v[236:239], v[64:79]
ds_read_b64_tr_b16 v[28:29], v2 offset:26624
ds_read_b64_tr_b16 v[30:31], v2 offset:27136
v_mfma_f32_32x32x16_bf16 v[80:95], v[16:19], v[236:239], v[80:95]
ds_read_b64_tr_b16 v[12:13], v3 offset:26624
ds_read_b64_tr_b16 v[14:15], v3 offset:27136
s_waitcnt lgkmcnt(4)
v_mfma_f32_32x32x16_bf16 v[64:79], v[20:23], v[240:243], v[64:79]
ds_read_b64_tr_b16 v[16:17], v2 offset:28672
ds_read_b64_tr_b16 v[18:19], v2 offset:29184
v_mbcnt_lo_u32_b32 v8, -1, 0
v_mbcnt_hi_u32_b32 v8, -1, v8
v_lshlrev_b32 v9, 3, v8
v_cmp_gt_u32 s[64:65], 32, v8
v_mov_b32 v8, 142336
v_mfma_f32_32x32x16_bf16 v[80:95], v[24:27], v[240:243], v[80:95]
ds_read_b64_tr_b16 v[20:21], v3 offset:28672
ds_read_b64_tr_b16 v[22:23], v3 offset:29184
v_add_u32 v9, 141312, v9
v_cndmask_b32 v8, v8, v9, s[64:65]
s_waitcnt lgkmcnt(4)
v_mfma_f32_32x32x16_bf16 v[64:79], v[28:31], v[244:247], v[64:79]
ds_read_b64_tr_b16 v[24:25], v2 offset:30720
ds_read_b64_tr_b16 v[26:27], v2 offset:31232
ds_read_b64 v[10:11], v8 offset:768
ds_read_b64 v[8:9], v8 offset:512
v_mfma_f32_32x32x16_bf16 v[80:95], v[12:15], v[244:247], v[80:95]
ds_read_b64_tr_b16 v[28:29], v3 offset:30720
ds_read_b64_tr_b16 v[30:31], v3 offset:31232
s_waitcnt lgkmcnt(6)
v_mfma_f32_32x32x16_bf16 v[64:79], v[16:19], v[248:251], v[64:79]
v_mfma_f32_32x32x16_bf16 v[80:95], v[20:23], v[248:251], v[80:95]
s_waitcnt lgkmcnt(0)
v_mfma_f32_32x32x16_bf16 v[64:79], v[24:27], v[252:255], v[64:79]
v_mfma_f32_32x32x16_bf16 v[80:95], v[28:31], v[252:255], v[80:95]
v_mfma_f32_32x32x8_bf16 v[64:79], v[8:9], v[4:5], v[64:79]
v_mfma_f32_32x32x8_bf16 v[80:95], v[10:11], v[4:5], v[80:95]
v_mbcnt_lo_u32_b32 v8, -1, 0
v_mbcnt_hi_u32_b32 v8, -1, v8
v_bfe_u32 v9, v8, 4, 1
v_and_b32 v10, 15, v8
v_lshrrev_b32 v8, 5, v8
v_lshl_add_u32 v8, v8, 4, v10
v_lshlrev_b32 v9, 10, v9
v_lshl_add_u32 v8, v8, 4, v9
s_nop 2
v_mul_f32 v64, v64, v7
v_mul_f32 v65, v65, v7
v_cvt_pk_bf16_f32 v64, v64, v65
v_pk_max_i16 v64, v64, 0
v_mul_f32 v66, v66, v7
v_mul_f32 v67, v67, v7
v_cvt_pk_bf16_f32 v65, v66, v67
v_pk_max_i16 v65, v65, 0
v_mul_f32 v68, v68, v7
v_mul_f32 v69, v69, v7
v_cvt_pk_bf16_f32 v66, v68, v69
v_pk_max_i16 v66, v66, 0
v_mul_f32 v70, v70, v7
v_mul_f32 v71, v71, v7
v_cvt_pk_bf16_f32 v67, v70, v71
v_pk_max_i16 v67, v67, 0
v_mul_f32 v72, v72, v7
v_mul_f32 v73, v73, v7
v_cvt_pk_bf16_f32 v68, v72, v73
v_pk_max_i16 v68, v68, 0
v_mul_f32 v74, v74, v7
v_mul_f32 v75, v75, v7
v_cvt_pk_bf16_f32 v69, v74, v75
v_pk_max_i16 v69, v69, 0
v_mul_f32 v76, v76, v7
v_mul_f32 v77, v77, v7
v_cvt_pk_bf16_f32 v70, v76, v77
v_pk_max_i16 v70, v70, 0
v_mul_f32 v78, v78, v7
v_mul_f32 v79, v79, v7
v_cvt_pk_bf16_f32 v71, v78, v79
v_pk_max_i16 v71, v71, 0
s_add_u32 s43, s52, 0
buffer_store_dwordx4 v[64:67], v8, s[16:19], s43 offen sc1
s_add_u32 s43, s52, 512
buffer_store_dwordx4 v[68:71], v8, s[16:19], s43 offen sc1
v_mul_f32 v80, v80, v7
v_mul_f32 v81, v81, v7
v_cvt_pk_bf16_f32 v80, v80, v81
v_pk_max_i16 v80, v80, 0
v_mul_f32 v82, v82, v7
v_mul_f32 v83, v83, v7
v_cvt_pk_bf16_f32 v81, v82, v83
v_pk_max_i16 v81, v81, 0
v_mul_f32 v84, v84, v7
v_mul_f32 v85, v85, v7
v_cvt_pk_bf16_f32 v82, v84, v85
v_pk_max_i16 v82, v82, 0
v_mul_f32 v86, v86, v7
v_mul_f32 v87, v87, v7
v_cvt_pk_bf16_f32 v83, v86, v87
v_pk_max_i16 v83, v83, 0
v_mul_f32 v88, v88, v7
v_mul_f32 v89, v89, v7
v_cvt_pk_bf16_f32 v84, v88, v89
v_pk_max_i16 v84, v84, 0
v_mul_f32 v90, v90, v7
v_mul_f32 v91, v91, v7
v_cvt_pk_bf16_f32 v85, v90, v91
v_pk_max_i16 v85, v85, 0
v_mul_f32 v92, v92, v7
v_mul_f32 v93, v93, v7
v_cvt_pk_bf16_f32 v86, v92, v93
v_pk_max_i16 v86, v86, 0
v_mul_f32 v94, v94, v7
v_mul_f32 v95, v95, v7
v_cvt_pk_bf16_f32 v87, v94, v95
v_pk_max_i16 v87, v87, 0
s_add_u32 s43, s52, 4096
buffer_store_dwordx4 v[80:83], v8, s[16:19], s43 offen sc1
s_add_u32 s43, s52, 4608
buffer_store_dwordx4 v[84:87], v8, s[16:19], s43 offen sc1
s_setprio 0
v_mbcnt_lo_u32_b32 v0, -1, 0
v_mbcnt_hi_u32_b32 v0, -1, v0
L_att:
v_and_b32 v14, 31, v0
v_lshrrev_b32 v15, 5, v0
s_lshl_b32 s43, s37, 9
v_lshl_add_u32 v6, v14, 4, s43
v_add_u32 v5, 3, v15
v_mul_u32_u24 v1, 6144, v5
v_add_u32 v1, v1, v6
v_add_u32 v2, 12296, v6
s_mul_i32 s44, s37, 2560
s_add_u32 s45, s44, 30720
v_lshl_add_u32 v6, v14, 4, s45
v_lshl_add_u32 v34, v5, 9, v6
v_add_u32 v35, 1032, v6
v_lshlrev_b32 v33, 4, v0
v_add_u32 v33, 131072, v33
v_mov_b32 v68, 0
v_mov_b32 v69, 0
v_mov_b32 v55, 0
s_lshl_b32 s53, s48, 2
s_add_u32 s53, s53, s37
s_mov_b32 s68, 0xffffffff
s_mov_b32 s69, 0xfffffff0
s_mov_b32 s8, 0xfffffffe
s_mov_b32 s9, 0xffffffe0
s_mov_b32 s10, 0xfffffffc
s_mov_b32 s11, 0xffffffc0
s_mov_b32 s12, 0xfffffff8
s_mov_b32 s13, 0xffffff80
s_mov_b32 s14, 0xffffff00
s_mov_b32 s15, 0xfffff000
s_mov_b32 s24, 0xfffffe00
s_mov_b32 s25, 0xffffe000
s_mov_b32 s26, 0xfffffc00
s_mov_b32 s27, 0xffffc000
s_mov_b32 s32, 0xfffff800
s_mov_b32 s33, 0xffff8000
s_mov_b32 s34, 0xffff0000
s_mov_b32 s35, 0xfff00000
s_mov_b32 s60, 0xfffe0000
s_mov_b32 s61, 0xffe00000
s_mov_b32 s62, 0xfffc0000
s_mov_b32 s63, 0xffc00000
s_mov_b32 s0, 0xfff80000
s_mov_b32 s1, 0xff800000
s_mov_b32 s70, 0xff000000
s_mov_b32 s71, 0xf0000000
s_mov_b32 s64, 0xfe000000
s_mov_b32 s65, 0xe0000000
s_mov_b32 s66, 0xfc000000
s_mov_b32 s67, 0xc0000000
L_att2:
s_cbranch_vccz Lr_15
s_waitcnt vmcnt(7)
Lr_15:
s_barrier
ds_read_b128 v[64:67], v34
s_mov_b32 exec_hi, 0
ds_read_b64 v[68:69], v35
s_mov_b32 exec_hi, -1
s_cbranch_vccnz Lr_16
ds_read_b128 v[16:19], v33 offset:30720
ds_read_b128 v[20:23], v33 offset:31744
Lr_16:
.p2align 3
ds_read_b64 v[70:71], v2 offset:0
ds_read_b128 v[96:99], v1 offset:0
ds_read_b64 v[72:73], v2 offset:4096
ds_read_b128 v[100:103], v1 offset:4096
s_waitcnt lgkmcnt(2)
v_mfma_f32_32x32x8_bf16 v[128:143], v[70:71], v[68:69], 0
ds_read_b64 v[74:75], v2 offset:512
ds_read_b128 v[104:107], v1 offset:512
s_cbranch_vccnz Lr_17
s_and_b32 s43, s2, 6
s_lshl_b32 s28, s43, 2
s_lshr_b32 s44, s2, 3
s_and_b32 s44, s44, 7
s_add_u32 s28, s28, s44
s_and_b32 s29, s2, 1
s_lshl_b32 s29, s29, 2
s_lshr_b32 s44, s2, 6
s_add_u32 s29, s29, s44
v_mul_u32_u24 v6, 40, v15
v_add_u32 v6, v6, v14
s_mul_i32 s44, s37, 2560
s_add_u32 s43, s44, 41280
v_lshl_add_u32 v3, v6, 4, s43
s_mov_b32 s56, 0xfffff
s_mov_b32 s57, 0xfffff
Lr_17:
v_mfma_f32_32x32x16_bf16 v[128:143], v[96:99], v[64:67], v[128:143]
s_cbranch_vccnz Lr_18
v_mov_b32 v76, 0x3f803f80
v_mov_b32 v77, 0x3f803f80
v_mov_b32 v78, 0x3f803f80
Lr_18:
s_waitcnt lgkmcnt(2)
v_mfma_f32_32x32x8_bf16 v[240:255], v[72:73], v[68:69], 0
ds_read_b64 v[70:71], v2 offset:1024
ds_read_b128 v[96:99], v1 offset:1024
s_cbranch_vccnz Lr_19
v_mov_b32 v79, 0x3f803f80
v_mov_b32 v80, 0x3f803f80
v_mov_b32 v81, 0x3f803f80
Lr_19:
v_mfma_f32_32x32x16_bf16 v[240:255], v[100:103], v[64:67], v[240:255]
s_cbranch_vccnz Lr_20
v_mov_b32 v82, 0x3f803f80
v_mov_b32 v83, 0x3f803f80
v_mov_b32 v84, 0x3f803f80
v_mov_b32 v85, 0x3f803f80
Lr_20:
s_waitcnt lgkmcnt(2)
v_mfma_f32_32x32x8_bf16 v[144:159], v[74:75], v[68:69], 0
ds_read_b64 v[72:73], v2 offset:1536
ds_read_b128 v[100:103], v1 offset:1536
s_cbranch_vccnz Lr_21
v_mov_b32 v86, 0x3f803f80
v_mov_b32 v87, 0x3f803f80
v_mov_b32 v88, 0x3f803f80
Lr_21:
v_mfma_f32_32x32x16_bf16 v[144:159], v[104:107], v[64:67], v[144:159]
s_cbranch_vccnz Lr_22
v_mov_b32 v89, 0x3f803f80
v_mov_b32 v90, 0x3f803f80
v_mov_b32 v91, 0x3f803f80
Lr_22:
s_cmp_lt_u32 s53, 8
s_cbranch_scc1 Lfx_23
Lfb_24:
s_nop 1
v_cndmask_b32 v128, v128, v240, s[68:69]
v_cndmask_b32 v129, v129, v241, s[8:9]
v_cndmask_b32 v130, v130, v242, s[10:11]
v_cndmask_b32 v131, v131, v243, s[12:13]
v_cndmask_b32 v132, v132, v244, s[14:15]
v_cndmask_b32 v133, v133, v245, s[24:25]
s_waitcnt lgkmcnt(2)
v_mfma_f32_32x32x8_bf16 v[160:175], v[70:71], v[68:69], 0
ds_read_b64 v[74:75], v2 offset:2048
ds_read_b128 v[104:107], v1 offset:2048
s_cbranch_vccnz Lr_25
v_mov_b32 v60, 0
v_mov_b32 v61, 0
s_mov_b32 exec_hi, 0
v_mov_b32 v60, 0x3f803f80
v_mov_b32 v61, 0x3f80
s_mov_b32 exec_hi, -1
v_bfe_u32 v12, v0, 4, 1
v_lshlrev_b32 v12, 10, v12
v_and_b32 v13, 15, v0
v_lshl_add_u32 v6, v15, 4, v13
v_lshl_add_u32 v13, v13, 3, v12
v_lshl_add_u32 v12, v6, 4, v12
v_lshl_add_u32 v13, v15, 30, v13
v_lshlrev_b32 v53, 4, v0
s_lshl_b32 s43, s37, 10
v_add_u32 v50, s43, v53
v_add_u32 v53, 8192, v53
Lr_25:
v_cndmask_b32 v134, v134, v246, s[26:27]
v_cndmask_b32 v135, v135, v247, s[32:33]
v_cndmask_b32 v136, v136, v248, s[34:35]
v_cndmask_b32 v137, v137, v249, s[60:61]
v_cndmask_b32 v138, v138, v250, s[62:63]
v_cndmask_b32 v139, v139, v251, s[0:1]
v_mfma_f32_32x32x16_bf16 v[160:175], v[96:99], v[64:67], v[160:175]
s_cbranch_vccnz Lr_26
s_waitcnt vmcnt(0)
s_lshl_b32 s43, s39, 2
s_add_u32 s43, s43, s37
s_lshl_b32 s43, s43, 4
s_add_u32 s43, s43, s40
s_lshl_b32 s43, s43, 6
s_add_u32 s43, s43, 23101440
v_mov_b32 v10, s54
v_mov_b32 v11, s55
s_mov_b64 exec, 1
buffer_store_dwordx2 v[10:11], off, s[16:19], s43 sc1
s_mov_b64 exec, -1
Lr_26:
s_cbranch_vccnz Lr_27
v_add_u32 v48, 71680, v50
v_add_u32 v51, 71680, v53
v_add_u32 v49, 126976, v50
v_add_u32 v52, 126976, v53
v_lshlrev_b32 v6, 3, v0
v_sub_u32 v54, v49, v6
Lr_27:
v_cndmask_b32 v140, v140, v252, s[70:71]
v_cndmask_b32 v141, v141, v253, s[64:65]
v_cndmask_b32 v142, v142, v254, s[66:67]
s_mov_b32 s68, 0xf8000000
s_mov_b32 s69, 0x80000000
v_cndmask_b32 v143, v143, v255, s[68:69]
v_max3_f32 v4, v128, v129, v130
v_max3_f32 v5, v131, v132, v133
s_waitcnt lgkmcnt(2)
v_mfma_f32_32x32x8_bf16 v[176:191], v[72:73], v[68:69], 0
ds_read_b64 v[70:71], v2 offset:2560
ds_read_b128 v[96:99], v1 offset:2560
s_cbranch_vccnz Lr_28
v_and_b32 v6, 15, v0
s_lshl_b32 s43, s28, 2
s_and_b32 s44, s37, 3
s_add_u32 s43, s43, s44
s_lshl_b32 s43, s43, 4
v_add_u32 v6, s43, v6
v_mul_u32_u24 v6, 1280, v6
v_lshrrev_b32 v55, 4, v0
v_lshl_add_u32 v6, v55, 3, v6
s_mul_i32 s43, s29, 160
v_add_u32 v55, s43, v6
buffer_load_dwordx2 v[36:37], v55, s[4:7], 0 offen offset:0
Lr_28:
v_max3_f32 v4, v134, v135, v4
v_max3_f32 v5, v136, v137, v5
v_max3_f32 v4, v138, v139, v4
v_max3_f32 v5, v140, v141, v5
v_max3_f32 v4, v142, v143, v4
s_cmp_lt_u32 s53, 7
s_cbranch_scc1 Lfx_29
Lfb_30:
v_max3_f32 v4, v144, v145, v4
v_mfma_f32_32x32x16_bf16 v[176:191], v[100:103], v[64:67], v[176:191]
s_cbranch_vccz Lr_31
s_mul_i32 s44, s29, 5
s_lshr_b32 s44, s44, 2
s_mul_i32 s44, s44, 640
s_add_u32 s44, s44, 23175168
s_mov_b32 exec_hi, 0x1f
buffer_load_dwordx4 v[36:39], v33, s[16:19], s44 offen sc1
buffer_load_dwordx4 v[40:43], v33, s[16:19], s44 offen offset:640 sc1
s_mov_b32 exec_hi, -1
Lr_31:
s_cbranch_vccnz Lr_32
buffer_load_dwordx2 v[38:39], v55, s[4:7], 0 offen offset:32
buffer_load_dwordx2 v[40:41], v55, s[4:7], 0 offen offset:64
buffer_load_dwordx2 v[42:43], v55, s[4:7], 0 offen offset:96
buffer_load_dwordx2 v[44:45], v55, s[4:7], 0 offen offset:128
Lr_32:
v_max3_f32 v5, v146, v147, v5
v_max3_f32 v4, v148, v149, v4
v_max3_f32 v5, v150, v151, v5
v_max3_f32 v4, v152, v153, v4
v_max3_f32 v5, v154, v155, v5
v_max3_f32 v4, v156, v157, v4
s_waitcnt lgkmcnt(2)
v_mfma_f32_32x32x8_bf16 v[192:207], v[74:75], v[68:69], 0
ds_read_b64 v[72:73], v2 offset:3072
ds_read_b128 v[100:103], v1 offset:3072
v_max3_f32 v5, v158, v159, v5
s_cmp_lt_u32 s53, 6
s_cbranch_scc1 Lfx_33
Lfb_34:
v_max3_f32 v4, v160, v161, v4
v_max3_f32 v5, v162, v163, v5
v_max3_f32 v4, v164, v165, v4
v_max3_f32 v5, v166, v167, v5
v_max3_f32 v4, v168, v169, v4
v_mfma_f32_32x32x16_bf16 v[192:207], v[104:107], v[64:67], v[192:207]
v_max3_f32 v5, v170, v171, v5
v_max3_f32 v4, v172, v173, v4
v_max3_f32 v5, v174, v175, v5
s_cmp_lt_u32 s53, 5
s_cbranch_scc1 Lfx_35
Lfb_36:
v_max3_f32 v4, v176, v177, v4
v_max3_f32 v5, v178, v179, v5
v_max3_f32 v4, v180, v181, v4
s_waitcnt lgkmcnt(2)
v_mfma_f32_32x32x8_bf16 v[208:223], v[70:71], v[68:69], 0
ds_read_b64 v[74:75], v2 offset:3584
ds_read_b128 v[104:107], v1 offset:3584
v_max3_f32 v5, v182, v183, v5
v_max3_f32 v4, v184, v185, v4
v_max3_f32 v5, v186, v187, v5
v_max3_f32 v4, v188, v189, v4
v_max3_f32 v5, v190, v191, v5
v_mfma_f32_32x32x16_bf16 v[208:223], v[96:99], v[64:67], v[208:223]
s_cmp_lt_u32 s53, 4
s_cbranch_scc1 Lfx_37
Lfb_38:
v_max3_f32 v4, v192, v193, v4
v_max3_f32 v5, v194, v195, v5
v_max3_f32 v4, v196, v197, v4
v_max3_f32 v5, v198, v199, v5
v_max3_f32 v4, v200, v201, v4
v_max3_f32 v5, v202, v203, v5
s_waitcnt lgkmcnt(2)
v_mfma_f32_32x32x8_bf16 v[224:239], v[72:73], v[68:69], 0
v_max3_f32 v4, v204, v205, v4
v_max3_f32 v5, v206, v207, v5
v_mfma_f32_32x32x16_bf16 v[224:239], v[100:103], v[64:67], v[224:239]
s_cmp_lt_u32 s53, 3
s_cbranch_scc1 Lfx_39
Lfb_40:
v_max3_f32 v4, v208, v209, v4
v_max3_f32 v5, v210, v211, v5
v_max3_f32 v4, v212, v213, v4
v_max3_f32 v5, v214, v215, v5
v_max3_f32 v4, v216, v217, v4
v_max3_f32 v5, v218, v219, v5
s_waitcnt lgkmcnt(0)
v_mfma_f32_32x32x8_bf16 v[240:255], v[74:75], v[68:69], 0
v_max3_f32 v4, v220, v221, v4
v_max3_f32 v5, v222, v223, v5
v_mfma_f32_32x32x16_bf16 v[240:255], v[104:107], v[64:67], v[240:255]
s_cbranch_vccz Lr_41
s_waitcnt vmcnt(2)
Lr_41:
s_barrier
s_mov_b64 exec, s[56:57]
ds_read_b128 v[76:79], v3 offset:20480
ds_read_b128 v[80:83], v3 offset:21760
s_mov_b64 exec, -1
s_mov_b64 exec, s[56:57]
ds_read_b128 v[84:87], v3 offset:0
ds_read_b128 v[88:91], v3 offset:1280
s_mov_b64 exec, -1
s_cmp_lt_u32 s53, 2
s_cbranch_scc1 Lfx_42
Lfb_43:
v_max3_f32 v4, v224, v225, v4
v_max3_f32 v5, v226, v227, v5
v_max3_f32 v4, v228, v229, v4
v_max3_f32 v5, v230, v231, v5
v_max3_f32 v4, v232, v233, v4
v_max3_f32 v5, v234, v235, v5
v_max3_f32 v4, v236, v237, v4
v_max3_f32 v5, v238, v239, v5
s_cbranch_vccz Lr_44
s_waitcnt vmcnt(0)
s_mov_b32 s47, 0
Lw_45:
s_mov_b32 exec_hi, 0x1f
v_cmp_ne_u64 s[64:65], s[54:55], v[36:37]
v_cmp_ne_u64 s[66:67], s[54:55], v[38:39]
s_nop 0
s_or_b64 s[64:65], s[64:65], s[66:67]
v_cmp_ne_u64 s[66:67], s[54:55], v[40:41]
s_nop 0
s_or_b64 s[64:65], s[64:65], s[66:67]
v_cmp_ne_u64 s[66:67], s[54:55], v[42:43]
s_nop 0
s_or_b64 s[64:65], s[64:65], s[66:67]
s_mov_b32 exec_hi, -1
s_cmp_eq_u64 s[64:65], 0
s_cbranch_scc1 Lw_46
s_add_u32 s47, s47, 1
s_cmp_gt_u32 s47, 400000
s_cbranch_scc1 Lw_46
s_sleep 16
s_mul_i32 s44, s29, 5
s_lshr_b32 s44, s44, 2
s_mul_i32 s44, s44, 640
s_add_u32 s44, s44, 23175168
s_mov_b32 exec_hi, 0x1f
buffer_load_dwordx4 v[36:39], v33, s[16:19], s44 offen sc1
buffer_load_dwordx4 v[40:43], v33, s[16:19], s44 offen offset:640 sc1
s_mov_b32 exec_hi, -1
s_waitcnt vmcnt(0)
s_branch Lw_45
Lw_46:
Lr_44:
s_cbranch_vccz Lr_47
s_add_u32 s43, s31, 0
s_cmp_lg_u32 s52, 0
s_cbranch_scc1 Lk_48
s_add_u32 m0, s51, 79872
s_nop 0
buffer_load_dwordx4 v9, s[16:19], s43 offen sc1 lds
Lk_48:
s_add_u32 m0, s41, 79872
s_nop 0
buffer_load_dwordx4 v8, s[16:19], s43 offen sc1 lds
s_add_u32 m0, s41, 83968
s_add_u32 s43, s43, 4096
buffer_load_dwordx4 v8, s[16:19], s43 offen sc1 lds
Lr_47:
s_cmp_lt_u32 s53, 1
s_cbranch_scc1 Lfx_49
Lfb_50:
v_max3_f32 v4, v240, v241, v4
v_max3_f32 v5, v242, v243, v5
v_max3_f32 v4, v244, v245, v4
v_max3_f32 v5, v246, v247, v5
v_max3_f32 v4, v248, v249, v4
v_max3_f32 v5, v250, v251, v5
v_max3_f32 v4, v252, v253, v4
v_max3_f32 v5, v254, v255, v5
v_max_f32 v4, v4, v5
v_mov_b32 v5, v4
s_nop 1
v_permlane32_swap_b32 v5, v4
v_max_f32 v4, v4, v5
v_sub_f32 v4, 0, v4
v_and_b32 v5, 0xffff0000, v4
v_sub_f32 v4, v4, v5
v_and_b32 v6, 0xffff0000, v4
v_sub_f32 v4, v4, v6
v_lshrrev_b32 v5, 16, v5
v_or_b32 v62, v5, v6
v_lshrrev_b32 v63, 16, v4
s_nop 1
v_mfma_f32_32x32x8_bf16 v[128:143], v[60:61], v[62:63], v[128:143]
v_mfma_f32_32x32x8_bf16 v[144:159], v[60:61], v[62:63], v[144:159]
s_nop 10
v_exp_f32 v128, v128
v_exp_f32 v129, v129
v_exp_f32 v130, v130
v_exp_f32 v131, v131
v_cvt_pk_bf16_f32 v128, v128, v129
v_exp_f32 v132, v132
v_exp_f32 v133, v133
v_cvt_pk_bf16_f32 v129, v130, v131
v_exp_f32 v134, v134
v_exp_f32 v135, v135
v_cvt_pk_bf16_f32 v130, v132, v133
v_exp_f32 v136, v136
v_exp_f32 v137, v137
v_cvt_pk_bf16_f32 v131, v134, v135
v_exp_f32 v138, v138
v_exp_f32 v139, v139
v_cvt_pk_bf16_f32 v132, v136, v137
v_exp_f32 v140, v140
v_exp_f32 v141, v141
v_cvt_pk_bf16_f32 v133, v138, v139
v_exp_f32 v142, v142
v_exp_f32 v143, v143
v_cvt_pk_bf16_f32 v134, v140, v141
v_cvt_pk_bf16_f32 v135, v142, v143
v_and_b32 v24, v16, v128
v_and_b32 v25, v17, v129
v_and_b32 v26, v18, v130
v_and_b32 v27, v19, v131
v_and_b32 v28, v20, v132
v_and_b32 v29, v21, v133
v_and_b32 v30, v22, v134
v_and_b32 v31, v23, v135
v_xor_b32 v128, v128, v24
v_xor_b32 v129, v129, v25
v_xor_b32 v130, v130, v26
v_xor_b32 v131, v131, v27
v_xor_b32 v132, v132, v28
v_xor_b32 v133, v133, v29
v_xor_b32 v134, v134, v30
v_xor_b32 v135, v135, v31
v_exp_f32 v144, v144
v_exp_f32 v145, v145
v_exp_f32 v146, v146
v_mfma_f32_32x32x8_bf16 v[160:175], v[60:61], v[62:63], v[160:175]
v_exp_f32 v147, v147
s_waitcnt lgkmcnt(2)
v_cvt_pk_bf16_f32 v144, v144, v145
v_mfma_f32_32x32x16_bf16 v[112:127], v[76:79], v[24:27], 0
v_exp_f32 v148, v148
v_mfma_f32_32x32x16_bf16 v[112:127], v[80:83], v[28:31], v[112:127]
v_exp_f32 v149, v149
s_waitcnt lgkmcnt(0)
v_cvt_pk_bf16_f32 v145, v146, v147
s_mov_b64 exec, s[56:57]
ds_read_b128 v[76:79], v3 offset:2560
ds_read_b128 v[80:83], v3 offset:3840
s_mov_b64 exec, -1
v_exp_f32 v150, v150
v_mfma_f32_32x32x16_bf16 v[112:127], v[84:87], v[128:131], v[112:127]
v_exp_f32 v151, v151
v_mfma_f32_32x32x16_bf16 v[112:127], v[88:91], v[132:135], v[112:127]
v_cvt_pk_bf16_f32 v146, v148, v149
s_mov_b64 exec, s[56:57]
ds_read_b128 v[84:87], v3 offset:5120
ds_read_b128 v[88:91], v3 offset:6400
s_mov_b64 exec, -1
v_exp_f32 v152, v152
s_cbranch_vccz Lr_51
s_add_u32 s43, s31, 10240
s_cmp_lg_u32 s52, 1
s_cbranch_scc1 Lk_52
s_add_u32 m0, s51, 98304
s_nop 0
buffer_load_dwordx4 v9, s[16:19], s43 offen sc1 lds
Lk_52:
s_add_u32 m0, s41, 98304
s_nop 0
buffer_load_dwordx4 v8, s[16:19], s43 offen sc1 lds
s_add_u32 m0, s41, 102400
s_add_u32 s43, s43, 4096
buffer_load_dwordx4 v8, s[16:19], s43 offen sc1 lds
Lr_51:
v_exp_f32 v153, v153
s_cbranch_vccz Lr_53
s_add_u32 s43, s31, 20480
s_cmp_lg_u32 s52, 0
s_cbranch_scc1 Lk_54
s_add_u32 m0, s51, 116736
s_nop 0
buffer_load_dwordx4 v9, s[16:19], s43 offen sc1 lds
Lk_54:
s_add_u32 m0, s41, 116736
s_nop 0
buffer_load_dwordx4 v8, s[16:19], s43 offen sc1 lds
s_add_u32 m0, s41, 120832
s_add_u32 s43, s43, 4096
buffer_load_dwordx4 v8, s[16:19], s43 offen sc1 lds
Lr_53:
v_cvt_pk_bf16_f32 v147, v150, v151
v_exp_f32 v154, v154
v_exp_f32 v155, v155
v_cvt_pk_bf16_f32 v148, v152, v153
v_exp_f32 v156, v156
v_exp_f32 v157, v157
v_cvt_pk_bf16_f32 v149, v154, v155
v_exp_f32 v158, v158
v_exp_f32 v159, v159
v_cvt_pk_bf16_f32 v150, v156, v157
v_cvt_pk_bf16_f32 v151, v158, v159
v_exp_f32 v160, v160
v_exp_f32 v161, v161
v_exp_f32 v162, v162
v_mfma_f32_32x32x8_bf16 v[176:191], v[60:61], v[62:63], v[176:191]
v_exp_f32 v163, v163
v_cvt_pk_bf16_f32 v160, v160, v161
s_waitcnt lgkmcnt(2)
v_exp_f32 v164, v164
v_exp_f32 v165, v165
v_mfma_f32_32x32x16_bf16 v[112:127], v[76:79], v[144:147], v[112:127]
v_cvt_pk_bf16_f32 v161, v162, v163
v_exp_f32 v166, v166
v_mfma_f32_32x32x16_bf16 v[112:127], v[80:83], v[148:151], v[112:127]
v_exp_f32 v167, v167
v_cvt_pk_bf16_f32 v162, v164, v165
s_mov_b64 exec, s[56:57]
ds_read_b128 v[76:79], v3 offset:7680
ds_read_b128 v[80:83], v3 offset:8960
s_mov_b64 exec, -1
v_exp_f32 v168, v168
v_exp_f32 v169, v169
s_cbranch_vccz Lr_55
s_add_u32 s43, s31, 30720
s_cmp_lg_u32 s52, 1
s_cbranch_scc1 Lk_56
s_add_u32 m0, s51, 135168
s_nop 0
buffer_load_dwordx4 v9, s[16:19], s43 offen sc1 lds
Lk_56:
s_add_u32 m0, s41, 135168
s_nop 0
buffer_load_dwordx4 v8, s[16:19], s43 offen sc1 lds
s_add_u32 m0, s41, 139264
s_add_u32 s43, s43, 4096
buffer_load_dwordx4 v8, s[16:19], s43 offen sc1 lds
Lr_55:
v_cvt_pk_bf16_f32 v163, v166, v167
v_exp_f32 v170, v170
s_cbranch_vccz Lr_57
s_add_u32 s43, s31, 40960
s_cmp_lg_u32 s52, 0
s_cbranch_scc1 Lk_58
s_add_u32 m0, s51, 153600
s_nop 0
buffer_load_dwordx4 v9, s[16:19], s43 offen sc1 lds
Lk_58:
s_add_u32 m0, s41, 153600
s_nop 0
buffer_load_dwordx4 v8, s[16:19], s43 offen sc1 lds
s_add_u32 m0, s41, 157696
s_add_u32 s43, s43, 4096
buffer_load_dwordx4 v8, s[16:19], s43 offen sc1 lds
Lr_57:
v_exp_f32 v171, v171
v_cvt_pk_bf16_f32 v164, v168, v169
v_exp_f32 v172, v172
v_exp_f32 v173, v173
v_cvt_pk_bf16_f32 v165, v170, v171
v_exp_f32 v174, v174
v_exp_f32 v175, v175
v_cvt_pk_bf16_f32 v166, v172, v173
v_cvt_pk_bf16_f32 v167, v174, v175
v_exp_f32 v176, v176
v_exp_f32 v177, v177
v_exp_f32 v178, v178
v_mfma_f32_32x32x8_bf16 v[192:207], v[60:61], v[62:63], v[192:207]
v_exp_f32 v179, v179
v_cvt_pk_bf16_f32 v176, v176, v177
s_waitcnt lgkmcnt(2)
v_exp_f32 v180, v180
v_exp_f32 v181, v181
v_mfma_f32_32x32x16_bf16 v[112:127], v[84:87], v[160:163], v[112:127]
v_cvt_pk_bf16_f32 v177, v178, v179
v_exp_f32 v182, v182
v_mfma_f32_32x32x16_bf16 v[112:127], v[88:91], v[164:167], v[112:127]
v_exp_f32 v183, v183
v_cvt_pk_bf16_f32 v178, v180, v181
s_mov_b64 exec, s[56:57]
ds_read_b128 v[84:87], v3 offset:10240
ds_read_b128 v[88:91], v3 offset:11520
s_mov_b64 exec, -1
v_exp_f32 v184, v184
v_exp_f32 v185, v185
s_cbranch_vccz Lr_59
s_add_u32 s43, s31, 51200
s_cmp_lg_u32 s52, 1
s_cbranch_scc1 Lk_60
s_add_u32 m0, s51, 8192
s_nop 0
buffer_load_dwordx4 v9, s[16:19], s43 offen sc1 lds
Lk_60:
s_add_u32 m0, s41, 8192
s_nop 0
buffer_load_dwordx4 v8, s[16:19], s43 offen sc1 lds
s_add_u32 m0, s41, 12288
s_add_u32 s43, s43, 4096
buffer_load_dwordx4 v8, s[16:19], s43 offen sc1 lds
Lr_59:
v_cvt_pk_bf16_f32 v179, v182, v183
v_exp_f32 v186, v186
s_cbranch_vccz Lr_61
s_add_u32 s43, s31, 61440
s_cmp_lg_u32 s52, 0
s_cbranch_scc1 Lk_62
s_add_u32 m0, s51, 26624
s_nop 0
buffer_load_dwordx4 v9, s[16:19], s43 offen sc1 lds
Lk_62:
s_add_u32 m0, s41, 26624
s_nop 0
buffer_load_dwordx4 v8, s[16:19], s43 offen sc1 lds
s_add_u32 m0, s41, 30720
s_add_u32 s43, s43, 4096
buffer_load_dwordx4 v8, s[16:19], s43 offen sc1 lds
Lr_61:
v_exp_f32 v187, v187
v_cvt_pk_bf16_f32 v180, v184, v185
v_exp_f32 v188, v188
v_exp_f32 v189, v189
v_cvt_pk_bf16_f32 v181, v186, v187
v_exp_f32 v190, v190
v_exp_f32 v191, v191
v_cvt_pk_bf16_f32 v182, v188, v189
v_cvt_pk_bf16_f32 v183, v190, v191
v_exp_f32 v192, v192
v_exp_f32 v193, v193
v_exp_f32 v194, v194
v_mfma_f32_32x32x8_bf16 v[208:223], v[60:61], v[62:63], v[208:223]
v_exp_f32 v195, v195
v_cvt_pk_bf16_f32 v192, v192, v193
v_exp_f32 v196, v196
v_exp_f32 v197, v197
s_waitcnt lgkmcnt(2)
v_cvt_pk_bf16_f32 v193, v194, v195
v_exp_f32 v198, v198
v_exp_f32 v199, v199
v_cvt_pk_bf16_f32 v194, v196, v197
v_mfma_f32_32x32x16_bf16 v[112:127], v[76:79], v[176:179], v[112:127]
v_exp_f32 v200, v200
v_exp_f32 v201, v201
v_cvt_pk_bf16_f32 v195, v198, v199
v_exp_f32 v202, v202
v_mfma_f32_32x32x16_bf16 v[112:127], v[80:83], v[180:183], v[112:127]
v_exp_f32 v203, v203
v_cvt_pk_bf16_f32 v196, v200, v201
v_exp_f32 v204, v204
v_exp_f32 v205, v205
s_mov_b64 exec, s[56:57]
ds_read_b128 v[76:79], v3 offset:12800
ds_read_b128 v[80:83], v3 offset:14080
s_mov_b64 exec, -1
v_cvt_pk_bf16_f32 v197, v202, v203
v_exp_f32 v206, v206
v_exp_f32 v207, v207
v_cvt_pk_bf16_f32 v198, v204, v205
v_cvt_pk_bf16_f32 v199, v206, v207
v_exp_f32 v208, v208
v_exp_f32 v209, v209
v_exp_f32 v210, v210
v_mfma_f32_32x32x8_bf16 v[224:239], v[60:61], v[62:63], v[224:239]
v_exp_f32 v211, v211
v_cvt_pk_bf16_f32 v208, v208, v209
v_exp_f32 v212, v212
v_exp_f32 v213, v213
s_waitcnt lgkmcnt(2)
v_cvt_pk_bf16_f32 v209, v210, v211
v_exp_f32 v214, v214
v_exp_f32 v215, v215
v_cvt_pk_bf16_f32 v210, v212, v213
v_mfma_f32_32x32x16_bf16 v[112:127], v[84:87], v[192:195], v[112:127]
v_exp_f32 v216, v216
v_exp_f32 v217, v217
v_cvt_pk_bf16_f32 v211, v214, v215
v_exp_f32 v218, v218
v_mfma_f32_32x32x16_bf16 v[112:127], v[88:91], v[196:199], v[112:127]
v_exp_f32 v219, v219
v_cvt_pk_bf16_f32 v212, v216, v217
v_exp_f32 v220, v220
v_exp_f32 v221, v221
s_mov_b64 exec, s[56:57]
ds_read_b128 v[84:87], v3 offset:15360
ds_read_b128 v[88:91], v3 offset:16640
s_mov_b64 exec, -1
v_cvt_pk_bf16_f32 v213, v218, v219
v_exp_f32 v222, v222
v_exp_f32 v223, v223
v_cvt_pk_bf16_f32 v214, v220, v221
v_cvt_pk_bf16_f32 v215, v222, v223
s_cbranch_vccz Lr_63
s_lshl_b32 s44, s28, 1
s_lshr_b32 s45, s37, 1
s_add_u32 s44, s44, s45
s_lshl_b32 s44, s44, 10
s_add_u32 s44, s44, 23101440
s_mov_b64 exec, 0x3fff
buffer_load_dwordx2 v[10:11], v32, s[16:19], s44 offen sc1
s_mov_b64 exec, -1
Lr_63:
v_exp_f32 v224, v224
v_exp_f32 v225, v225
v_exp_f32 v226, v226
v_mfma_f32_32x32x8_bf16 v[240:255], v[60:61], v[62:63], v[240:255]
v_exp_f32 v227, v227
v_cvt_pk_bf16_f32 v224, v224, v225
v_exp_f32 v228, v228
v_exp_f32 v229, v229
s_waitcnt lgkmcnt(2)
v_cvt_pk_bf16_f32 v225, v226, v227
v_exp_f32 v230, v230
v_exp_f32 v231, v231
v_cvt_pk_bf16_f32 v226, v228, v229
v_mfma_f32_32x32x16_bf16 v[112:127], v[76:79], v[208:211], v[112:127]
v_exp_f32 v232, v232
v_exp_f32 v233, v233
v_cvt_pk_bf16_f32 v227, v230, v231
v_exp_f32 v234, v234
v_mfma_f32_32x32x16_bf16 v[112:127], v[80:83], v[212:215], v[112:127]
v_exp_f32 v235, v235
v_cvt_pk_bf16_f32 v228, v232, v233
v_exp_f32 v236, v236
v_exp_f32 v237, v237
s_mov_b64 exec, s[56:57]
ds_read_b128 v[76:79], v3 offset:17920
ds_read_b128 v[80:83], v3 offset:19200
s_mov_b64 exec, -1
v_cvt_pk_bf16_f32 v229, v234, v235
v_exp_f32 v238, v238
v_exp_f32 v239, v239
v_cvt_pk_bf16_f32 v230, v236, v237
v_cvt_pk_bf16_f32 v231, v238, v239
s_cbranch_vccz Lr_64
s_waitcnt vmcnt(0)
s_mov_b64 exec, 0x3fff
v_cmp_ne_u64 s[64:65], s[54:55], v[10:11]
s_mov_b64 exec, -1
s_cmp_lg_u64 s[64:65], 0
s_cbranch_scc1 Lk_65
s_add_u32 m0, s41, 71680
s_add_u32 s43, s30, 0
buffer_load_dwordx4 v8, s[16:19], s43 offen sc1 lds
s_add_u32 m0, s41, 75776
s_add_u32 s43, s30, 4096
buffer_load_dwordx4 v8, s[16:19], s43 offen sc1 lds
s_add_u32 m0, s41, 90112
s_add_u32 s43, s30, 8192
buffer_load_dwordx4 v8, s[16:19], s43 offen sc1 lds
s_add_u32 m0, s41, 94208
s_add_u32 s43, s30, 12288
buffer_load_dwordx4 v8, s[16:19], s43 offen sc1 lds
s_add_u32 m0, s41, 108544
s_add_u32 s43, s30, 16384
buffer_load_dwordx4 v8, s[16:19], s43 offen sc1 lds
s_add_u32 m0, s41, 112640
s_add_u32 s43, s30, 20480
buffer_load_dwordx4 v8, s[16:19], s43 offen sc1 lds
s_add_u32 m0, s41, 126976
s_add_u32 s43, s30, 24576
buffer_load_dwordx4 v8, s[16:19], s43 offen sc1 lds
s_add_u32 m0, s41, 131072
s_add_u32 s43, s30, 28672
buffer_load_dwordx4 v8, s[16:19], s43 offen sc1 lds
s_add_u32 m0, s41, 145408
s_add_u32 s43, s30, 32768
buffer_load_dwordx4 v8, s[16:19], s43 offen sc1 lds
s_add_u32 m0, s41, 149504
s_add_u32 s43, s30, 36864
buffer_load_dwordx4 v8, s[16:19], s43 offen sc1 lds
s_add_u32 m0, s41, 0
s_add_u32 s43, s30, 40960
buffer_load_dwordx4 v8, s[16:19], s43 offen sc1 lds
s_add_u32 m0, s41, 4096
s_add_u32 s43, s30, 45056
buffer_load_dwordx4 v8, s[16:19], s43 offen sc1 lds
s_add_u32 m0, s41, 18432
s_add_u32 s43, s30, 49152
buffer_load_dwordx4 v8, s[16:19], s43 offen sc1 lds
s_add_u32 m0, s41, 22528
s_add_u32 s43, s30, 53248
buffer_load_dwordx4 v8, s[16:19], s43 offen sc1 lds
s_mov_b32 s42, 1
Lk_65:
Lr_64:
v_exp_f32 v240, v240
v_exp_f32 v241, v241
v_exp_f32 v242, v242
s_waitcnt lgkmcnt(2)
v_exp_f32 v243, v243
v_cvt_pk_bf16_f32 v240, v240, v241
v_exp_f32 v244, v244
v_exp_f32 v245, v245
v_cvt_pk_bf16_f32 v241, v242, v243
v_exp_f32 v246, v246
v_mfma_f32_32x32x16_bf16 v[112:127], v[84:87], v[224:227], v[112:127]
v_exp_f32 v247, v247
v_cvt_pk_bf16_f32 v242, v244, v245
v_exp_f32 v248, v248
v_exp_f32 v249, v249
v_cvt_pk_bf16_f32 v243, v246, v247
v_exp_f32 v250, v250
v_mfma_f32_32x32x16_bf16 v[112:127], v[88:91], v[228:231], v[112:127]
v_exp_f32 v251, v251
v_cvt_pk_bf16_f32 v244, v248, v249
v_exp_f32 v252, v252
v_exp_f32 v253, v253
v_cvt_pk_bf16_f32 v245, v250, v251
v_exp_f32 v254, v254
v_exp_f32 v255, v255
v_cvt_pk_bf16_f32 v246, v252, v253
v_cvt_pk_bf16_f32 v247, v254, v255
s_waitcnt lgkmcnt(0)
v_mfma_f32_32x32x16_bf16 v[112:127], v[76:79], v[240:243], v[112:127]
v_mfma_f32_32x32x16_bf16 v[112:127], v[80:83], v[244:247], v[112:127]
s_lshr_b32 s43, s37, 1
s_lshl_b32 s44, s48, 1
s_add_u32 s43, s43, s44
s_mul_i32 s43, s43, 148
s_and_b32 s44, s37, 1
s_add_u32 s43, s43, s44
s_lshl_b32 s43, s43, 11
s_lshl_b32 s44, s38, 9
s_add_u32 s43, s43, s44
s_add_u32 s43, s43, 8609792
s_lshr_b32 s44, s49, 2
s_lshl_b32 s44, s44, 12
s_and_b32 s45, s49, 3
s_lshl_b32 s45, s45, 7
s_add_u32 s44, s44, s45
s_add_u32 s44, s44, s43
s_add_u32 s59, s44, 65536
s_lshl_b32 s45, s49, 12
s_add_u32 s58, s43, s45
v_rcp_f32 v5, v124
s_nop 0
v_mul_f32 v112, v112, v5
v_mul_f32 v113, v113, v5
v_mul_f32 v114, v114, v5
v_mul_f32 v115, v115, v5
v_mul_f32 v116, v116, v5
v_mul_f32 v117, v117, v5
v_mul_f32 v118, v118, v5
v_mul_f32 v119, v119, v5
v_mul_f32 v120, v120, v5
v_mul_f32 v121, v121, v5
v_mul_f32 v122, v122, v5
v_mul_f32 v123, v123, v5
v_cvt_pk_bf16_f32 v112, v112, v113
v_cvt_pk_bf16_f32 v113, v114, v115
v_cvt_pk_bf16_f32 v114, v116, v117
v_cvt_pk_bf16_f32 v115, v118, v119
v_cvt_pk_bf16_f32 v116, v120, v121
v_cvt_pk_bf16_f32 v117, v122, v123
s_cbranch_vccz Lr_66
s_cmp_lg_u32 s42, 0
s_cbranch_scc1 Lk_67
s_lshl_b32 s44, s28, 1
s_lshr_b32 s45, s37, 1
s_add_u32 s44, s44, s45
s_lshl_b32 s44, s44, 10
s_add_u32 s44, s44, 23101440
s_mov_b32 s47, 0
Lpoll_68:
s_mov_b32 exec_lo, 0x3fff
s_mov_b32 exec_hi, 0
buffer_load_dwordx2 v[10:11], v32, s[16:19], s44 offen sc1
s_add_u32 s47, s47, 1
s_cmp_gt_u32 s47, 400000
s_cbranch_scc1 Lpd_69
s_waitcnt vmcnt(0)
v_cmp_ne_u64 s[64:65], s[54:55], v[10:11]
s_mov_b64 exec, -1
s_cmp_lg_u64 s[64:65], 0
s_cbranch_scc0 Lpd_69
s_sleep 4
s_branch Lpoll_68
Lpd_69:
s_mov_b64 exec, -1
s_add_u32 m0, s41, 71680
s_add_u32 s43, s30, 0
buffer_load_dwordx4 v8, s[16:19], s43 offen sc1 lds
s_add_u32 m0, s41, 75776
s_add_u32 s43, s30, 4096
buffer_load_dwordx4 v8, s[16:19], s43 offen sc1 lds
s_add_u32 m0, s41, 90112
s_add_u32 s43, s30, 8192
buffer_load_dwordx4 v8, s[16:19], s43 offen sc1 lds
s_add_u32 m0, s41, 94208
s_add_u32 s43, s30, 12288
buffer_load_dwordx4 v8, s[16:19], s43 offen sc1 lds
s_add_u32 m0, s41, 108544
s_add_u32 s43, s30, 16384
buffer_load_dwordx4 v8, s[16:19], s43 offen sc1 lds
s_add_u32 m0, s41, 112640
s_add_u32 s43, s30, 20480
buffer_load_dwordx4 v8, s[16:19], s43 offen sc1 lds
s_add_u32 m0, s41, 126976
s_add_u32 s43, s30, 24576
buffer_load_dwordx4 v8, s[16:19], s43 offen sc1 lds
s_add_u32 m0, s41, 131072
s_add_u32 s43, s30, 28672
buffer_load_dwordx4 v8, s[16:19], s43 offen sc1 lds
s_add_u32 m0, s41, 145408
s_add_u32 s43, s30, 32768
buffer_load_dwordx4 v8, s[16:19], s43 offen sc1 lds
s_add_u32 m0, s41, 149504
s_add_u32 s43, s30, 36864
buffer_load_dwordx4 v8, s[16:19], s43 offen sc1 lds
s_add_u32 m0, s41, 0
s_add_u32 s43, s30, 40960
buffer_load_dwordx4 v8, s[16:19], s43 offen sc1 lds
s_add_u32 m0, s41, 4096
s_add_u32 s43, s30, 45056
buffer_load_dwordx4 v8, s[16:19], s43 offen sc1 lds
s_add_u32 m0, s41, 18432
s_add_u32 s43, s30, 49152
buffer_load_dwordx4 v8, s[16:19], s43 offen sc1 lds
s_add_u32 m0, s41, 22528
s_add_u32 s43, s30, 53248
buffer_load_dwordx4 v8, s[16:19], s43 offen sc1 lds
Lk_67:
Lr_66:
buffer_store_dwordx4 v[112:115], v12, s[16:19], s58 offen sc1
buffer_store_dwordx2 v[116:117], v13, s[16:19], s59 offen sc1
s_cbranch_vccz L_p3c
s_waitcnt vmcnt(12)
s_barrier
s_add_u32 s43, s31, 71680
s_cmp_lg_u32 s52, 1
s_cbranch_scc1 Lk_70
s_add_u32 m0, s51, 45056
s_nop 0
buffer_load_dwordx4 v9, s[16:19], s43 offen sc1 lds
Lk_70:
s_add_u32 m0, s41, 45056
s_nop 0
buffer_load_dwordx4 v8, s[16:19], s43 offen sc1 lds
s_add_u32 m0, s41, 49152
s_add_u32 s43, s43, 4096
buffer_load_dwordx4 v8, s[16:19], s43 offen sc1 lds
s_add_u32 m0, s41, 36864
s_add_u32 s43, s30, 57344
buffer_load_dwordx4 v8, s[16:19], s43 offen sc1 lds
s_add_u32 m0, s41, 40960
s_add_u32 s43, s30, 61440
buffer_load_dwordx4 v8, s[16:19], s43 offen sc1 lds
s_waitcnt vmcnt(10)
s_barrier
s_add_u32 s43, s31, 81920
s_cmp_lg_u32 s52, 0
s_cbranch_scc1 Lk_71
s_add_u32 m0, s51, 79872
s_nop 0
buffer_load_dwordx4 v9, s[16:19], s43 offen sc1 lds
Lk_71:
s_add_u32 m0, s41, 79872
s_nop 0
buffer_load_dwordx4 v8, s[16:19], s43 offen sc1 lds
s_add_u32 m0, s41, 83968
s_add_u32 s43, s43, 4096
buffer_load_dwordx4 v8, s[16:19], s43 offen sc1 lds
s_add_u32 m0, s41, 71680
s_add_u32 s43, s30, 65536
buffer_load_dwordx4 v8, s[16:19], s43 offen sc1 lds
s_add_u32 m0, s41, 75776
s_add_u32 s43, s30, 69632
buffer_load_dwordx4 v8, s[16:19], s43 offen sc1 lds
s_add_u32 s43, s31, 92160
s_cmp_lg_u32 s52, 1
s_cbranch_scc1 Lk_72
s_add_u32 m0, s51, 98304
s_nop 0
buffer_load_dwordx4 v9, s[16:19], s43 offen sc1 lds
Lk_72:
s_add_u32 m0, s41, 98304
s_nop 0
buffer_load_dwordx4 v8, s[16:19], s43 offen sc1 lds
s_add_u32 m0, s41, 102400
s_add_u32 s43, s43, 4096
buffer_load_dwordx4 v8, s[16:19], s43 offen sc1 lds
s_add_u32 m0, s41, 90112
s_add_u32 s43, s30, 73728
buffer_load_dwordx4 v8, s[16:19], s43 offen sc1 lds
s_add_u32 m0, s41, 94208
s_add_u32 s43, s30, 77824
buffer_load_dwordx4 v8, s[16:19], s43 offen sc1 lds
s_waitcnt vmcnt(8)
s_barrier
s_add_u32 s43, s31, 102400
s_cmp_lg_u32 s52, 0
s_cbranch_scc1 Lk_73
s_add_u32 m0, s51, 116736
s_nop 0
buffer_load_dwordx4 v9, s[16:19], s43 offen sc1 lds
Lk_73:
s_add_u32 m0, s41, 116736
s_nop 0
buffer_load_dwordx4 v8, s[16:19], s43 offen sc1 lds
s_add_u32 m0, s41, 120832
s_add_u32 s43, s43, 4096
buffer_load_dwordx4 v8, s[16:19], s43 offen sc1 lds
s_add_u32 m0, s41, 108544
s_add_u32 s43, s30, 81920
buffer_load_dwordx4 v8, s[16:19], s43 offen sc1 lds
s_add_u32 m0, s41, 112640
s_add_u32 s43, s30, 86016
buffer_load_dwordx4 v8, s[16:19], s43 offen sc1 lds
s_add_u32 s43, s31, 112640
s_cmp_lg_u32 s52, 1
s_cbranch_scc1 Lk_74
s_add_u32 m0, s51, 135168
s_nop 0
buffer_load_dwordx4 v9, s[16:19], s43 offen sc1 lds
Lk_74:
s_add_u32 m0, s41, 135168
s_nop 0
buffer_load_dwordx4 v8, s[16:19], s43 offen sc1 lds
s_add_u32 m0, s41, 139264
s_add_u32 s43, s43, 4096
buffer_load_dwordx4 v8, s[16:19], s43 offen sc1 lds
s_add_u32 m0, s41, 126976
s_add_u32 s43, s30, 90112
buffer_load_dwordx4 v8, s[16:19], s43 offen sc1 lds
s_add_u32 m0, s41, 131072
s_add_u32 s43, s30, 94208
buffer_load_dwordx4 v8, s[16:19], s43 offen sc1 lds
s_waitcnt vmcnt(12)
s_barrier
s_add_u32 s43, s31, 122880
s_cmp_lg_u32 s52, 0
s_cbranch_scc1 Lk_75
s_add_u32 m0, s51, 153600
s_nop 0
buffer_load_dwordx4 v9, s[16:19], s43 offen sc1 lds
Lk_75:
s_add_u32 m0, s41, 153600
s_nop 0
buffer_load_dwordx4 v8, s[16:19], s43 offen sc1 lds
s_add_u32 m0, s41, 157696
s_add_u32 s43, s43, 4096
buffer_load_dwordx4 v8, s[16:19], s43 offen sc1 lds
s_add_u32 m0, s41, 145408
s_add_u32 s43, s30, 98304
buffer_load_dwordx4 v8, s[16:19], s43 offen sc1 lds
s_add_u32 m0, s41, 149504
s_add_u32 s43, s30, 102400
buffer_load_dwordx4 v8, s[16:19], s43 offen sc1 lds
s_waitcnt vmcnt(12)
s_barrier
s_add_u32 s43, s31, 133120
s_cmp_lg_u32 s52, 1
s_cbranch_scc1 Lk_76
s_add_u32 m0, s51, 8192
s_nop 0
buffer_load_dwordx4 v9, s[16:19], s43 offen sc1 lds
Lk_76:
s_add_u32 m0, s41, 8192
s_nop 0
buffer_load_dwordx4 v8, s[16:19], s43 offen sc1 lds
s_add_u32 m0, s41, 12288
s_add_u32 s43, s43, 4096
buffer_load_dwordx4 v8, s[16:19], s43 offen sc1 lds
s_add_u32 m0, s41, 0
s_add_u32 s43, s30, 106496
buffer_load_dwordx4 v8, s[16:19], s43 offen sc1 lds
s_add_u32 m0, s41, 4096
s_add_u32 s43, s30, 110592
buffer_load_dwordx4 v8, s[16:19], s43 offen sc1 lds
s_waitcnt vmcnt(12)
s_barrier
s_add_u32 s43, s31, 143360
s_cmp_lg_u32 s52, 0
s_cbranch_scc1 Lk_77
s_add_u32 m0, s51, 26624
s_nop 0
buffer_load_dwordx4 v9, s[16:19], s43 offen sc1 lds
Lk_77:
s_add_u32 m0, s41, 26624
s_nop 0
buffer_load_dwordx4 v8, s[16:19], s43 offen sc1 lds
s_add_u32 m0, s41, 30720
s_add_u32 s43, s43, 4096
buffer_load_dwordx4 v8, s[16:19], s43 offen sc1 lds
s_add_u32 m0, s41, 18432
s_add_u32 s43, s30, 114688
buffer_load_dwordx4 v8, s[16:19], s43 offen sc1 lds
s_add_u32 m0, s41, 22528
s_add_u32 s43, s30, 118784
buffer_load_dwordx4 v8, s[16:19], s43 offen sc1 lds
s_waitcnt vmcnt(12)
s_barrier
s_add_u32 s43, s31, 153600
s_cmp_lg_u32 s52, 1
s_cbranch_scc1 Lk_78
s_add_u32 m0, s51, 45056
s_nop 0
buffer_load_dwordx4 v9, s[16:19], s43 offen sc1 lds
Lk_78:
s_add_u32 m0, s41, 45056
s_nop 0
buffer_load_dwordx4 v8, s[16:19], s43 offen sc1 lds
s_add_u32 m0, s41, 49152
s_add_u32 s43, s43, 4096
buffer_load_dwordx4 v8, s[16:19], s43 offen sc1 lds
s_add_u32 m0, s41, 36864
s_add_u32 s43, s30, 122880
buffer_load_dwordx4 v8, s[16:19], s43 offen sc1 lds
s_add_u32 m0, s41, 40960
s_add_u32 s43, s30, 126976
buffer_load_dwordx4 v8, s[16:19], s43 offen sc1 lds
s_waitcnt vmcnt(12)
s_barrier
s_add_u32 s43, s31, 163840
s_cmp_lg_u32 s52, 0
s_cbranch_scc1 Lk_79
s_add_u32 m0, s51, 79872
s_nop 0
buffer_load_dwordx4 v9, s[16:19], s43 offen sc1 lds
Lk_79:
s_add_u32 m0, s41, 79872
s_nop 0
buffer_load_dwordx4 v8, s[16:19], s43 offen sc1 lds
s_add_u32 m0, s41, 83968
s_add_u32 s43, s43, 4096
buffer_load_dwordx4 v8, s[16:19], s43 offen sc1 lds
s_add_u32 m0, s41, 71680
s_add_u32 s43, s30, 131072
buffer_load_dwordx4 v8, s[16:19], s43 offen sc1 lds
s_add_u32 m0, s41, 75776
s_add_u32 s43, s30, 135168
buffer_load_dwordx4 v8, s[16:19], s43 offen sc1 lds
s_waitcnt vmcnt(12)
s_barrier
s_add_u32 s43, s31, 174080
s_cmp_lg_u32 s52, 1
s_cbranch_scc1 Lk_80
s_add_u32 m0, s51, 98304
s_nop 0
buffer_load_dwordx4 v9, s[16:19], s43 offen sc1 lds
Lk_80:
s_add_u32 m0, s41, 98304
s_nop 0
buffer_load_dwordx4 v8, s[16:19], s43 offen sc1 lds
s_add_u32 m0, s41, 102400
s_add_u32 s43, s43, 4096
buffer_load_dwordx4 v8, s[16:19], s43 offen sc1 lds
s_add_u32 m0, s41, 90112
s_add_u32 s43, s30, 139264
buffer_load_dwordx4 v8, s[16:19], s43 offen sc1 lds
s_add_u32 m0, s41, 94208
s_add_u32 s43, s30, 143360
buffer_load_dwordx4 v8, s[16:19], s43 offen sc1 lds
s_waitcnt vmcnt(12)
s_barrier
s_add_u32 s43, s31, 184320
s_cmp_lg_u32 s52, 0
s_cbranch_scc1 Lk_81
s_add_u32 m0, s51, 116736
s_nop 0
buffer_load_dwordx4 v9, s[16:19], s43 offen sc1 lds
Lk_81:
s_add_u32 m0, s41, 116736
s_nop 0
buffer_load_dwordx4 v8, s[16:19], s43 offen sc1 lds
s_add_u32 m0, s41, 120832
s_add_u32 s43, s43, 4096
buffer_load_dwordx4 v8, s[16:19], s43 offen sc1 lds
s_add_u32 m0, s41, 108544
s_add_u32 s43, s30, 147456
buffer_load_dwordx4 v8, s[16:19], s43 offen sc1 lds
s_add_u32 m0, s41, 112640
s_add_u32 s43, s30, 151552
buffer_load_dwordx4 v8, s[16:19], s43 offen sc1 lds
s_waitcnt vmcnt(12)
s_barrier
s_add_u32 s43, s31, 194560
s_cmp_lg_u32 s52, 1
s_cbranch_scc1 Lk_82
s_add_u32 m0, s51, 135168
s_nop 0
buffer_load_dwordx4 v9, s[16:19], s43 offen sc1 lds
Lk_82:
s_add_u32 m0, s41, 135168
s_nop 0
buffer_load_dwordx4 v8, s[16:19], s43 offen sc1 lds
s_add_u32 m0, s41, 139264
s_add_u32 s43, s43, 4096
buffer_load_dwordx4 v8, s[16:19], s43 offen sc1 lds
s_add_u32 m0, s41, 126976
s_add_u32 s43, s30, 155648
buffer_load_dwordx4 v8, s[16:19], s43 offen sc1 lds
s_add_u32 m0, s41, 131072
s_add_u32 s43, s30, 159744
buffer_load_dwordx4 v8, s[16:19], s43 offen sc1 lds
s_waitcnt vmcnt(12)
s_barrier
s_add_u32 s43, s31, 204800
s_cmp_lg_u32 s52, 0
s_cbranch_scc1 Lk_83
s_add_u32 m0, s51, 153600
s_nop 0
buffer_load_dwordx4 v9, s[16:19], s43 offen sc1 lds
Lk_83:
s_add_u32 m0, s41, 153600
s_nop 0
buffer_load_dwordx4 v8, s[16:19], s43 offen sc1 lds
s_add_u32 m0, s41, 157696
s_add_u32 s43, s43, 4096
buffer_load_dwordx4 v8, s[16:19], s43 offen sc1 lds
s_add_u32 m0, s41, 145408
s_add_u32 s43, s30, 163840
buffer_load_dwordx4 v8, s[16:19], s43 offen sc1 lds
s_add_u32 m0, s41, 149504
s_add_u32 s43, s30, 167936
buffer_load_dwordx4 v8, s[16:19], s43 offen sc1 lds
s_waitcnt vmcnt(12)
s_barrier
s_add_u32 s43, s31, 215040
s_cmp_lg_u32 s52, 1
s_cbranch_scc1 Lk_84
s_add_u32 m0, s51, 8192
s_nop 0
buffer_load_dwordx4 v9, s[16:19], s43 offen sc1 lds
Lk_84:
s_add_u32 m0, s41, 8192
s_nop 0
buffer_load_dwordx4 v8, s[16:19], s43 offen sc1 lds
s_add_u32 m0, s41, 12288
s_add_u32 s43, s43, 4096
buffer_load_dwordx4 v8, s[16:19], s43 offen sc1 lds
s_add_u32 m0, s41, 0
s_add_u32 s43, s30, 172032
buffer_load_dwordx4 v8, s[16:19], s43 offen sc1 lds
s_add_u32 m0, s41, 4096
s_add_u32 s43, s30, 176128
buffer_load_dwordx4 v8, s[16:19], s43 offen sc1 lds
s_waitcnt vmcnt(12)
s_barrier
s_add_u32 s43, s31, 225280
s_cmp_lg_u32 s52, 0
s_cbranch_scc1 Lk_85
s_add_u32 m0, s51, 26624
s_nop 0
buffer_load_dwordx4 v9, s[16:19], s43 offen sc1 lds
Lk_85:
s_add_u32 m0, s41, 26624
s_nop 0
buffer_load_dwordx4 v8, s[16:19], s43 offen sc1 lds
s_add_u32 m0, s41, 30720
s_add_u32 s43, s43, 4096
buffer_load_dwordx4 v8, s[16:19], s43 offen sc1 lds
s_add_u32 m0, s41, 18432
s_add_u32 s43, s30, 180224
buffer_load_dwordx4 v8, s[16:19], s43 offen sc1 lds
s_add_u32 m0, s41, 22528
s_add_u32 s43, s30, 184320
buffer_load_dwordx4 v8, s[16:19], s43 offen sc1 lds
s_waitcnt vmcnt(12)
s_barrier
s_add_u32 s43, s31, 235520
s_cmp_lg_u32 s52, 1
s_cbranch_scc1 Lk_86
s_add_u32 m0, s51, 45056
s_nop 0
buffer_load_dwordx4 v9, s[16:19], s43 offen sc1 lds
Lk_86:
s_add_u32 m0, s41, 45056
s_nop 0
buffer_load_dwordx4 v8, s[16:19], s43 offen sc1 lds
s_add_u32 m0, s41, 49152
s_add_u32 s43, s43, 4096
buffer_load_dwordx4 v8, s[16:19], s43 offen sc1 lds
s_add_u32 m0, s41, 36864
s_add_u32 s43, s30, 188416
buffer_load_dwordx4 v8, s[16:19], s43 offen sc1 lds
s_add_u32 m0, s41, 40960
s_add_u32 s43, s30, 192512
buffer_load_dwordx4 v8, s[16:19], s43 offen sc1 lds
s_waitcnt vmcnt(12)
s_barrier
s_add_u32 s43, s31, 245760
s_cmp_lg_u32 s52, 0
s_cbranch_scc1 Lk_87
s_add_u32 m0, s51, 79872
s_nop 0
buffer_load_dwordx4 v9, s[16:19], s43 offen sc1 lds
Lk_87:
s_add_u32 m0, s41, 79872
s_nop 0
buffer_load_dwordx4 v8, s[16:19], s43 offen sc1 lds
s_add_u32 m0, s41, 83968
s_add_u32 s43, s43, 4096
buffer_load_dwordx4 v8, s[16:19], s43 offen sc1 lds
s_add_u32 m0, s41, 71680
s_add_u32 s43, s30, 196608
buffer_load_dwordx4 v8, s[16:19], s43 offen sc1 lds
s_add_u32 m0, s41, 75776
s_add_u32 s43, s30, 200704
buffer_load_dwordx4 v8, s[16:19], s43 offen sc1 lds
s_waitcnt vmcnt(12)
s_barrier
s_lshr_b32 s44, s28, 1
s_lshl_b32 s44, s44, 10
s_add_u32 s44, s44, 23085056
s_mov_b64 exec, 0xffff
buffer_load_dwordx2 v[10:11], v32, s[16:19], s44 offen sc1
s_mov_b64 exec, -1
s_add_u32 s43, s31, 256000
s_cmp_lg_u32 s52, 1
s_cbranch_scc1 Lk_88
s_add_u32 m0, s51, 98304
s_nop 0
buffer_load_dwordx4 v9, s[16:19], s43 offen sc1 lds
Lk_88:
s_add_u32 m0, s41, 98304
s_nop 0
buffer_load_dwordx4 v8, s[16:19], s43 offen sc1 lds
s_add_u32 m0, s41, 102400
s_add_u32 s43, s43, 4096
buffer_load_dwordx4 v8, s[16:19], s43 offen sc1 lds
s_add_u32 m0, s41, 90112
s_add_u32 s43, s30, 204800
buffer_load_dwordx4 v8, s[16:19], s43 offen sc1 lds
s_add_u32 m0, s41, 94208
s_add_u32 s43, s30, 208896
buffer_load_dwordx4 v8, s[16:19], s43 offen sc1 lds
s_waitcnt vmcnt(13)
s_barrier
s_add_u32 s43, s31, 266240
s_cmp_lg_u32 s52, 0
s_cbranch_scc1 Lk_89
s_add_u32 m0, s51, 116736
s_nop 0
buffer_load_dwordx4 v9, s[16:19], s43 offen sc1 lds
Lk_89:
s_add_u32 m0, s41, 116736
s_nop 0
buffer_load_dwordx4 v8, s[16:19], s43 offen sc1 lds
s_add_u32 m0, s41, 120832
s_add_u32 s43, s43, 4096
buffer_load_dwordx4 v8, s[16:19], s43 offen sc1 lds
s_add_u32 m0, s41, 108544
s_add_u32 s43, s30, 212992
buffer_load_dwordx4 v8, s[16:19], s43 offen sc1 lds
s_add_u32 m0, s41, 112640
s_add_u32 s43, s30, 217088
buffer_load_dwordx4 v8, s[16:19], s43 offen sc1 lds
s_waitcnt vmcnt(13)
s_barrier
s_add_u32 s43, s31, 276480
s_cmp_lg_u32 s52, 1
s_cbranch_scc1 Lk_90
s_add_u32 m0, s51, 135168
s_nop 0
buffer_load_dwordx4 v9, s[16:19], s43 offen sc1 lds
Lk_90:
s_add_u32 m0, s41, 135168
s_nop 0
buffer_load_dwordx4 v8, s[16:19], s43 offen sc1 lds
s_add_u32 m0, s41, 139264
s_add_u32 s43, s43, 4096
buffer_load_dwordx4 v8, s[16:19], s43 offen sc1 lds
s_waitcnt vmcnt(10)
s_mov_b64 exec, 0xffff
v_cmp_ne_u64 s[64:65], s[54:55], v[10:11]
s_mov_b64 exec, -1
s_cmp_lg_u64 s[64:65], 0
s_cbranch_scc0 Lk_91
s_mov_b32 s47, 0
Lpoll_92:
s_mov_b32 exec_lo, 0xffff
s_mov_b32 exec_hi, 0
buffer_load_dwordx2 v[10:11], v32, s[16:19], s44 offen sc1
s_add_u32 s47, s47, 1
s_cmp_gt_u32 s47, 400000
s_cbranch_scc1 Lpd_93
s_waitcnt vmcnt(0)
v_cmp_ne_u64 s[64:65], s[54:55], v[10:11]
s_mov_b64 exec, -1
s_cmp_lg_u64 s[64:65], 0
s_cbranch_scc0 Lpd_93
s_sleep 4
s_branch Lpoll_92
Lpd_93:
s_mov_b64 exec, -1
Lk_91:
s_add_u32 m0, s41, 126976
s_add_u32 s43, s30, 221184
buffer_load_dwordx4 v8, s[16:19], s43 offen sc1 lds
s_add_u32 m0, s41, 131072
s_add_u32 s43, s30, 225280
buffer_load_dwordx4 v8, s[16:19], s43 offen sc1 lds
s_barrier
s_add_u32 s43, s31, 286720
s_cmp_lg_u32 s52, 0
s_cbranch_scc1 Lk_94
s_add_u32 m0, s51, 153600
s_nop 0
buffer_load_dwordx4 v9, s[16:19], s43 offen sc1 lds
Lk_94:
s_add_u32 m0, s41, 153600
s_nop 0
buffer_load_dwordx4 v8, s[16:19], s43 offen sc1 lds
s_add_u32 m0, s41, 157696
s_add_u32 s43, s43, 4096
buffer_load_dwordx4 v8, s[16:19], s43 offen sc1 lds
s_add_u32 m0, s41, 145408
s_add_u32 s43, s30, 229376
buffer_load_dwordx4 v8, s[16:19], s43 offen sc1 lds
s_add_u32 m0, s41, 149504
s_add_u32 s43, s30, 233472
buffer_load_dwordx4 v8, s[16:19], s43 offen sc1 lds
s_waitcnt vmcnt(12)
s_barrier
s_add_u32 s43, s31, 296960
s_cmp_lg_u32 s52, 1
s_cbranch_scc1 Lk_95
s_add_u32 m0, s51, 8192
s_nop 0
buffer_load_dwordx4 v9, s[16:19], s43 offen sc1 lds
Lk_95:
s_add_u32 m0, s41, 8192
s_nop 0
buffer_load_dwordx4 v8, s[16:19], s43 offen sc1 lds
s_add_u32 m0, s41, 12288
s_add_u32 s43, s43, 4096
buffer_load_dwordx4 v8, s[16:19], s43 offen sc1 lds
s_add_u32 m0, s41, 0
s_add_u32 s43, s30, 237568
buffer_load_dwordx4 v8, s[16:19], s43 offen sc1 lds
s_add_u32 m0, s41, 4096
s_add_u32 s43, s30, 241664
buffer_load_dwordx4 v8, s[16:19], s43 offen sc1 lds
s_waitcnt vmcnt(12)
s_barrier
s_add_u32 s43, s31, 307200
s_cmp_lg_u32 s52, 0
s_cbranch_scc1 Lk_96
s_add_u32 m0, s51, 26624
s_nop 0
buffer_load_dwordx4 v9, s[16:19], s43 offen sc1 lds
Lk_96:
s_add_u32 m0, s41, 26624
s_nop 0
buffer_load_dwordx4 v8, s[16:19], s43 offen sc1 lds
s_add_u32 m0, s41, 30720
s_add_u32 s43, s43, 4096
buffer_load_dwordx4 v8, s[16:19], s43 offen sc1 lds
s_add_u32 m0, s41, 18432
s_add_u32 s43, s30, 245760
buffer_load_dwordx4 v8, s[16:19], s43 offen sc1 lds
s_add_u32 m0, s41, 22528
s_add_u32 s43, s30, 249856
buffer_load_dwordx4 v8, s[16:19], s43 offen sc1 lds
s_waitcnt vmcnt(12)
s_barrier
s_add_u32 s43, s31, 317440
s_cmp_lg_u32 s52, 1
s_cbranch_scc1 Lk_97
s_add_u32 m0, s51, 45056
s_nop 0
buffer_load_dwordx4 v9, s[16:19], s43 offen sc1 lds
Lk_97:
s_add_u32 m0, s41, 45056
s_nop 0
buffer_load_dwordx4 v8, s[16:19], s43 offen sc1 lds
s_add_u32 m0, s41, 49152
s_add_u32 s43, s43, 4096
buffer_load_dwordx4 v8, s[16:19], s43 offen sc1 lds
s_add_u32 m0, s41, 36864
s_add_u32 s43, s30, 253952
buffer_load_dwordx4 v8, s[16:19], s43 offen sc1 lds
s_add_u32 m0, s41, 40960
s_add_u32 s43, s30, 258048
buffer_load_dwordx4 v8, s[16:19], s43 offen sc1 lds
s_waitcnt vmcnt(12)
s_barrier
s_add_u32 s43, s31, 327680
s_cmp_lg_u32 s52, 0
s_cbranch_scc1 Lk_98
s_add_u32 m0, s51, 79872
s_nop 0
buffer_load_dwordx4 v9, s[16:19], s43 offen sc1 lds
Lk_98:
s_add_u32 m0, s41, 79872
s_nop 0
buffer_load_dwordx4 v8, s[16:19], s43 offen sc1 lds
s_add_u32 m0, s41, 83968
s_add_u32 s43, s43, 4096
buffer_load_dwordx4 v8, s[16:19], s43 offen sc1 lds
s_add_u32 m0, s41, 71680
s_add_u32 s43, s30, 262144
buffer_load_dwordx4 v8, s[16:19], s43 offen sc1 lds
s_add_u32 m0, s41, 75776
s_add_u32 s43, s30, 266240
buffer_load_dwordx4 v8, s[16:19], s43 offen sc1 lds
s_waitcnt vmcnt(12)
s_barrier
s_add_u32 s43, s31, 337920
s_cmp_lg_u32 s52, 1
s_cbranch_scc1 Lk_99
s_add_u32 m0, s51, 98304
s_nop 0
buffer_load_dwordx4 v9, s[16:19], s43 offen sc1 lds
Lk_99:
s_add_u32 m0, s41, 98304
s_nop 0
buffer_load_dwordx4 v8, s[16:19], s43 offen sc1 lds
s_add_u32 m0, s41, 102400
s_add_u32 s43, s43, 4096
buffer_load_dwordx4 v8, s[16:19], s43 offen sc1 lds
s_add_u32 m0, s41, 90112
s_add_u32 s43, s30, 270336
buffer_load_dwordx4 v8, s[16:19], s43 offen sc1 lds
s_add_u32 m0, s41, 94208
s_add_u32 s43, s30, 274432
buffer_load_dwordx4 v8, s[16:19], s43 offen sc1 lds
s_waitcnt vmcnt(12)
s_barrier
s_add_u32 s43, s31, 348160
s_cmp_lg_u32 s52, 0
s_cbranch_scc1 Lk_100
s_add_u32 m0, s51, 116736
s_nop 0
buffer_load_dwordx4 v9, s[16:19], s43 offen sc1 lds
Lk_100:
s_add_u32 m0, s41, 116736
s_nop 0
buffer_load_dwordx4 v8, s[16:19], s43 offen sc1 lds
s_add_u32 m0, s41, 120832
s_add_u32 s43, s43, 4096
buffer_load_dwordx4 v8, s[16:19], s43 offen sc1 lds
s_add_u32 m0, s41, 108544
s_add_u32 s43, s30, 278528
buffer_load_dwordx4 v8, s[16:19], s43 offen sc1 lds
s_add_u32 m0, s41, 112640
s_add_u32 s43, s30, 282624
buffer_load_dwordx4 v8, s[16:19], s43 offen sc1 lds
s_waitcnt vmcnt(12)
s_barrier
s_add_u32 s43, s31, 358400
s_cmp_lg_u32 s52, 1
s_cbranch_scc1 Lk_101
s_add_u32 m0, s51, 135168
s_nop 0
buffer_load_dwordx4 v9, s[16:19], s43 offen sc1 lds
Lk_101:
s_add_u32 m0, s41, 135168
s_nop 0
buffer_load_dwordx4 v8, s[16:19], s43 offen sc1 lds
s_add_u32 m0, s41, 139264
s_add_u32 s43, s43, 4096
buffer_load_dwordx4 v8, s[16:19], s43 offen sc1 lds
s_add_u32 m0, s41, 126976
s_add_u32 s43, s30, 286720
buffer_load_dwordx4 v8, s[16:19], s43 offen sc1 lds
s_add_u32 m0, s41, 131072
s_add_u32 s43, s30, 290816
buffer_load_dwordx4 v8, s[16:19], s43 offen sc1 lds
s_waitcnt vmcnt(12)
s_barrier
s_add_u32 s43, s31, 368640
s_cmp_lg_u32 s52, 0
s_cbranch_scc1 Lk_102
s_add_u32 m0, s51, 153600
s_nop 0
buffer_load_dwordx4 v9, s[16:19], s43 offen sc1 lds
Lk_102:
s_add_u32 m0, s41, 153600
s_nop 0
buffer_load_dwordx4 v8, s[16:19], s43 offen sc1 lds
s_add_u32 m0, s41, 157696
s_add_u32 s43, s43, 4096
buffer_load_dwordx4 v8, s[16:19], s43 offen sc1 lds
s_add_u32 m0, s41, 145408
s_add_u32 s43, s30, 294912
buffer_load_dwordx4 v8, s[16:19], s43 offen sc1 lds
s_add_u32 m0, s41, 149504
s_add_u32 s43, s30, 299008
buffer_load_dwordx4 v8, s[16:19], s43 offen sc1 lds
s_waitcnt vmcnt(12)
s_barrier
s_waitcnt vmcnt(8)
s_barrier
s_waitcnt vmcnt(4)
s_barrier
s_waitcnt vmcnt(0)
s_barrier
s_branch L_fin
L_p3c:
.p2align 3
s_setprio 2
s_barrier
ds_read_b128 v[144:147], v48 offset:0
ds_read_b128 v[148:151], v51 offset:0
ds_read_b128 v[152:155], v51 offset:1024
ds_read_b128 v[156:159], v51 offset:2048
ds_read_b128 v[160:163], v51 offset:3072
ds_read_b128 v[164:167], v51 offset:4096
ds_read_b128 v[168:171], v48 offset:4096
ds_read_b128 v[172:175], v51 offset:5120
ds_read_b128 v[176:179], v51 offset:6144
ds_read_b128 v[180:183], v51 offset:7168
ds_read_b128 v[184:187], v51 offset:8192
ds_read_b128 v[188:191], v51 offset:9216
s_waitcnt lgkmcnt(0)
v_mfma_f32_16x16x32_bf16 v[64:67], v[148:151], v[144:147], 0
ds_read_b128 v[192:195], v48 offset:18432
ds_read_b128 v[196:199], v51 offset:18432
v_mfma_f32_16x16x32_bf16 v[68:71], v[152:155], v[144:147], 0
ds_read_b128 v[200:203], v51 offset:19456
ds_read_b128 v[204:207], v51 offset:20480
v_mfma_f32_16x16x32_bf16 v[72:75], v[156:159], v[144:147], 0
ds_read_b128 v[208:211], v51 offset:21504
ds_read_b128 v[212:215], v51 offset:22528
v_mfma_f32_16x16x32_bf16 v[76:79], v[160:163], v[144:147], 0
ds_read_b128 v[216:219], v48 offset:22528
ds_read_b128 v[220:223], v51 offset:23552
v_mfma_f32_16x16x32_bf16 v[80:83], v[164:167], v[144:147], 0
ds_read_b128 v[224:227], v51 offset:24576
ds_read_b128 v[228:231], v51 offset:25600
v_mfma_f32_16x16x32_bf16 v[64:67], v[172:175], v[168:171], v[64:67]
ds_read_b128 v[232:235], v51 offset:26624
ds_read_b128 v[236:239], v51 offset:27648
v_mfma_f32_16x16x32_bf16 v[68:71], v[176:179], v[168:171], v[68:71]
v_mfma_f32_16x16x32_bf16 v[72:75], v[180:183], v[168:171], v[72:75]
v_mfma_f32_16x16x32_bf16 v[76:79], v[184:187], v[168:171], v[76:79]
v_mfma_f32_16x16x32_bf16 v[80:83], v[188:191], v[168:171], v[80:83]
s_waitcnt lgkmcnt(0)
s_barrier
v_mfma_f32_16x16x32_bf16 v[64:67], v[196:199], v[192:195], v[64:67]
ds_read_b128 v[144:147], v48 offset:36864
ds_read_b128 v[148:151], v51 offset:36864
v_mfma_f32_16x16x32_bf16 v[68:71], v[200:203], v[192:195], v[68:71]
ds_read_b128 v[152:155], v51 offset:37888
ds_read_b128 v[156:159], v51 offset:38912
v_mfma_f32_16x16x32_bf16 v[72:75], v[204:207], v[192:195], v[72:75]
ds_read_b128 v[160:163], v51 offset:39936
ds_read_b128 v[164:167], v51 offset:40960
v_mfma_f32_16x16x32_bf16 v[76:79], v[208:211], v[192:195], v[76:79]
ds_read_b128 v[168:171], v48 offset:40960
ds_read_b128 v[172:175], v51 offset:41984
v_mfma_f32_16x16x32_bf16 v[80:83], v[212:215], v[192:195], v[80:83]
ds_read_b128 v[176:179], v51 offset:43008
ds_read_b128 v[180:183], v51 offset:44032
v_mfma_f32_16x16x32_bf16 v[64:67], v[220:223], v[216:219], v[64:67]
ds_read_b128 v[184:187], v51 offset:45056
ds_read_b128 v[188:191], v51 offset:46080
v_mfma_f32_16x16x32_bf16 v[68:71], v[224:227], v[216:219], v[68:71]
v_mfma_f32_16x16x32_bf16 v[72:75], v[228:231], v[216:219], v[72:75]
v_mfma_f32_16x16x32_bf16 v[76:79], v[232:235], v[216:219], v[76:79]
v_mfma_f32_16x16x32_bf16 v[80:83], v[236:239], v[216:219], v[80:83]
s_waitcnt lgkmcnt(0)
v_mfma_f32_16x16x32_bf16 v[64:67], v[148:151], v[144:147], v[64:67]
ds_read_b128 v[192:195], v49 offset:0
ds_read_b128 v[196:199], v52 offset:0
v_mfma_f32_16x16x32_bf16 v[68:71], v[152:155], v[144:147], v[68:71]
ds_read_b128 v[200:203], v52 offset:1024
ds_read_b128 v[204:207], v52 offset:2048
v_mfma_f32_16x16x32_bf16 v[72:75], v[156:159], v[144:147], v[72:75]
ds_read_b128 v[208:211], v52 offset:3072
ds_read_b128 v[212:215], v52 offset:4096
v_mfma_f32_16x16x32_bf16 v[76:79], v[160:163], v[144:147], v[76:79]
ds_read_b128 v[216:219], v49 offset:4096
ds_read_b128 v[220:223], v52 offset:5120
v_mfma_f32_16x16x32_bf16 v[80:83], v[164:167], v[144:147], v[80:83]
ds_read_b128 v[224:227], v52 offset:6144
ds_read_b128 v[228:231], v52 offset:7168
v_mfma_f32_16x16x32_bf16 v[64:67], v[172:175], v[168:171], v[64:67]
ds_read_b128 v[232:235], v52 offset:8192
ds_read_b128 v[236:239], v52 offset:9216
v_mfma_f32_16x16x32_bf16 v[68:71], v[176:179], v[168:171], v[68:71]
v_mfma_f32_16x16x32_bf16 v[72:75], v[180:183], v[168:171], v[72:75]
v_mfma_f32_16x16x32_bf16 v[76:79], v[184:187], v[168:171], v[76:79]
v_mfma_f32_16x16x32_bf16 v[80:83], v[188:191], v[168:171], v[80:83]
s_waitcnt lgkmcnt(0)
v_mfma_f32_16x16x32_bf16 v[64:67], v[196:199], v[192:195], v[64:67]
ds_read_b128 v[144:147], v49 offset:18432
ds_read_b128 v[148:151], v52 offset:18432
v_mfma_f32_16x16x32_bf16 v[68:71], v[200:203], v[192:195], v[68:71]
ds_read_b128 v[152:155], v52 offset:19456
ds_read_b128 v[156:159], v52 offset:20480
v_mfma_f32_16x16x32_bf16 v[72:75], v[204:207], v[192:195], v[72:75]
ds_read_b128 v[160:163], v52 offset:21504
ds_read_b128 v[164:167], v52 offset:22528
v_mfma_f32_16x16x32_bf16 v[76:79], v[208:211], v[192:195], v[76:79]
ds_read_b128 v[168:171], v49 offset:22528
ds_read_b128 v[172:175], v52 offset:23552
v_mfma_f32_16x16x32_bf16 v[80:83], v[212:215], v[192:195], v[80:83]
ds_read_b128 v[176:179], v52 offset:24576
ds_read_b128 v[180:183], v52 offset:25600
v_mfma_f32_16x16x32_bf16 v[64:67], v[220:223], v[216:219], v[64:67]
ds_read_b128 v[184:187], v52 offset:26624
ds_read_b128 v[188:191], v52 offset:27648
v_mfma_f32_16x16x32_bf16 v[68:71], v[224:227], v[216:219], v[68:71]
v_mfma_f32_16x16x32_bf16 v[72:75], v[228:231], v[216:219], v[72:75]
v_mfma_f32_16x16x32_bf16 v[76:79], v[232:235], v[216:219], v[76:79]
v_mfma_f32_16x16x32_bf16 v[80:83], v[236:239], v[216:219], v[80:83]
s_waitcnt vmcnt(0) lgkmcnt(0)
s_barrier
s_cmp_lg_u32 s36, 4
s_cbranch_scc1 Lk_103
s_lshl_b32 s43, s48, 4
s_add_u32 s43, s43, s49
s_lshl_b32 s43, s43, 6
s_add_u32 s43, s43, 23085056
v_mov_b32 v2, s54
v_mov_b32 v3, s55
s_mov_b64 exec, 1
buffer_store_dwordx2 v[2:3], off, s[16:19], s43 sc1
s_mov_b64 exec, -1
Lk_103:
v_mfma_f32_16x16x32_bf16 v[64:67], v[148:151], v[144:147], v[64:67]
ds_read_b128 v[192:195], v50 offset:0
ds_read_b128 v[196:199], v53 offset:0
v_mfma_f32_16x16x32_bf16 v[68:71], v[152:155], v[144:147], v[68:71]
ds_read_b128 v[200:203], v53 offset:1024
ds_read_b128 v[204:207], v53 offset:2048
v_mfma_f32_16x16x32_bf16 v[72:75], v[156:159], v[144:147], v[72:75]
ds_read_b128 v[208:211], v53 offset:3072
ds_read_b128 v[212:215], v53 offset:4096
v_mfma_f32_16x16x32_bf16 v[76:79], v[160:163], v[144:147], v[76:79]
ds_read_b128 v[216:219], v50 offset:4096
ds_read_b128 v[220:223], v53 offset:5120
v_mfma_f32_16x16x32_bf16 v[80:83], v[164:167], v[144:147], v[80:83]
ds_read_b128 v[224:227], v53 offset:6144
ds_read_b128 v[228:231], v53 offset:7168
v_mfma_f32_16x16x32_bf16 v[64:67], v[172:175], v[168:171], v[64:67]
ds_read_b128 v[232:235], v53 offset:8192
ds_read_b128 v[236:239], v53 offset:9216
v_mfma_f32_16x16x32_bf16 v[68:71], v[176:179], v[168:171], v[68:71]
v_mfma_f32_16x16x32_bf16 v[72:75], v[180:183], v[168:171], v[72:75]
v_mfma_f32_16x16x32_bf16 v[76:79], v[184:187], v[168:171], v[76:79]
v_mfma_f32_16x16x32_bf16 v[80:83], v[188:191], v[168:171], v[80:83]
s_waitcnt lgkmcnt(0)
v_mfma_f32_16x16x32_bf16 v[64:67], v[196:199], v[192:195], v[64:67]
ds_read_b128 v[144:147], v50 offset:18432
ds_read_b128 v[148:151], v53 offset:18432
v_mfma_f32_16x16x32_bf16 v[68:71], v[200:203], v[192:195], v[68:71]
ds_read_b128 v[152:155], v53 offset:19456
ds_read_b128 v[156:159], v53 offset:20480
v_mfma_f32_16x16x32_bf16 v[72:75], v[204:207], v[192:195], v[72:75]
ds_read_b128 v[160:163], v53 offset:21504
ds_read_b128 v[164:167], v53 offset:22528
v_mfma_f32_16x16x32_bf16 v[76:79], v[208:211], v[192:195], v[76:79]
ds_read_b128 v[168:171], v50 offset:22528
ds_read_b128 v[172:175], v53 offset:23552
v_mfma_f32_16x16x32_bf16 v[80:83], v[212:215], v[192:195], v[80:83]
ds_read_b128 v[176:179], v53 offset:24576
ds_read_b128 v[180:183], v53 offset:25600
v_mfma_f32_16x16x32_bf16 v[64:67], v[220:223], v[216:219], v[64:67]
ds_read_b128 v[184:187], v53 offset:26624
ds_read_b128 v[188:191], v53 offset:27648
v_mfma_f32_16x16x32_bf16 v[68:71], v[224:227], v[216:219], v[68:71]
v_mfma_f32_16x16x32_bf16 v[72:75], v[228:231], v[216:219], v[72:75]
v_mfma_f32_16x16x32_bf16 v[76:79], v[232:235], v[216:219], v[76:79]
v_mfma_f32_16x16x32_bf16 v[80:83], v[236:239], v[216:219], v[80:83]
s_waitcnt lgkmcnt(0)
v_mfma_f32_16x16x32_bf16 v[64:67], v[148:151], v[144:147], v[64:67]
ds_read_b128 v[192:195], v50 offset:36864
ds_read_b128 v[196:199], v53 offset:36864
v_mfma_f32_16x16x32_bf16 v[68:71], v[152:155], v[144:147], v[68:71]
ds_read_b128 v[200:203], v53 offset:37888
ds_read_b128 v[204:207], v53 offset:38912
v_mfma_f32_16x16x32_bf16 v[72:75], v[156:159], v[144:147], v[72:75]
ds_read_b128 v[208:211], v53 offset:39936
ds_read_b128 v[212:215], v53 offset:40960
v_mfma_f32_16x16x32_bf16 v[76:79], v[160:163], v[144:147], v[76:79]
ds_read_b128 v[216:219], v50 offset:40960
ds_read_b128 v[220:223], v53 offset:41984
v_mfma_f32_16x16x32_bf16 v[80:83], v[164:167], v[144:147], v[80:83]
ds_read_b128 v[224:227], v53 offset:43008
ds_read_b128 v[228:231], v53 offset:44032
v_mfma_f32_16x16x32_bf16 v[64:67], v[172:175], v[168:171], v[64:67]
ds_read_b128 v[232:235], v53 offset:45056
ds_read_b128 v[236:239], v53 offset:46080
v_mfma_f32_16x16x32_bf16 v[68:71], v[176:179], v[168:171], v[68:71]
v_mfma_f32_16x16x32_bf16 v[72:75], v[180:183], v[168:171], v[72:75]
v_mfma_f32_16x16x32_bf16 v[76:79], v[184:187], v[168:171], v[76:79]
v_mfma_f32_16x16x32_bf16 v[80:83], v[188:191], v[168:171], v[80:83]
s_waitcnt lgkmcnt(0)
s_barrier
v_mfma_f32_16x16x32_bf16 v[64:67], v[196:199], v[192:195], v[64:67]
ds_read_b128 v[144:147], v48 offset:0
ds_read_b128 v[148:151], v51 offset:0
v_mfma_f32_16x16x32_bf16 v[68:71], v[200:203], v[192:195], v[68:71]
ds_read_b128 v[152:155], v51 offset:1024
ds_read_b128 v[156:159], v51 offset:2048
v_mfma_f32_16x16x32_bf16 v[72:75], v[204:207], v[192:195], v[72:75]
ds_read_b128 v[160:163], v51 offset:3072
ds_read_b128 v[164:167], v51 offset:4096
v_mfma_f32_16x16x32_bf16 v[76:79], v[208:211], v[192:195], v[76:79]
ds_read_b128 v[168:171], v48 offset:4096
ds_read_b128 v[172:175], v51 offset:5120
v_mfma_f32_16x16x32_bf16 v[80:83], v[212:215], v[192:195], v[80:83]
ds_read_b128 v[176:179], v51 offset:6144
ds_read_b128 v[180:183], v51 offset:7168
v_mfma_f32_16x16x32_bf16 v[64:67], v[220:223], v[216:219], v[64:67]
ds_read_b128 v[184:187], v51 offset:8192
ds_read_b128 v[188:191], v51 offset:9216
v_mfma_f32_16x16x32_bf16 v[68:71], v[224:227], v[216:219], v[68:71]
v_mfma_f32_16x16x32_bf16 v[72:75], v[228:231], v[216:219], v[72:75]
v_mfma_f32_16x16x32_bf16 v[76:79], v[232:235], v[216:219], v[76:79]
v_mfma_f32_16x16x32_bf16 v[80:83], v[236:239], v[216:219], v[80:83]
s_waitcnt lgkmcnt(0)
s_barrier
v_mfma_f32_16x16x32_bf16 v[64:67], v[148:151], v[144:147], v[64:67]
ds_read_b128 v[192:195], v48 offset:18432
ds_read_b128 v[196:199], v51 offset:18432
v_mfma_f32_16x16x32_bf16 v[68:71], v[152:155], v[144:147], v[68:71]
ds_read_b128 v[200:203], v51 offset:19456
ds_read_b128 v[204:207], v51 offset:20480
v_mfma_f32_16x16x32_bf16 v[72:75], v[156:159], v[144:147], v[72:75]
ds_read_b128 v[208:211], v51 offset:21504
ds_read_b128 v[212:215], v51 offset:22528
v_mfma_f32_16x16x32_bf16 v[76:79], v[160:163], v[144:147], v[76:79]
ds_read_b128 v[216:219], v48 offset:22528
ds_read_b128 v[220:223], v51 offset:23552
v_mfma_f32_16x16x32_bf16 v[80:83], v[164:167], v[144:147], v[80:83]
ds_read_b128 v[224:227], v51 offset:24576
ds_read_b128 v[228:231], v51 offset:25600
v_mfma_f32_16x16x32_bf16 v[64:67], v[172:175], v[168:171], v[64:67]
ds_read_b128 v[232:235], v51 offset:26624
ds_read_b128 v[236:239], v51 offset:27648
v_mfma_f32_16x16x32_bf16 v[68:71], v[176:179], v[168:171], v[68:71]
v_mfma_f32_16x16x32_bf16 v[72:75], v[180:183], v[168:171], v[72:75]
v_mfma_f32_16x16x32_bf16 v[76:79], v[184:187], v[168:171], v[76:79]
v_mfma_f32_16x16x32_bf16 v[80:83], v[188:191], v[168:171], v[80:83]
s_waitcnt lgkmcnt(0)
s_barrier
s_lshl_b32 s43, s2, 3
s_add_u32 s43, s43, s36
s_cmp_lg_u32 s43, 5
s_cbranch_scc1 Lk_104
v_lshlrev_b32 v1, 6, v0
s_mov_b32 s43, 23068672
buffer_load_dwordx2 v[12:13], v1, s[16:19], s43 offen sc1
s_add_u32 s43, s43, 4096
buffer_load_dwordx2 v[14:15], v1, s[16:19], s43 offen sc1
s_add_u32 s43, s43, 4096
buffer_load_dwordx2 v[16:17], v1, s[16:19], s43 offen sc1
s_add_u32 s43, s43, 4096
buffer_load_dwordx2 v[18:19], v1, s[16:19], s43 offen sc1
s_add_u32 s43, s43, 4096
s_mov_b32 s43, 23171072
buffer_load_dwordx2 v[20:21], v1, s[16:19], s43 offen sc1
Lk_104:
v_mfma_f32_16x16x32_bf16 v[64:67], v[196:199], v[192:195], v[64:67]
ds_read_b128 v[144:147], v48 offset:36864
ds_read_b128 v[148:151], v51 offset:36864
v_mfma_f32_16x16x32_bf16 v[68:71], v[200:203], v[192:195], v[68:71]
ds_read_b128 v[152:155], v51 offset:37888
ds_read_b128 v[156:159], v51 offset:38912
v_mfma_f32_16x16x32_bf16 v[72:75], v[204:207], v[192:195], v[72:75]
ds_read_b128 v[160:163], v51 offset:39936
ds_read_b128 v[164:167], v51 offset:40960
v_mfma_f32_16x16x32_bf16 v[76:79], v[208:211], v[192:195], v[76:79]
ds_read_b128 v[168:171], v48 offset:40960
ds_read_b128 v[172:175], v51 offset:41984
v_mfma_f32_16x16x32_bf16 v[80:83], v[212:215], v[192:195], v[80:83]
ds_read_b128 v[176:179], v51 offset:43008
ds_read_b128 v[180:183], v51 offset:44032
v_mfma_f32_16x16x32_bf16 v[64:67], v[220:223], v[216:219], v[64:67]
ds_read_b128 v[184:187], v51 offset:45056
ds_read_b128 v[188:191], v51 offset:46080
v_mfma_f32_16x16x32_bf16 v[68:71], v[224:227], v[216:219], v[68:71]
v_mfma_f32_16x16x32_bf16 v[72:75], v[228:231], v[216:219], v[72:75]
v_mfma_f32_16x16x32_bf16 v[76:79], v[232:235], v[216:219], v[76:79]
v_mfma_f32_16x16x32_bf16 v[80:83], v[236:239], v[216:219], v[80:83]
s_waitcnt lgkmcnt(0)
s_barrier
v_mfma_f32_16x16x32_bf16 v[64:67], v[148:151], v[144:147], v[64:67]
ds_read_b128 v[192:195], v49 offset:0
ds_read_b128 v[196:199], v52 offset:0
v_mfma_f32_16x16x32_bf16 v[68:71], v[152:155], v[144:147], v[68:71]
ds_read_b128 v[200:203], v52 offset:1024
ds_read_b128 v[204:207], v52 offset:2048
v_mfma_f32_16x16x32_bf16 v[72:75], v[156:159], v[144:147], v[72:75]
ds_read_b128 v[208:211], v52 offset:3072
ds_read_b128 v[212:215], v52 offset:4096
v_mfma_f32_16x16x32_bf16 v[76:79], v[160:163], v[144:147], v[76:79]
ds_read_b128 v[216:219], v49 offset:4096
ds_read_b128 v[220:223], v52 offset:5120
v_mfma_f32_16x16x32_bf16 v[80:83], v[164:167], v[144:147], v[80:83]
ds_read_b128 v[224:227], v52 offset:6144
ds_read_b128 v[228:231], v52 offset:7168
v_mfma_f32_16x16x32_bf16 v[64:67], v[172:175], v[168:171], v[64:67]
ds_read_b128 v[232:235], v52 offset:8192
ds_read_b128 v[236:239], v52 offset:9216
v_mfma_f32_16x16x32_bf16 v[68:71], v[176:179], v[168:171], v[68:71]
v_mfma_f32_16x16x32_bf16 v[72:75], v[180:183], v[168:171], v[72:75]
v_mfma_f32_16x16x32_bf16 v[76:79], v[184:187], v[168:171], v[76:79]
v_mfma_f32_16x16x32_bf16 v[80:83], v[188:191], v[168:171], v[80:83]
s_waitcnt lgkmcnt(0)
s_barrier
v_mfma_f32_16x16x32_bf16 v[64:67], v[196:199], v[192:195], v[64:67]
ds_read_b128 v[144:147], v49 offset:18432
ds_read_b128 v[148:151], v52 offset:18432
v_mfma_f32_16x16x32_bf16 v[68:71], v[200:203], v[192:195], v[68:71]
ds_read_b128 v[152:155], v52 offset:19456
ds_read_b128 v[156:159], v52 offset:20480
v_mfma_f32_16x16x32_bf16 v[72:75], v[204:207], v[192:195], v[72:75]
ds_read_b128 v[160:163], v52 offset:21504
ds_read_b128 v[164:167], v52 offset:22528
v_mfma_f32_16x16x32_bf16 v[76:79], v[208:211], v[192:195], v[76:79]
ds_read_b128 v[168:171], v49 offset:22528
ds_read_b128 v[172:175], v52 offset:23552
v_mfma_f32_16x16x32_bf16 v[80:83], v[212:215], v[192:195], v[80:83]
ds_read_b128 v[176:179], v52 offset:24576
ds_read_b128 v[180:183], v52 offset:25600
v_mfma_f32_16x16x32_bf16 v[64:67], v[220:223], v[216:219], v[64:67]
ds_read_b128 v[184:187], v52 offset:26624
ds_read_b128 v[188:191], v52 offset:27648
v_mfma_f32_16x16x32_bf16 v[68:71], v[224:227], v[216:219], v[68:71]
v_mfma_f32_16x16x32_bf16 v[72:75], v[228:231], v[216:219], v[72:75]
v_mfma_f32_16x16x32_bf16 v[76:79], v[232:235], v[216:219], v[76:79]
v_mfma_f32_16x16x32_bf16 v[80:83], v[236:239], v[216:219], v[80:83]
s_waitcnt lgkmcnt(0)
s_barrier
v_mfma_f32_16x16x32_bf16 v[64:67], v[148:151], v[144:147], v[64:67]
ds_read_b128 v[192:195], v50 offset:0
ds_read_b128 v[196:199], v53 offset:0
v_mfma_f32_16x16x32_bf16 v[68:71], v[152:155], v[144:147], v[68:71]
ds_read_b128 v[200:203], v53 offset:1024
ds_read_b128 v[204:207], v53 offset:2048
v_mfma_f32_16x16x32_bf16 v[72:75], v[156:159], v[144:147], v[72:75]
ds_read_b128 v[208:211], v53 offset:3072
ds_read_b128 v[212:215], v53 offset:4096
v_mfma_f32_16x16x32_bf16 v[76:79], v[160:163], v[144:147], v[76:79]
ds_read_b128 v[216:219], v50 offset:4096
ds_read_b128 v[220:223], v53 offset:5120
v_mfma_f32_16x16x32_bf16 v[80:83], v[164:167], v[144:147], v[80:83]
ds_read_b128 v[224:227], v53 offset:6144
ds_read_b128 v[228:231], v53 offset:7168
v_mfma_f32_16x16x32_bf16 v[64:67], v[172:175], v[168:171], v[64:67]
ds_read_b128 v[232:235], v53 offset:8192
ds_read_b128 v[236:239], v53 offset:9216
v_mfma_f32_16x16x32_bf16 v[68:71], v[176:179], v[168:171], v[68:71]
v_mfma_f32_16x16x32_bf16 v[72:75], v[180:183], v[168:171], v[72:75]
v_mfma_f32_16x16x32_bf16 v[76:79], v[184:187], v[168:171], v[76:79]
v_mfma_f32_16x16x32_bf16 v[80:83], v[188:191], v[168:171], v[80:83]
s_waitcnt lgkmcnt(0)
s_barrier
s_lshl_b32 s43, s2, 3
s_add_u32 s43, s43, s36
s_cmp_lg_u32 s43, 5
s_cbranch_scc1 Lk_107
s_mov_b32 s47, 0
Lt_108:
s_waitcnt vmcnt(0)
s_mov_b32 exec_lo, 0x88888888
s_mov_b32 exec_hi, 0x88888888
v_cmp_ne_u64 s[64:65], s[54:55], v[20:21]
s_mov_b32 exec_lo, 0x7fff7fff
s_mov_b32 exec_hi, 0x7fff7fff
v_cmp_ne_u64 s[66:67], s[54:55], v[12:13]
s_nop 0
s_or_b64 s[64:65], s[64:65], s[66:67]
v_cmp_ne_u64 s[66:67], s[54:55], v[14:15]
s_nop 0
s_or_b64 s[64:65], s[64:65], s[66:67]
v_cmp_ne_u64 s[66:67], s[54:55], v[16:17]
s_nop 0
s_or_b64 s[64:65], s[64:65], s[66:67]
v_cmp_ne_u64 s[66:67], s[54:55], v[18:19]
s_nop 0
s_or_b64 s[64:65], s[64:65], s[66:67]
s_mov_b64 exec, -1
s_cmp_eq_u64 s[64:65], 0
s_cbranch_scc1 Lt_109
s_add_u32 s47, s47, 1
s_cmp_gt_u32 s47, 400000
s_cbranch_scc1 Lt_109
v_lshlrev_b32 v1, 6, v0
s_mov_b32 s43, 23068672
buffer_load_dwordx2 v[12:13], v1, s[16:19], s43 offen sc1
s_add_u32 s43, s43, 4096
buffer_load_dwordx2 v[14:15], v1, s[16:19], s43 offen sc1
s_add_u32 s43, s43, 4096
buffer_load_dwordx2 v[16:17], v1, s[16:19], s43 offen sc1
s_add_u32 s43, s43, 4096
buffer_load_dwordx2 v[18:19], v1, s[16:19], s43 offen sc1
s_add_u32 s43, s43, 4096
s_mov_b32 s43, 23171072
buffer_load_dwordx2 v[20:21], v1, s[16:19], s43 offen sc1
s_branch Lt_108
Lt_109:
s_mov_b32 s43, 23265280
v_mov_b32 v2, s54
v_mov_b32 v3, s55
s_mov_b64 exec, 1
buffer_store_dwordx2 v[2:3], off, s[16:19], s43 sc1
s_mov_b64 exec, -1
Lk_107:
v_mfma_f32_16x16x32_bf16 v[64:67], v[196:199], v[192:195], v[64:67]
ds_read_b128 v[144:147], v50 offset:18432
ds_read_b128 v[148:151], v53 offset:18432
v_mfma_f32_16x16x32_bf16 v[68:71], v[200:203], v[192:195], v[68:71]
ds_read_b128 v[152:155], v53 offset:19456
ds_read_b128 v[156:159], v53 offset:20480
v_mfma_f32_16x16x32_bf16 v[72:75], v[204:207], v[192:195], v[72:75]
ds_read_b128 v[160:163], v53 offset:21504
ds_read_b128 v[164:167], v53 offset:22528
v_mfma_f32_16x16x32_bf16 v[76:79], v[208:211], v[192:195], v[76:79]
ds_read_b128 v[168:171], v50 offset:22528
ds_read_b128 v[172:175], v53 offset:23552
v_mfma_f32_16x16x32_bf16 v[80:83], v[212:215], v[192:195], v[80:83]
ds_read_b128 v[176:179], v53 offset:24576
ds_read_b128 v[180:183], v53 offset:25600
v_mfma_f32_16x16x32_bf16 v[64:67], v[220:223], v[216:219], v[64:67]
ds_read_b128 v[184:187], v53 offset:26624
ds_read_b128 v[188:191], v53 offset:27648
v_mfma_f32_16x16x32_bf16 v[68:71], v[224:227], v[216:219], v[68:71]
v_mfma_f32_16x16x32_bf16 v[72:75], v[228:231], v[216:219], v[72:75]
v_mfma_f32_16x16x32_bf16 v[76:79], v[232:235], v[216:219], v[76:79]
v_mfma_f32_16x16x32_bf16 v[80:83], v[236:239], v[216:219], v[80:83]
s_waitcnt lgkmcnt(0)
s_barrier
v_mfma_f32_16x16x32_bf16 v[64:67], v[148:151], v[144:147], v[64:67]
ds_read_b128 v[192:195], v50 offset:36864
ds_read_b128 v[196:199], v53 offset:36864
v_mfma_f32_16x16x32_bf16 v[68:71], v[152:155], v[144:147], v[68:71]
ds_read_b128 v[200:203], v53 offset:37888
ds_read_b128 v[204:207], v53 offset:38912
v_mfma_f32_16x16x32_bf16 v[72:75], v[156:159], v[144:147], v[72:75]
ds_read_b128 v[208:211], v53 offset:39936
ds_read_b128 v[212:215], v53 offset:40960
v_mfma_f32_16x16x32_bf16 v[76:79], v[160:163], v[144:147], v[76:79]
ds_read_b128 v[216:219], v50 offset:40960
ds_read_b128 v[220:223], v53 offset:41984
v_mfma_f32_16x16x32_bf16 v[80:83], v[164:167], v[144:147], v[80:83]
ds_read_b128 v[224:227], v53 offset:43008
ds_read_b128 v[228:231], v53 offset:44032
v_mfma_f32_16x16x32_bf16 v[64:67], v[172:175], v[168:171], v[64:67]
ds_read_b128 v[232:235], v53 offset:45056
ds_read_b128 v[236:239], v53 offset:46080
v_mfma_f32_16x16x32_bf16 v[68:71], v[176:179], v[168:171], v[68:71]
v_mfma_f32_16x16x32_bf16 v[72:75], v[180:183], v[168:171], v[72:75]
v_mfma_f32_16x16x32_bf16 v[76:79], v[184:187], v[168:171], v[76:79]
v_mfma_f32_16x16x32_bf16 v[80:83], v[188:191], v[168:171], v[80:83]
s_waitcnt lgkmcnt(0)
s_barrier
v_mfma_f32_16x16x32_bf16 v[64:67], v[196:199], v[192:195], v[64:67]
ds_read_b128 v[144:147], v48 offset:0
ds_read_b128 v[148:151], v51 offset:0
v_mfma_f32_16x16x32_bf16 v[68:71], v[200:203], v[192:195], v[68:71]
ds_read_b128 v[152:155], v51 offset:1024
ds_read_b128 v[156:159], v51 offset:2048
v_mfma_f32_16x16x32_bf16 v[72:75], v[204:207], v[192:195], v[72:75]
ds_read_b128 v[160:163], v51 offset:3072
ds_read_b128 v[164:167], v51 offset:4096
v_mfma_f32_16x16x32_bf16 v[76:79], v[208:211], v[192:195], v[76:79]
ds_read_b128 v[168:171], v48 offset:4096
ds_read_b128 v[172:175], v51 offset:5120
v_mfma_f32_16x16x32_bf16 v[80:83], v[212:215], v[192:195], v[80:83]
ds_read_b128 v[176:179], v51 offset:6144
ds_read_b128 v[180:183], v51 offset:7168
v_mfma_f32_16x16x32_bf16 v[64:67], v[220:223], v[216:219], v[64:67]
ds_read_b128 v[184:187], v51 offset:8192
ds_read_b128 v[188:191], v51 offset:9216
v_mfma_f32_16x16x32_bf16 v[68:71], v[224:227], v[216:219], v[68:71]
v_mfma_f32_16x16x32_bf16 v[72:75], v[228:231], v[216:219], v[72:75]
v_mfma_f32_16x16x32_bf16 v[76:79], v[232:235], v[216:219], v[76:79]
v_mfma_f32_16x16x32_bf16 v[80:83], v[236:239], v[216:219], v[80:83]
s_waitcnt lgkmcnt(0)
s_barrier
v_mfma_f32_16x16x32_bf16 v[64:67], v[148:151], v[144:147], v[64:67]
ds_read_b128 v[192:195], v48 offset:18432
ds_read_b128 v[196:199], v51 offset:18432
v_mfma_f32_16x16x32_bf16 v[68:71], v[152:155], v[144:147], v[68:71]
ds_read_b128 v[200:203], v51 offset:19456
ds_read_b128 v[204:207], v51 offset:20480
v_mfma_f32_16x16x32_bf16 v[72:75], v[156:159], v[144:147], v[72:75]
ds_read_b128 v[208:211], v51 offset:21504
ds_read_b128 v[212:215], v51 offset:22528
v_mfma_f32_16x16x32_bf16 v[76:79], v[160:163], v[144:147], v[76:79]
ds_read_b128 v[216:219], v48 offset:22528
ds_read_b128 v[220:223], v51 offset:23552
v_mfma_f32_16x16x32_bf16 v[80:83], v[164:167], v[144:147], v[80:83]
ds_read_b128 v[224:227], v51 offset:24576
ds_read_b128 v[228:231], v51 offset:25600
v_mfma_f32_16x16x32_bf16 v[64:67], v[172:175], v[168:171], v[64:67]
ds_read_b128 v[232:235], v51 offset:26624
ds_read_b128 v[236:239], v51 offset:27648
v_mfma_f32_16x16x32_bf16 v[68:71], v[176:179], v[168:171], v[68:71]
v_mfma_f32_16x16x32_bf16 v[72:75], v[180:183], v[168:171], v[72:75]
v_mfma_f32_16x16x32_bf16 v[76:79], v[184:187], v[168:171], v[76:79]
v_mfma_f32_16x16x32_bf16 v[80:83], v[188:191], v[168:171], v[80:83]
s_waitcnt lgkmcnt(0)
s_barrier
v_mfma_f32_16x16x32_bf16 v[64:67], v[196:199], v[192:195], v[64:67]
ds_read_b128 v[144:147], v48 offset:36864
ds_read_b128 v[148:151], v51 offset:36864
v_mfma_f32_16x16x32_bf16 v[68:71], v[200:203], v[192:195], v[68:71]
ds_read_b128 v[152:155], v51 offset:37888
ds_read_b128 v[156:159], v51 offset:38912
v_mfma_f32_16x16x32_bf16 v[72:75], v[204:207], v[192:195], v[72:75]
ds_read_b128 v[160:163], v51 offset:39936
ds_read_b128 v[164:167], v51 offset:40960
v_mfma_f32_16x16x32_bf16 v[76:79], v[208:211], v[192:195], v[76:79]
ds_read_b128 v[168:171], v48 offset:40960
ds_read_b128 v[172:175], v51 offset:41984
v_mfma_f32_16x16x32_bf16 v[80:83], v[212:215], v[192:195], v[80:83]
ds_read_b128 v[176:179], v51 offset:43008
ds_read_b128 v[180:183], v51 offset:44032
v_mfma_f32_16x16x32_bf16 v[64:67], v[220:223], v[216:219], v[64:67]
ds_read_b128 v[184:187], v51 offset:45056
ds_read_b128 v[188:191], v51 offset:46080
v_mfma_f32_16x16x32_bf16 v[68:71], v[224:227], v[216:219], v[68:71]
v_mfma_f32_16x16x32_bf16 v[72:75], v[228:231], v[216:219], v[72:75]
v_mfma_f32_16x16x32_bf16 v[76:79], v[232:235], v[216:219], v[76:79]
v_mfma_f32_16x16x32_bf16 v[80:83], v[236:239], v[216:219], v[80:83]
s_waitcnt lgkmcnt(0)
s_barrier
v_mfma_f32_16x16x32_bf16 v[64:67], v[148:151], v[144:147], v[64:67]
ds_read_b128 v[192:195], v49 offset:0
ds_read_b128 v[196:199], v52 offset:0
v_mfma_f32_16x16x32_bf16 v[68:71], v[152:155], v[144:147], v[68:71]
ds_read_b128 v[200:203], v52 offset:1024
ds_read_b128 v[204:207], v52 offset:2048
v_mfma_f32_16x16x32_bf16 v[72:75], v[156:159], v[144:147], v[72:75]
ds_read_b128 v[208:211], v52 offset:3072
ds_read_b128 v[212:215], v52 offset:4096
v_mfma_f32_16x16x32_bf16 v[76:79], v[160:163], v[144:147], v[76:79]
ds_read_b128 v[216:219], v49 offset:4096
ds_read_b128 v[220:223], v52 offset:5120
v_mfma_f32_16x16x32_bf16 v[80:83], v[164:167], v[144:147], v[80:83]
ds_read_b128 v[224:227], v52 offset:6144
ds_read_b128 v[228:231], v52 offset:7168
v_mfma_f32_16x16x32_bf16 v[64:67], v[172:175], v[168:171], v[64:67]
ds_read_b128 v[232:235], v52 offset:8192
ds_read_b128 v[236:239], v52 offset:9216
v_mfma_f32_16x16x32_bf16 v[68:71], v[176:179], v[168:171], v[68:71]
v_mfma_f32_16x16x32_bf16 v[72:75], v[180:183], v[168:171], v[72:75]
v_mfma_f32_16x16x32_bf16 v[76:79], v[184:187], v[168:171], v[76:79]
v_mfma_f32_16x16x32_bf16 v[80:83], v[188:191], v[168:171], v[80:83]
s_waitcnt lgkmcnt(0)
s_barrier
v_mfma_f32_16x16x32_bf16 v[64:67], v[196:199], v[192:195], v[64:67]
ds_read_b128 v[144:147], v49 offset:18432
ds_read_b128 v[148:151], v52 offset:18432
v_mfma_f32_16x16x32_bf16 v[68:71], v[200:203], v[192:195], v[68:71]
ds_read_b128 v[152:155], v52 offset:19456
ds_read_b128 v[156:159], v52 offset:20480
v_mfma_f32_16x16x32_bf16 v[72:75], v[204:207], v[192:195], v[72:75]
ds_read_b128 v[160:163], v52 offset:21504
ds_read_b128 v[164:167], v52 offset:22528
v_mfma_f32_16x16x32_bf16 v[76:79], v[208:211], v[192:195], v[76:79]
ds_read_b128 v[168:171], v49 offset:22528
ds_read_b128 v[172:175], v52 offset:23552
v_mfma_f32_16x16x32_bf16 v[80:83], v[212:215], v[192:195], v[80:83]
ds_read_b128 v[176:179], v52 offset:24576
ds_read_b128 v[180:183], v52 offset:25600
v_mfma_f32_16x16x32_bf16 v[64:67], v[220:223], v[216:219], v[64:67]
ds_read_b128 v[184:187], v52 offset:26624
ds_read_b128 v[188:191], v52 offset:27648
v_mfma_f32_16x16x32_bf16 v[68:71], v[224:227], v[216:219], v[68:71]
v_mfma_f32_16x16x32_bf16 v[72:75], v[228:231], v[216:219], v[72:75]
v_mfma_f32_16x16x32_bf16 v[76:79], v[232:235], v[216:219], v[76:79]
v_mfma_f32_16x16x32_bf16 v[80:83], v[236:239], v[216:219], v[80:83]
s_waitcnt lgkmcnt(0)
s_barrier
v_mfma_f32_16x16x32_bf16 v[64:67], v[148:151], v[144:147], v[64:67]
ds_read_b128 v[192:195], v50 offset:0
ds_read_b128 v[196:199], v53 offset:0
v_mfma_f32_16x16x32_bf16 v[68:71], v[152:155], v[144:147], v[68:71]
ds_read_b128 v[200:203], v53 offset:1024
ds_read_b128 v[204:207], v53 offset:2048
v_mfma_f32_16x16x32_bf16 v[72:75], v[156:159], v[144:147], v[72:75]
ds_read_b128 v[208:211], v53 offset:3072
ds_read_b128 v[212:215], v53 offset:4096
v_mfma_f32_16x16x32_bf16 v[76:79], v[160:163], v[144:147], v[76:79]
ds_read_b128 v[216:219], v50 offset:4096
ds_read_b128 v[220:223], v53 offset:5120
v_mfma_f32_16x16x32_bf16 v[80:83], v[164:167], v[144:147], v[80:83]
ds_read_b128 v[224:227], v53 offset:6144
ds_read_b128 v[228:231], v53 offset:7168
v_mfma_f32_16x16x32_bf16 v[64:67], v[172:175], v[168:171], v[64:67]
ds_read_b128 v[232:235], v53 offset:8192
ds_read_b128 v[236:239], v53 offset:9216
v_mfma_f32_16x16x32_bf16 v[68:71], v[176:179], v[168:171], v[68:71]
v_mfma_f32_16x16x32_bf16 v[72:75], v[180:183], v[168:171], v[72:75]
v_mfma_f32_16x16x32_bf16 v[76:79], v[184:187], v[168:171], v[76:79]
v_mfma_f32_16x16x32_bf16 v[80:83], v[188:191], v[168:171], v[80:83]
s_waitcnt lgkmcnt(0)
s_barrier
v_mfma_f32_16x16x32_bf16 v[64:67], v[196:199], v[192:195], v[64:67]
ds_read_b128 v[144:147], v50 offset:18432
ds_read_b128 v[148:151], v53 offset:18432
v_mfma_f32_16x16x32_bf16 v[68:71], v[200:203], v[192:195], v[68:71]
ds_read_b128 v[152:155], v53 offset:19456
ds_read_b128 v[156:159], v53 offset:20480
v_mfma_f32_16x16x32_bf16 v[72:75], v[204:207], v[192:195], v[72:75]
ds_read_b128 v[160:163], v53 offset:21504
ds_read_b128 v[164:167], v53 offset:22528
v_mfma_f32_16x16x32_bf16 v[76:79], v[208:211], v[192:195], v[76:79]
ds_read_b128 v[168:171], v50 offset:22528
ds_read_b128 v[172:175], v53 offset:23552
v_mfma_f32_16x16x32_bf16 v[80:83], v[212:215], v[192:195], v[80:83]
ds_read_b128 v[176:179], v53 offset:24576
ds_read_b128 v[180:183], v53 offset:25600
v_mfma_f32_16x16x32_bf16 v[64:67], v[220:223], v[216:219], v[64:67]
ds_read_b128 v[184:187], v53 offset:26624
ds_read_b128 v[188:191], v53 offset:27648
v_mfma_f32_16x16x32_bf16 v[68:71], v[224:227], v[216:219], v[68:71]
v_mfma_f32_16x16x32_bf16 v[72:75], v[228:231], v[216:219], v[72:75]
v_mfma_f32_16x16x32_bf16 v[76:79], v[232:235], v[216:219], v[76:79]
v_mfma_f32_16x16x32_bf16 v[80:83], v[236:239], v[216:219], v[80:83]
s_waitcnt lgkmcnt(0)
s_barrier
v_mfma_f32_16x16x32_bf16 v[64:67], v[148:151], v[144:147], v[64:67]
ds_read_b128 v[192:195], v50 offset:36864
ds_read_b128 v[196:199], v53 offset:36864
v_mfma_f32_16x16x32_bf16 v[68:71], v[152:155], v[144:147], v[68:71]
ds_read_b128 v[200:203], v53 offset:37888
ds_read_b128 v[204:207], v53 offset:38912
v_mfma_f32_16x16x32_bf16 v[72:75], v[156:159], v[144:147], v[72:75]
ds_read_b128 v[208:211], v53 offset:39936
ds_read_b128 v[212:215], v53 offset:40960
v_mfma_f32_16x16x32_bf16 v[76:79], v[160:163], v[144:147], v[76:79]
ds_read_b128 v[216:219], v50 offset:40960
ds_read_b128 v[220:223], v53 offset:41984
v_mfma_f32_16x16x32_bf16 v[80:83], v[164:167], v[144:147], v[80:83]
ds_read_b128 v[224:227], v53 offset:43008
ds_read_b128 v[228:231], v53 offset:44032
v_mfma_f32_16x16x32_bf16 v[64:67], v[172:175], v[168:171], v[64:67]
ds_read_b128 v[232:235], v53 offset:45056
ds_read_b128 v[236:239], v53 offset:46080
v_mfma_f32_16x16x32_bf16 v[68:71], v[176:179], v[168:171], v[68:71]
v_mfma_f32_16x16x32_bf16 v[72:75], v[180:183], v[168:171], v[72:75]
v_mfma_f32_16x16x32_bf16 v[76:79], v[184:187], v[168:171], v[76:79]
v_mfma_f32_16x16x32_bf16 v[80:83], v[188:191], v[168:171], v[80:83]
s_waitcnt lgkmcnt(0)
s_barrier
v_mfma_f32_16x16x32_bf16 v[64:67], v[196:199], v[192:195], v[64:67]
ds_read_b128 v[144:147], v48 offset:0
ds_read_b128 v[148:151], v51 offset:0
v_mfma_f32_16x16x32_bf16 v[68:71], v[200:203], v[192:195], v[68:71]
ds_read_b128 v[152:155], v51 offset:1024
ds_read_b128 v[156:159], v51 offset:2048
v_mfma_f32_16x16x32_bf16 v[72:75], v[204:207], v[192:195], v[72:75]
ds_read_b128 v[160:163], v51 offset:3072
ds_read_b128 v[164:167], v51 offset:4096
v_mfma_f32_16x16x32_bf16 v[76:79], v[208:211], v[192:195], v[76:79]
ds_read_b128 v[168:171], v48 offset:4096
ds_read_b128 v[172:175], v51 offset:5120
v_mfma_f32_16x16x32_bf16 v[80:83], v[212:215], v[192:195], v[80:83]
ds_read_b128 v[176:179], v51 offset:6144
ds_read_b128 v[180:183], v51 offset:7168
v_mfma_f32_16x16x32_bf16 v[64:67], v[220:223], v[216:219], v[64:67]
ds_read_b128 v[184:187], v51 offset:8192
ds_read_b128 v[188:191], v51 offset:9216
v_mfma_f32_16x16x32_bf16 v[68:71], v[224:227], v[216:219], v[68:71]
v_mfma_f32_16x16x32_bf16 v[72:75], v[228:231], v[216:219], v[72:75]
v_mfma_f32_16x16x32_bf16 v[76:79], v[232:235], v[216:219], v[76:79]
v_mfma_f32_16x16x32_bf16 v[80:83], v[236:239], v[216:219], v[80:83]
s_waitcnt lgkmcnt(0)
s_barrier
v_mfma_f32_16x16x32_bf16 v[64:67], v[148:151], v[144:147], v[64:67]
ds_read_b128 v[192:195], v48 offset:18432
ds_read_b128 v[196:199], v51 offset:18432
v_mfma_f32_16x16x32_bf16 v[68:71], v[152:155], v[144:147], v[68:71]
ds_read_b128 v[200:203], v51 offset:19456
ds_read_b128 v[204:207], v51 offset:20480
v_mfma_f32_16x16x32_bf16 v[72:75], v[156:159], v[144:147], v[72:75]
ds_read_b128 v[208:211], v51 offset:21504
ds_read_b128 v[212:215], v51 offset:22528
v_mfma_f32_16x16x32_bf16 v[76:79], v[160:163], v[144:147], v[76:79]
ds_read_b128 v[216:219], v48 offset:22528
ds_read_b128 v[220:223], v51 offset:23552
v_mfma_f32_16x16x32_bf16 v[80:83], v[164:167], v[144:147], v[80:83]
ds_read_b128 v[224:227], v51 offset:24576
ds_read_b128 v[228:231], v51 offset:25600
v_mfma_f32_16x16x32_bf16 v[64:67], v[172:175], v[168:171], v[64:67]
ds_read_b128 v[232:235], v51 offset:26624
ds_read_b128 v[236:239], v51 offset:27648
v_mfma_f32_16x16x32_bf16 v[68:71], v[176:179], v[168:171], v[68:71]
v_mfma_f32_16x16x32_bf16 v[72:75], v[180:183], v[168:171], v[72:75]
v_mfma_f32_16x16x32_bf16 v[76:79], v[184:187], v[168:171], v[76:79]
v_mfma_f32_16x16x32_bf16 v[80:83], v[188:191], v[168:171], v[80:83]
s_waitcnt lgkmcnt(0)
s_barrier
v_mfma_f32_16x16x32_bf16 v[64:67], v[196:199], v[192:195], v[64:67]
ds_read_b128 v[144:147], v48 offset:36864
ds_read_b128 v[148:151], v51 offset:36864
v_mfma_f32_16x16x32_bf16 v[68:71], v[200:203], v[192:195], v[68:71]
ds_read_b128 v[152:155], v51 offset:37888
ds_read_b128 v[156:159], v51 offset:38912
v_mfma_f32_16x16x32_bf16 v[72:75], v[204:207], v[192:195], v[72:75]
ds_read_b128 v[160:163], v51 offset:39936
ds_read_b128 v[164:167], v51 offset:40960
v_mfma_f32_16x16x32_bf16 v[76:79], v[208:211], v[192:195], v[76:79]
ds_read_b128 v[168:171], v48 offset:40960
ds_read_b128 v[172:175], v51 offset:41984
v_mfma_f32_16x16x32_bf16 v[80:83], v[212:215], v[192:195], v[80:83]
ds_read_b128 v[176:179], v51 offset:43008
ds_read_b128 v[180:183], v51 offset:44032
v_mfma_f32_16x16x32_bf16 v[64:67], v[220:223], v[216:219], v[64:67]
ds_read_b128 v[184:187], v51 offset:45056
ds_read_b128 v[188:191], v51 offset:46080
v_mfma_f32_16x16x32_bf16 v[68:71], v[224:227], v[216:219], v[68:71]
v_mfma_f32_16x16x32_bf16 v[72:75], v[228:231], v[216:219], v[72:75]
v_mfma_f32_16x16x32_bf16 v[76:79], v[232:235], v[216:219], v[76:79]
v_mfma_f32_16x16x32_bf16 v[80:83], v[236:239], v[216:219], v[80:83]
s_waitcnt lgkmcnt(0)
s_barrier
v_mfma_f32_16x16x32_bf16 v[64:67], v[148:151], v[144:147], v[64:67]
ds_read_b128 v[192:195], v49 offset:0
ds_read_b128 v[196:199], v52 offset:0
v_mfma_f32_16x16x32_bf16 v[68:71], v[152:155], v[144:147], v[68:71]
ds_read_b128 v[200:203], v52 offset:1024
ds_read_b128 v[204:207], v52 offset:2048
v_mfma_f32_16x16x32_bf16 v[72:75], v[156:159], v[144:147], v[72:75]
ds_read_b128 v[208:211], v52 offset:3072
ds_read_b128 v[212:215], v52 offset:4096
v_mfma_f32_16x16x32_bf16 v[76:79], v[160:163], v[144:147], v[76:79]
ds_read_b128 v[216:219], v49 offset:4096
ds_read_b128 v[220:223], v52 offset:5120
v_mfma_f32_16x16x32_bf16 v[80:83], v[164:167], v[144:147], v[80:83]
ds_read_b128 v[224:227], v52 offset:6144
ds_read_b128 v[228:231], v52 offset:7168
v_mfma_f32_16x16x32_bf16 v[64:67], v[172:175], v[168:171], v[64:67]
ds_read_b128 v[232:235], v52 offset:8192
ds_read_b128 v[236:239], v52 offset:9216
v_mfma_f32_16x16x32_bf16 v[68:71], v[176:179], v[168:171], v[68:71]
v_mfma_f32_16x16x32_bf16 v[72:75], v[180:183], v[168:171], v[72:75]
v_mfma_f32_16x16x32_bf16 v[76:79], v[184:187], v[168:171], v[76:79]
v_mfma_f32_16x16x32_bf16 v[80:83], v[188:191], v[168:171], v[80:83]
s_waitcnt lgkmcnt(0)
s_barrier
v_mfma_f32_16x16x32_bf16 v[84:87], v[196:199], v[192:195], 0
ds_read_b128 v[144:147], v49 offset:18432
ds_read_b128 v[148:151], v52 offset:18432
v_mfma_f32_16x16x32_bf16 v[88:91], v[200:203], v[192:195], 0
ds_read_b128 v[152:155], v52 offset:19456
ds_read_b128 v[156:159], v52 offset:20480
v_mfma_f32_16x16x32_bf16 v[92:95], v[204:207], v[192:195], 0
ds_read_b128 v[160:163], v52 offset:21504
ds_read_b128 v[164:167], v52 offset:22528
v_mfma_f32_16x16x32_bf16 v[96:99], v[208:211], v[192:195], 0
ds_read_b128 v[168:171], v49 offset:22528
ds_read_b128 v[172:175], v52 offset:23552
v_mfma_f32_16x16x32_bf16 v[100:103], v[212:215], v[192:195], 0
ds_read_b128 v[176:179], v52 offset:24576
ds_read_b128 v[180:183], v52 offset:25600
v_mfma_f32_16x16x32_bf16 v[84:87], v[220:223], v[216:219], v[84:87]
ds_read_b128 v[184:187], v52 offset:26624
ds_read_b128 v[188:191], v52 offset:27648
v_mfma_f32_16x16x32_bf16 v[88:91], v[224:227], v[216:219], v[88:91]
v_mul_f32 v104, 0xbfb8aa3b, v64
v_mul_f32 v105, 0xbfb8aa3b, v65
v_mul_f32 v106, 0xbfb8aa3b, v66
v_mul_f32 v107, 0xbfb8aa3b, v67
v_mfma_f32_16x16x32_bf16 v[92:95], v[228:231], v[216:219], v[92:95]
v_exp_f32 v104, v104
v_exp_f32 v105, v105
v_exp_f32 v106, v106
v_exp_f32 v107, v107
v_mfma_f32_16x16x32_bf16 v[96:99], v[232:235], v[216:219], v[96:99]
v_add_f32 v104, 1.0, v104
v_add_f32 v105, 1.0, v105
v_add_f32 v106, 1.0, v106
v_add_f32 v107, 1.0, v107
v_mfma_f32_16x16x32_bf16 v[100:103], v[236:239], v[216:219], v[100:103]
v_rcp_f32 v104, v104
v_rcp_f32 v105, v105
v_rcp_f32 v106, v106
v_rcp_f32 v107, v107
v_mul_f32 v64, v64, v104
v_mul_f32 v65, v65, v105
v_mul_f32 v66, v66, v106
v_mul_f32 v67, v67, v107
s_waitcnt lgkmcnt(0)
s_barrier
v_mfma_f32_16x16x32_bf16 v[84:87], v[148:151], v[144:147], v[84:87]
ds_read_b128 v[192:195], v50 offset:0
ds_read_b128 v[196:199], v53 offset:0
v_mfma_f32_16x16x32_bf16 v[88:91], v[152:155], v[144:147], v[88:91]
ds_read_b128 v[200:203], v53 offset:1024
ds_read_b128 v[204:207], v53 offset:2048
v_mfma_f32_16x16x32_bf16 v[92:95], v[156:159], v[144:147], v[92:95]
ds_read_b128 v[208:211], v53 offset:3072
ds_read_b128 v[212:215], v53 offset:4096
v_mfma_f32_16x16x32_bf16 v[96:99], v[160:163], v[144:147], v[96:99]
ds_read_b128 v[216:219], v50 offset:4096
ds_read_b128 v[220:223], v53 offset:5120
v_mfma_f32_16x16x32_bf16 v[100:103], v[164:167], v[144:147], v[100:103]
ds_read_b128 v[224:227], v53 offset:6144
ds_read_b128 v[228:231], v53 offset:7168
v_mfma_f32_16x16x32_bf16 v[84:87], v[172:175], v[168:171], v[84:87]
ds_read_b128 v[232:235], v53 offset:8192
ds_read_b128 v[236:239], v53 offset:9216
v_mfma_f32_16x16x32_bf16 v[88:91], v[176:179], v[168:171], v[88:91]
v_mul_f32 v108, 0xbfb8aa3b, v68
v_mul_f32 v109, 0xbfb8aa3b, v69
v_mul_f32 v110, 0xbfb8aa3b, v70
v_mul_f32 v111, 0xbfb8aa3b, v71
v_mfma_f32_16x16x32_bf16 v[92:95], v[180:183], v[168:171], v[92:95]
v_exp_f32 v108, v108
v_exp_f32 v109, v109
v_exp_f32 v110, v110
v_exp_f32 v111, v111
v_mfma_f32_16x16x32_bf16 v[96:99], v[184:187], v[168:171], v[96:99]
v_add_f32 v108, 1.0, v108
v_add_f32 v109, 1.0, v109
v_add_f32 v110, 1.0, v110
v_add_f32 v111, 1.0, v111
v_mfma_f32_16x16x32_bf16 v[100:103], v[188:191], v[168:171], v[100:103]
v_rcp_f32 v108, v108
v_rcp_f32 v109, v109
v_rcp_f32 v110, v110
v_rcp_f32 v111, v111
v_mul_f32 v68, v68, v108
v_mul_f32 v69, v69, v109
v_mul_f32 v70, v70, v110
v_mul_f32 v71, v71, v111
s_waitcnt lgkmcnt(0)
s_barrier
v_mfma_f32_16x16x32_bf16 v[84:87], v[196:199], v[192:195], v[84:87]
ds_read_b128 v[144:147], v50 offset:18432
ds_read_b128 v[148:151], v53 offset:18432
v_mfma_f32_16x16x32_bf16 v[88:91], v[200:203], v[192:195], v[88:91]
ds_read_b128 v[152:155], v53 offset:19456
ds_read_b128 v[156:159], v53 offset:20480
v_mfma_f32_16x16x32_bf16 v[92:95], v[204:207], v[192:195], v[92:95]
ds_read_b128 v[160:163], v53 offset:21504
ds_read_b128 v[164:167], v53 offset:22528
v_mfma_f32_16x16x32_bf16 v[96:99], v[208:211], v[192:195], v[96:99]
ds_read_b128 v[168:171], v50 offset:22528
ds_read_b128 v[172:175], v53 offset:23552
v_mfma_f32_16x16x32_bf16 v[100:103], v[212:215], v[192:195], v[100:103]
ds_read_b128 v[176:179], v53 offset:24576
ds_read_b128 v[180:183], v53 offset:25600
v_mfma_f32_16x16x32_bf16 v[84:87], v[220:223], v[216:219], v[84:87]
ds_read_b128 v[184:187], v53 offset:26624
ds_read_b128 v[188:191], v53 offset:27648
v_mfma_f32_16x16x32_bf16 v[88:91], v[224:227], v[216:219], v[88:91]
v_mul_f32 v112, 0xbfb8aa3b, v72
v_mul_f32 v113, 0xbfb8aa3b, v73
v_mul_f32 v114, 0xbfb8aa3b, v74
v_mul_f32 v115, 0xbfb8aa3b, v75
v_mfma_f32_16x16x32_bf16 v[92:95], v[228:231], v[216:219], v[92:95]
v_exp_f32 v112, v112
v_exp_f32 v113, v113
v_exp_f32 v114, v114
v_exp_f32 v115, v115
v_mfma_f32_16x16x32_bf16 v[96:99], v[232:235], v[216:219], v[96:99]
v_add_f32 v112, 1.0, v112
v_add_f32 v113, 1.0, v113
v_add_f32 v114, 1.0, v114
v_add_f32 v115, 1.0, v115
v_mfma_f32_16x16x32_bf16 v[100:103], v[236:239], v[216:219], v[100:103]
v_rcp_f32 v112, v112
v_rcp_f32 v113, v113
v_rcp_f32 v114, v114
v_rcp_f32 v115, v115
v_mul_f32 v72, v72, v112
v_mul_f32 v73, v73, v113
v_mul_f32 v74, v74, v114
v_mul_f32 v75, v75, v115
s_waitcnt lgkmcnt(0)
s_barrier
v_mfma_f32_16x16x32_bf16 v[84:87], v[148:151], v[144:147], v[84:87]
ds_read_b128 v[192:195], v50 offset:36864
ds_read_b128 v[196:199], v53 offset:36864
v_mfma_f32_16x16x32_bf16 v[88:91], v[152:155], v[144:147], v[88:91]
ds_read_b128 v[200:203], v53 offset:37888
ds_read_b128 v[204:207], v53 offset:38912
v_mfma_f32_16x16x32_bf16 v[92:95], v[156:159], v[144:147], v[92:95]
ds_read_b128 v[208:211], v53 offset:39936
ds_read_b128 v[212:215], v53 offset:40960
v_mfma_f32_16x16x32_bf16 v[96:99], v[160:163], v[144:147], v[96:99]
ds_read_b128 v[216:219], v50 offset:40960
ds_read_b128 v[220:223], v53 offset:41984
v_mfma_f32_16x16x32_bf16 v[100:103], v[164:167], v[144:147], v[100:103]
ds_read_b128 v[224:227], v53 offset:43008
ds_read_b128 v[228:231], v53 offset:44032
v_mfma_f32_16x16x32_bf16 v[84:87], v[172:175], v[168:171], v[84:87]
ds_read_b128 v[232:235], v53 offset:45056
ds_read_b128 v[236:239], v53 offset:46080
v_mfma_f32_16x16x32_bf16 v[88:91], v[176:179], v[168:171], v[88:91]
v_mul_f32 v116, 0xbfb8aa3b, v76
v_mul_f32 v117, 0xbfb8aa3b, v77
v_mul_f32 v118, 0xbfb8aa3b, v78
v_mul_f32 v119, 0xbfb8aa3b, v79
v_mfma_f32_16x16x32_bf16 v[92:95], v[180:183], v[168:171], v[92:95]
v_exp_f32 v116, v116
v_exp_f32 v117, v117
v_exp_f32 v118, v118
v_exp_f32 v119, v119
v_mfma_f32_16x16x32_bf16 v[96:99], v[184:187], v[168:171], v[96:99]
v_add_f32 v116, 1.0, v116
v_add_f32 v117, 1.0, v117
v_add_f32 v118, 1.0, v118
v_add_f32 v119, 1.0, v119
v_mfma_f32_16x16x32_bf16 v[100:103], v[188:191], v[168:171], v[100:103]
v_rcp_f32 v116, v116
v_rcp_f32 v117, v117
v_rcp_f32 v118, v118
v_rcp_f32 v119, v119
v_mul_f32 v76, v76, v116
v_mul_f32 v77, v77, v117
v_mul_f32 v78, v78, v118
v_mul_f32 v79, v79, v119
s_waitcnt lgkmcnt(0)
s_barrier
v_mfma_f32_16x16x32_bf16 v[84:87], v[196:199], v[192:195], v[84:87]
ds_read_b128 v[144:147], v48 offset:0
ds_read_b128 v[148:151], v51 offset:0
v_mfma_f32_16x16x32_bf16 v[88:91], v[200:203], v[192:195], v[88:91]
ds_read_b128 v[152:155], v51 offset:1024
ds_read_b128 v[156:159], v51 offset:2048
v_mfma_f32_16x16x32_bf16 v[92:95], v[204:207], v[192:195], v[92:95]
ds_read_b128 v[160:163], v51 offset:3072
ds_read_b128 v[164:167], v51 offset:4096
v_mfma_f32_16x16x32_bf16 v[96:99], v[208:211], v[192:195], v[96:99]
ds_read_b128 v[168:171], v48 offset:4096
ds_read_b128 v[172:175], v51 offset:5120
v_mfma_f32_16x16x32_bf16 v[100:103], v[212:215], v[192:195], v[100:103]
ds_read_b128 v[176:179], v51 offset:6144
ds_read_b128 v[180:183], v51 offset:7168
v_mfma_f32_16x16x32_bf16 v[84:87], v[220:223], v[216:219], v[84:87]
ds_read_b128 v[184:187], v51 offset:8192
ds_read_b128 v[188:191], v51 offset:9216
v_mfma_f32_16x16x32_bf16 v[88:91], v[224:227], v[216:219], v[88:91]
v_mul_f32 v120, 0xbfb8aa3b, v80
v_mul_f32 v121, 0xbfb8aa3b, v81
v_mul_f32 v122, 0xbfb8aa3b, v82
v_mul_f32 v123, 0xbfb8aa3b, v83
v_mfma_f32_16x16x32_bf16 v[92:95], v[228:231], v[216:219], v[92:95]
v_exp_f32 v120, v120
v_exp_f32 v121, v121
v_exp_f32 v122, v122
v_exp_f32 v123, v123
v_mfma_f32_16x16x32_bf16 v[96:99], v[232:235], v[216:219], v[96:99]
v_add_f32 v120, 1.0, v120
v_add_f32 v121, 1.0, v121
v_add_f32 v122, 1.0, v122
v_add_f32 v123, 1.0, v123
v_mfma_f32_16x16x32_bf16 v[100:103], v[236:239], v[216:219], v[100:103]
v_rcp_f32 v120, v120
v_rcp_f32 v121, v121
v_rcp_f32 v122, v122
v_rcp_f32 v123, v123
v_mul_f32 v80, v80, v120
v_mul_f32 v81, v81, v121
v_mul_f32 v82, v82, v122
v_mul_f32 v83, v83, v123
s_waitcnt lgkmcnt(0)
s_barrier
v_mfma_f32_16x16x32_bf16 v[84:87], v[148:151], v[144:147], v[84:87]
ds_read_b128 v[192:195], v48 offset:18432
ds_read_b128 v[196:199], v51 offset:18432
v_mfma_f32_16x16x32_bf16 v[88:91], v[152:155], v[144:147], v[88:91]
ds_read_b128 v[200:203], v51 offset:19456
ds_read_b128 v[204:207], v51 offset:20480
v_mfma_f32_16x16x32_bf16 v[92:95], v[156:159], v[144:147], v[92:95]
ds_read_b128 v[208:211], v51 offset:21504
ds_read_b128 v[212:215], v51 offset:22528
v_mfma_f32_16x16x32_bf16 v[96:99], v[160:163], v[144:147], v[96:99]
ds_read_b128 v[216:219], v48 offset:22528
ds_read_b128 v[220:223], v51 offset:23552
v_mfma_f32_16x16x32_bf16 v[100:103], v[164:167], v[144:147], v[100:103]
ds_read_b128 v[224:227], v51 offset:24576
ds_read_b128 v[228:231], v51 offset:25600
v_mfma_f32_16x16x32_bf16 v[84:87], v[172:175], v[168:171], v[84:87]
ds_read_b128 v[232:235], v51 offset:26624
ds_read_b128 v[236:239], v51 offset:27648
v_mfma_f32_16x16x32_bf16 v[88:91], v[176:179], v[168:171], v[88:91]
v_bfe_u32 v6, v0, 4, 1
v_mul_u32_u24 v6, 24, v6
v_add_u32 v6, v6, v55
v_mfma_f32_16x16x32_bf16 v[92:95], v[180:183], v[168:171], v[92:95]
v_lshlrev_b32 v124, 16, v36
v_and_b32 v125, 0xffff0000, v36
v_lshlrev_b32 v126, 16, v37
v_and_b32 v127, 0xffff0000, v37
v_mfma_f32_16x16x32_bf16 v[96:99], v[184:187], v[168:171], v[96:99]
v_lshlrev_b32 v128, 16, v38
v_and_b32 v129, 0xffff0000, v38
v_lshlrev_b32 v130, 16, v39
v_and_b32 v131, 0xffff0000, v39
v_mfma_f32_16x16x32_bf16 v[100:103], v[188:191], v[168:171], v[100:103]
v_lshlrev_b32 v132, 16, v40
v_and_b32 v133, 0xffff0000, v40
v_lshlrev_b32 v134, 16, v41
v_and_b32 v135, 0xffff0000, v41
v_lshlrev_b32 v136, 16, v42
v_and_b32 v137, 0xffff0000, v42
v_lshlrev_b32 v138, 16, v43
v_and_b32 v139, 0xffff0000, v43
s_waitcnt lgkmcnt(0)
s_barrier
v_mfma_f32_16x16x32_bf16 v[84:87], v[196:199], v[192:195], v[84:87]
ds_read_b128 v[144:147], v48 offset:36864
ds_read_b128 v[148:151], v51 offset:36864
v_mfma_f32_16x16x32_bf16 v[88:91], v[200:203], v[192:195], v[88:91]
ds_read_b128 v[152:155], v51 offset:37888
ds_read_b128 v[156:159], v51 offset:38912
v_mfma_f32_16x16x32_bf16 v[92:95], v[204:207], v[192:195], v[92:95]
ds_read_b128 v[160:163], v51 offset:39936
ds_read_b128 v[164:167], v51 offset:40960
v_mfma_f32_16x16x32_bf16 v[96:99], v[208:211], v[192:195], v[96:99]
ds_read_b128 v[168:171], v48 offset:40960
ds_read_b128 v[172:175], v51 offset:41984
v_mfma_f32_16x16x32_bf16 v[100:103], v[212:215], v[192:195], v[100:103]
ds_read_b128 v[176:179], v51 offset:43008
ds_read_b128 v[180:183], v51 offset:44032
v_mfma_f32_16x16x32_bf16 v[84:87], v[220:223], v[216:219], v[84:87]
ds_read_b128 v[184:187], v51 offset:45056
ds_read_b128 v[188:191], v51 offset:46080
v_mfma_f32_16x16x32_bf16 v[88:91], v[224:227], v[216:219], v[88:91]
v_lshlrev_b32 v140, 16, v44
v_and_b32 v141, 0xffff0000, v44
v_lshlrev_b32 v142, 16, v45
v_and_b32 v143, 0xffff0000, v45
v_mfma_f32_16x16x32_bf16 v[92:95], v[228:231], v[216:219], v[92:95]
v_mfma_f32_16x16x32_bf16 v[96:99], v[232:235], v[216:219], v[96:99]
v_mfma_f32_16x16x32_bf16 v[100:103], v[236:239], v[216:219], v[100:103]
s_waitcnt lgkmcnt(0)
s_barrier
v_mfma_f32_16x16x32_bf16 v[84:87], v[148:151], v[144:147], v[84:87]
ds_read_b64 v[192:193], v54 offset:0
ds_read_b64 v[194:195], v54 offset:512
v_mfma_f32_16x16x32_bf16 v[88:91], v[152:155], v[144:147], v[88:91]
ds_read_b128 v[196:199], v52 offset:0
ds_read_b128 v[200:203], v52 offset:1024
v_mfma_f32_16x16x32_bf16 v[92:95], v[156:159], v[144:147], v[92:95]
ds_read_b128 v[204:207], v52 offset:2048
ds_read_b128 v[208:211], v52 offset:3072
v_mfma_f32_16x16x32_bf16 v[96:99], v[160:163], v[144:147], v[96:99]
ds_read_b128 v[212:215], v52 offset:4096
ds_read_b64 v[216:217], v54 offset:4096
v_mfma_f32_16x16x32_bf16 v[100:103], v[164:167], v[144:147], v[100:103]
ds_read_b64 v[218:219], v54 offset:4608
ds_read_b128 v[220:223], v52 offset:5120
v_mfma_f32_16x16x32_bf16 v[84:87], v[172:175], v[168:171], v[84:87]
ds_read_b128 v[224:227], v52 offset:6144
ds_read_b128 v[228:231], v52 offset:7168
v_mfma_f32_16x16x32_bf16 v[88:91], v[176:179], v[168:171], v[88:91]
ds_read_b128 v[232:235], v52 offset:8192
ds_read_b128 v[236:239], v52 offset:9216
v_mfma_f32_16x16x32_bf16 v[92:95], v[180:183], v[168:171], v[92:95]
v_mfma_f32_16x16x32_bf16 v[96:99], v[184:187], v[168:171], v[96:99]
v_mfma_f32_16x16x32_bf16 v[100:103], v[188:191], v[168:171], v[100:103]
s_waitcnt lgkmcnt(0)
s_barrier
v_mfma_f32_16x16x32_bf16 v[84:87], v[196:199], v[192:195], v[84:87]
ds_read_b64 v[144:145], v54 offset:18432
ds_read_b64 v[146:147], v54 offset:18944
v_mfma_f32_16x16x32_bf16 v[88:91], v[200:203], v[192:195], v[88:91]
ds_read_b128 v[148:151], v52 offset:18432
ds_read_b128 v[152:155], v52 offset:19456
v_mfma_f32_16x16x32_bf16 v[92:95], v[204:207], v[192:195], v[92:95]
ds_read_b128 v[156:159], v52 offset:20480
ds_read_b128 v[160:163], v52 offset:21504
v_mfma_f32_16x16x32_bf16 v[96:99], v[208:211], v[192:195], v[96:99]
ds_read_b128 v[164:167], v52 offset:22528
ds_read_b64 v[168:169], v54 offset:22528
v_mfma_f32_16x16x32_bf16 v[100:103], v[212:215], v[192:195], v[100:103]
ds_read_b64 v[170:171], v54 offset:23040
ds_read_b128 v[172:175], v52 offset:23552
v_mfma_f32_16x16x32_bf16 v[84:87], v[220:223], v[216:219], v[84:87]
ds_read_b128 v[176:179], v52 offset:24576
ds_read_b128 v[180:183], v52 offset:25600
v_mfma_f32_16x16x32_bf16 v[88:91], v[224:227], v[216:219], v[88:91]
ds_read_b128 v[184:187], v52 offset:26624
ds_read_b128 v[188:191], v52 offset:27648
v_mfma_f32_16x16x32_bf16 v[92:95], v[228:231], v[216:219], v[92:95]
v_mfma_f32_16x16x32_bf16 v[96:99], v[232:235], v[216:219], v[96:99]
v_mfma_f32_16x16x32_bf16 v[100:103], v[236:239], v[216:219], v[100:103]
s_waitcnt lgkmcnt(0)
v_mfma_f32_16x16x32_bf16 v[84:87], v[148:151], v[144:147], v[84:87]
v_mfma_f32_16x16x32_bf16 v[88:91], v[152:155], v[144:147], v[88:91]
v_mfma_f32_16x16x32_bf16 v[92:95], v[156:159], v[144:147], v[92:95]
v_mfma_f32_16x16x32_bf16 v[96:99], v[160:163], v[144:147], v[96:99]
v_mfma_f32_16x16x32_bf16 v[100:103], v[164:167], v[144:147], v[100:103]
v_mfma_f32_16x16x32_bf16 v[84:87], v[172:175], v[168:171], v[84:87]
v_mfma_f32_16x16x32_bf16 v[88:91], v[176:179], v[168:171], v[88:91]
v_mfma_f32_16x16x32_bf16 v[92:95], v[180:183], v[168:171], v[92:95]
v_mfma_f32_16x16x32_bf16 v[96:99], v[184:187], v[168:171], v[96:99]
v_mfma_f32_16x16x32_bf16 v[100:103], v[188:191], v[168:171], v[100:103]
s_nop 3
v_fmac_f32 v124, v84, v64
v_fmac_f32 v125, v85, v65
v_fmac_f32 v126, v86, v66
v_fmac_f32 v127, v87, v67
v_fmac_f32 v128, v88, v68
v_fmac_f32 v129, v89, v69
v_fmac_f32 v130, v90, v70
v_fmac_f32 v131, v91, v71
v_fmac_f32 v132, v92, v72
v_fmac_f32 v133, v93, v73
v_fmac_f32 v134, v94, v74
v_fmac_f32 v135, v95, v75
v_fmac_f32 v136, v96, v76
v_fmac_f32 v137, v97, v77
v_fmac_f32 v138, v98, v78
v_fmac_f32 v139, v99, v79
v_fmac_f32 v140, v100, v80
v_fmac_f32 v141, v101, v81
v_fmac_f32 v142, v102, v82
v_fmac_f32 v143, v103, v83
v_cvt_pk_bf16_f32 v104, v124, v125
v_cvt_pk_bf16_f32 v105, v126, v127
v_cvt_pk_bf16_f32 v106, v128, v129
v_cvt_pk_bf16_f32 v107, v130, v131
v_cvt_pk_bf16_f32 v108, v132, v133
v_cvt_pk_bf16_f32 v109, v134, v135
v_cvt_pk_bf16_f32 v110, v136, v137
v_cvt_pk_bf16_f32 v111, v138, v139
v_cvt_pk_bf16_f32 v112, v140, v141
v_cvt_pk_bf16_f32 v113, v142, v143
buffer_store_dwordx2 v[112:113], v55, s[20:23], 0 offen offset:128
v_permlane16_swap_b32 v104, v106
v_permlane16_swap_b32 v105, v107
buffer_store_dwordx4 v[104:107], v6, s[20:23], 0 offen offset:0
v_permlane16_swap_b32 v108, v110
v_permlane16_swap_b32 v109, v111
buffer_store_dwordx4 v[108:111], v6, s[20:23], 0 offen offset:64
s_branch L_fin
Lfx_23:
s_nop 15
v_mov_b32 v128, 0xff800000
v_mov_b32 v129, 0xff800000
v_mov_b32 v130, 0xff800000
v_mov_b32 v131, 0xff800000
v_mov_b32 v132, 0xff800000
v_mov_b32 v133, 0xff800000
v_mov_b32 v134, 0xff800000
v_mov_b32 v135, 0xff800000
v_mov_b32 v136, 0xff800000
v_mov_b32 v137, 0xff800000
v_mov_b32 v138, 0xff800000
v_mov_b32 v139, 0xff800000
v_mov_b32 v140, 0xff800000
v_mov_b32 v141, 0xff800000
v_mov_b32 v142, 0xff800000
v_mov_b32 v143, 0xff800000
s_branch Lfb_24
Lfx_29:
s_nop 15
v_mov_b32 v144, 0xff800000
v_mov_b32 v145, 0xff800000
v_mov_b32 v146, 0xff800000
v_mov_b32 v147, 0xff800000
v_mov_b32 v148, 0xff800000
v_mov_b32 v149, 0xff800000
v_mov_b32 v150, 0xff800000
v_mov_b32 v151, 0xff800000
v_mov_b32 v152, 0xff800000
v_mov_b32 v153, 0xff800000
v_mov_b32 v154, 0xff800000
v_mov_b32 v155, 0xff800000
v_mov_b32 v156, 0xff800000
v_mov_b32 v157, 0xff800000
v_mov_b32 v158, 0xff800000
v_mov_b32 v159, 0xff800000
s_branch Lfb_30
Lfx_33:
s_nop 15
v_mov_b32 v160, 0xff800000
v_mov_b32 v161, 0xff800000
v_mov_b32 v162, 0xff800000
v_mov_b32 v163, 0xff800000
v_mov_b32 v164, 0xff800000
v_mov_b32 v165, 0xff800000
v_mov_b32 v166, 0xff800000
v_mov_b32 v167, 0xff800000
v_mov_b32 v168, 0xff800000
v_mov_b32 v169, 0xff800000
v_mov_b32 v170, 0xff800000
v_mov_b32 v171, 0xff800000
v_mov_b32 v172, 0xff800000
v_mov_b32 v173, 0xff800000
v_mov_b32 v174, 0xff800000
v_mov_b32 v175, 0xff800000
s_branch Lfb_34
Lfx_35:
s_nop 15
v_mov_b32 v176, 0xff800000
v_mov_b32 v177, 0xff800000
v_mov_b32 v178, 0xff800000
v_mov_b32 v179, 0xff800000
v_mov_b32 v180, 0xff800000
v_mov_b32 v181, 0xff800000
v_mov_b32 v182, 0xff800000
v_mov_b32 v183, 0xff800000
v_mov_b32 v184, 0xff800000
v_mov_b32 v185, 0xff800000
v_mov_b32 v186, 0xff800000
v_mov_b32 v187, 0xff800000
v_mov_b32 v188, 0xff800000
v_mov_b32 v189, 0xff800000
v_mov_b32 v190, 0xff800000
v_mov_b32 v191, 0xff800000
s_branch Lfb_36
Lfx_37:
s_nop 15
v_mov_b32 v192, 0xff800000
v_mov_b32 v193, 0xff800000
v_mov_b32 v194, 0xff800000
v_mov_b32 v195, 0xff800000
v_mov_b32 v196, 0xff800000
v_mov_b32 v197, 0xff800000
v_mov_b32 v198, 0xff800000
v_mov_b32 v199, 0xff800000
v_mov_b32 v200, 0xff800000
v_mov_b32 v201, 0xff800000
v_mov_b32 v202, 0xff800000
v_mov_b32 v203, 0xff800000
v_mov_b32 v204, 0xff800000
v_mov_b32 v205, 0xff800000
v_mov_b32 v206, 0xff800000
v_mov_b32 v207, 0xff800000
s_branch Lfb_38
Lfx_39:
s_nop 15
v_mov_b32 v208, 0xff800000
v_mov_b32 v209, 0xff800000
v_mov_b32 v210, 0xff800000
v_mov_b32 v211, 0xff800000
v_mov_b32 v212, 0xff800000
v_mov_b32 v213, 0xff800000
v_mov_b32 v214, 0xff800000
v_mov_b32 v215, 0xff800000
v_mov_b32 v216, 0xff800000
v_mov_b32 v217, 0xff800000
v_mov_b32 v218, 0xff800000
v_mov_b32 v219, 0xff800000
v_mov_b32 v220, 0xff800000
v_mov_b32 v221, 0xff800000
v_mov_b32 v222, 0xff800000
v_mov_b32 v223, 0xff800000
s_branch Lfb_40
Lfx_42:
s_nop 15
v_mov_b32 v224, 0xff800000
v_mov_b32 v225, 0xff800000
v_mov_b32 v226, 0xff800000
v_mov_b32 v227, 0xff800000
v_mov_b32 v228, 0xff800000
v_mov_b32 v229, 0xff800000
v_mov_b32 v230, 0xff800000
v_mov_b32 v231, 0xff800000
v_mov_b32 v232, 0xff800000
v_mov_b32 v233, 0xff800000
v_mov_b32 v234, 0xff800000
v_mov_b32 v235, 0xff800000
v_mov_b32 v236, 0xff800000
v_mov_b32 v237, 0xff800000
v_mov_b32 v238, 0xff800000
v_mov_b32 v239, 0xff800000
s_branch Lfb_43
Lfx_49:
s_nop 15
v_mov_b32 v240, 0xff800000
v_mov_b32 v241, 0xff800000
v_mov_b32 v242, 0xff800000
v_mov_b32 v243, 0xff800000
v_mov_b32 v244, 0xff800000
v_mov_b32 v245, 0xff800000
v_mov_b32 v246, 0xff800000
v_mov_b32 v247, 0xff800000
v_mov_b32 v248, 0xff800000
v_mov_b32 v249, 0xff800000
v_mov_b32 v250, 0xff800000
v_mov_b32 v251, 0xff800000
v_mov_b32 v252, 0xff800000
v_mov_b32 v253, 0xff800000
v_mov_b32 v254, 0xff800000
v_mov_b32 v255, 0xff800000
s_branch Lfb_50
L_fin:
s_endpgm
L_vpath:
.p2align 3
s_barrier
ds_read_b128 v[96:99], v64 offset:0
ds_read_b64_tr_b16 v[12:13], v0 offset:0
ds_read_b64_tr_b16 v[14:15], v0 offset:512
ds_read_b64_tr_b16 v[16:17], v1 offset:0
ds_read_b64_tr_b16 v[18:19], v1 offset:512
ds_read_b64_tr_b16 v[20:21], v0 offset:2048
ds_read_b64_tr_b16 v[22:23], v0 offset:2560
ds_read_b64_tr_b16 v[24:25], v1 offset:2048
ds_read_b64_tr_b16 v[26:27], v1 offset:2560
ds_read_b128 v[100:103], v65 offset:0
ds_read_b128 v[104:107], v66 offset:0
ds_read_b128 v[108:111], v67 offset:0
s_waitcnt lgkmcnt(7)
v_mfma_f32_32x32x16_bf16 v[32:47], v[96:99], v[12:15], 0
ds_read_b64_tr_b16 v[28:29], v0 offset:4096
ds_read_b64_tr_b16 v[30:31], v0 offset:4608
v_mfma_f32_4x4x4_16b_bf16 v[76:79], v[96:97], v[96:97], 0
v_mfma_f32_4x4x4_16b_bf16 v[80:83], v[98:99], v[98:99], 0
v_mfma_f32_16x16x32_bf16 v[72:75], v[68:71], v[96:99], 0
v_mfma_f32_32x32x16_bf16 v[48:63], v[96:99], v[16:19], 0
ds_read_b64_tr_b16 v[12:13], v1 offset:4096
ds_read_b64_tr_b16 v[14:15], v1 offset:4608
s_waitcnt lgkmcnt(6)
v_mfma_f32_32x32x16_bf16 v[32:47], v[100:103], v[20:23], v[32:47]
ds_read_b64_tr_b16 v[16:17], v0 offset:6144
ds_read_b64_tr_b16 v[18:19], v0 offset:6656
v_mfma_f32_4x4x4_16b_bf16 v[76:79], v[100:101], v[100:101], v[76:79]
v_mfma_f32_4x4x4_16b_bf16 v[80:83], v[102:103], v[102:103], v[80:83]
v_mfma_f32_16x16x32_bf16 v[72:75], v[68:71], v[100:103], v[72:75]
v_mfma_f32_32x32x16_bf16 v[48:63], v[100:103], v[24:27], v[48:63]
ds_read_b64_tr_b16 v[20:21], v1 offset:6144
ds_read_b64_tr_b16 v[22:23], v1 offset:6656
s_waitcnt lgkmcnt(4)
v_mfma_f32_32x32x16_bf16 v[32:47], v[104:107], v[28:31], v[32:47]
s_barrier
ds_read_b64_tr_b16 v[24:25], v0 offset:8192
ds_read_b64_tr_b16 v[26:27], v0 offset:8704
ds_read_b128 v[112:115], v64 offset:16384
v_mfma_f32_4x4x4_16b_bf16 v[76:79], v[104:105], v[104:105], v[76:79]
v_mfma_f32_4x4x4_16b_bf16 v[80:83], v[106:107], v[106:107], v[80:83]
v_mfma_f32_16x16x32_bf16 v[72:75], v[68:71], v[104:107], v[72:75]
v_mfma_f32_32x32x16_bf16 v[48:63], v[104:107], v[12:15], v[48:63]
ds_read_b64_tr_b16 v[28:29], v1 offset:8192
ds_read_b64_tr_b16 v[30:31], v1 offset:8704
ds_read_b128 v[116:119], v65 offset:16384
s_waitcnt lgkmcnt(6)
v_mfma_f32_32x32x16_bf16 v[32:47], v[108:111], v[16:19], v[32:47]
ds_read_b64_tr_b16 v[12:13], v0 offset:10240
ds_read_b64_tr_b16 v[14:15], v0 offset:10752
ds_read_b128 v[120:123], v66 offset:16384
v_mfma_f32_4x4x4_16b_bf16 v[76:79], v[108:109], v[108:109], v[76:79]
v_mfma_f32_4x4x4_16b_bf16 v[80:83], v[110:111], v[110:111], v[80:83]
v_mfma_f32_16x16x32_bf16 v[72:75], v[68:71], v[108:111], v[72:75]
v_mfma_f32_32x32x16_bf16 v[48:63], v[108:111], v[20:23], v[48:63]
ds_read_b64_tr_b16 v[16:17], v1 offset:10240
ds_read_b64_tr_b16 v[18:19], v1 offset:10752
ds_read_b128 v[124:127], v67 offset:16384
s_waitcnt lgkmcnt(7)
v_mfma_f32_32x32x16_bf16 v[32:47], v[112:115], v[24:27], v[32:47]
ds_read_b64_tr_b16 v[20:21], v0 offset:12288
ds_read_b64_tr_b16 v[22:23], v0 offset:12800
v_mfma_f32_4x4x4_16b_bf16 v[76:79], v[112:113], v[112:113], v[76:79]
v_mfma_f32_4x4x4_16b_bf16 v[80:83], v[114:115], v[114:115], v[80:83]
v_mfma_f32_16x16x32_bf16 v[72:75], v[68:71], v[112:115], v[72:75]
v_mfma_f32_32x32x16_bf16 v[48:63], v[112:115], v[28:31], v[48:63]
ds_read_b64_tr_b16 v[24:25], v1 offset:12288
ds_read_b64_tr_b16 v[26:27], v1 offset:12800
s_waitcnt lgkmcnt(5)
v_mfma_f32_32x32x16_bf16 v[32:47], v[116:119], v[12:15], v[32:47]
ds_read_b64_tr_b16 v[28:29], v0 offset:14336
ds_read_b64_tr_b16 v[30:31], v0 offset:14848
v_mfma_f32_4x4x4_16b_bf16 v[76:79], v[116:117], v[116:117], v[76:79]
v_mfma_f32_4x4x4_16b_bf16 v[80:83], v[118:119], v[118:119], v[80:83]
v_mfma_f32_16x16x32_bf16 v[72:75], v[68:71], v[116:119], v[72:75]
v_mfma_f32_32x32x16_bf16 v[48:63], v[116:119], v[16:19], v[48:63]
ds_read_b64_tr_b16 v[12:13], v1 offset:14336
ds_read_b64_tr_b16 v[14:15], v1 offset:14848
s_waitcnt lgkmcnt(4)
v_mfma_f32_32x32x16_bf16 v[32:47], v[120:123], v[20:23], v[32:47]
s_barrier
ds_read_b64_tr_b16 v[16:17], v0 offset:16384
ds_read_b64_tr_b16 v[18:19], v0 offset:16896
ds_read_b128 v[128:131], v64 offset:32768
v_mfma_f32_4x4x4_16b_bf16 v[76:79], v[120:121], v[120:121], v[76:79]
v_mfma_f32_4x4x4_16b_bf16 v[80:83], v[122:123], v[122:123], v[80:83]
v_mfma_f32_16x16x32_bf16 v[72:75], v[68:71], v[120:123], v[72:75]
v_mfma_f32_32x32x16_bf16 v[48:63], v[120:123], v[24:27], v[48:63]
ds_read_b64_tr_b16 v[20:21], v1 offset:16384
ds_read_b64_tr_b16 v[22:23], v1 offset:16896
ds_read_b128 v[132:135], v65 offset:32768
s_waitcnt lgkmcnt(6)
v_mfma_f32_32x32x16_bf16 v[32:47], v[124:127], v[28:31], v[32:47]
ds_read_b64_tr_b16 v[24:25], v0 offset:18432
ds_read_b64_tr_b16 v[26:27], v0 offset:18944
ds_read_b128 v[136:139], v66 offset:32768
v_mfma_f32_4x4x4_16b_bf16 v[76:79], v[124:125], v[124:125], v[76:79]
v_mfma_f32_4x4x4_16b_bf16 v[80:83], v[126:127], v[126:127], v[80:83]
v_mfma_f32_16x16x32_bf16 v[72:75], v[68:71], v[124:127], v[72:75]
v_mfma_f32_32x32x16_bf16 v[48:63], v[124:127], v[12:15], v[48:63]
ds_read_b64_tr_b16 v[28:29], v1 offset:18432
ds_read_b64_tr_b16 v[30:31], v1 offset:18944
ds_read_b128 v[140:143], v67 offset:32768
s_waitcnt lgkmcnt(7)
v_mfma_f32_32x32x16_bf16 v[32:47], v[128:131], v[16:19], v[32:47]
ds_read_b64_tr_b16 v[12:13], v0 offset:20480
ds_read_b64_tr_b16 v[14:15], v0 offset:20992
v_mfma_f32_4x4x4_16b_bf16 v[76:79], v[128:129], v[128:129], v[76:79]
v_mfma_f32_4x4x4_16b_bf16 v[80:83], v[130:131], v[130:131], v[80:83]
v_mfma_f32_16x16x32_bf16 v[72:75], v[68:71], v[128:131], v[72:75]
v_mfma_f32_32x32x16_bf16 v[48:63], v[128:131], v[20:23], v[48:63]
ds_read_b64_tr_b16 v[16:17], v1 offset:20480
ds_read_b64_tr_b16 v[18:19], v1 offset:20992
s_waitcnt lgkmcnt(5)
v_mfma_f32_32x32x16_bf16 v[32:47], v[132:135], v[24:27], v[32:47]
ds_read_b64_tr_b16 v[20:21], v0 offset:22528
ds_read_b64_tr_b16 v[22:23], v0 offset:23040
v_mfma_f32_4x4x4_16b_bf16 v[76:79], v[132:133], v[132:133], v[76:79]
v_mfma_f32_4x4x4_16b_bf16 v[80:83], v[134:135], v[134:135], v[80:83]
v_mfma_f32_16x16x32_bf16 v[72:75], v[68:71], v[132:135], v[72:75]
v_mfma_f32_32x32x16_bf16 v[48:63], v[132:135], v[28:31], v[48:63]
ds_read_b64_tr_b16 v[24:25], v1 offset:22528
ds_read_b64_tr_b16 v[26:27], v1 offset:23040
s_waitcnt lgkmcnt(4)
v_mfma_f32_32x32x16_bf16 v[32:47], v[136:139], v[12:15], v[32:47]
s_barrier
ds_read_b64_tr_b16 v[28:29], v0 offset:24576
ds_read_b64_tr_b16 v[30:31], v0 offset:25088
ds_read_b128 v[144:147], v64 offset:49152
v_mfma_f32_4x4x4_16b_bf16 v[76:79], v[136:137], v[136:137], v[76:79]
v_mfma_f32_4x4x4_16b_bf16 v[80:83], v[138:139], v[138:139], v[80:83]
v_mfma_f32_16x16x32_bf16 v[72:75], v[68:71], v[136:139], v[72:75]
v_mfma_f32_32x32x16_bf16 v[48:63], v[136:139], v[16:19], v[48:63]
ds_read_b64_tr_b16 v[12:13], v1 offset:24576
ds_read_b64_tr_b16 v[14:15], v1 offset:25088
ds_read_b128 v[148:151], v65 offset:49152
s_waitcnt lgkmcnt(6)
v_mfma_f32_32x32x16_bf16 v[32:47], v[140:143], v[20:23], v[32:47]
ds_read_b64_tr_b16 v[16:17], v0 offset:26624
ds_read_b64_tr_b16 v[18:19], v0 offset:27136
ds_read_b128 v[152:155], v66 offset:49152
v_mfma_f32_4x4x4_16b_bf16 v[76:79], v[140:141], v[140:141], v[76:79]
v_mfma_f32_4x4x4_16b_bf16 v[80:83], v[142:143], v[142:143], v[80:83]
v_mfma_f32_16x16x32_bf16 v[72:75], v[68:71], v[140:143], v[72:75]
v_mfma_f32_32x32x16_bf16 v[48:63], v[140:143], v[24:27], v[48:63]
ds_read_b64_tr_b16 v[20:21], v1 offset:26624
ds_read_b64_tr_b16 v[22:23], v1 offset:27136
ds_read_b128 v[156:159], v67 offset:49152
s_waitcnt lgkmcnt(7)
v_mfma_f32_32x32x16_bf16 v[32:47], v[144:147], v[28:31], v[32:47]
ds_read_b64_tr_b16 v[24:25], v0 offset:28672
ds_read_b64_tr_b16 v[26:27], v0 offset:29184
v_mfma_f32_4x4x4_16b_bf16 v[76:79], v[144:145], v[144:145], v[76:79]
v_mfma_f32_4x4x4_16b_bf16 v[80:83], v[146:147], v[146:147], v[80:83]
v_mfma_f32_16x16x32_bf16 v[72:75], v[68:71], v[144:147], v[72:75]
v_mfma_f32_32x32x16_bf16 v[48:63], v[144:147], v[12:15], v[48:63]
ds_read_b64_tr_b16 v[28:29], v1 offset:28672
ds_read_b64_tr_b16 v[30:31], v1 offset:29184
s_waitcnt lgkmcnt(5)
v_mfma_f32_32x32x16_bf16 v[32:47], v[148:151], v[16:19], v[32:47]
ds_read_b64_tr_b16 v[12:13], v0 offset:30720
ds_read_b64_tr_b16 v[14:15], v0 offset:31232
v_mfma_f32_4x4x4_16b_bf16 v[76:79], v[148:149], v[148:149], v[76:79]
v_mfma_f32_4x4x4_16b_bf16 v[80:83], v[150:151], v[150:151], v[80:83]
v_mfma_f32_16x16x32_bf16 v[72:75], v[68:71], v[148:151], v[72:75]
v_mfma_f32_32x32x16_bf16 v[48:63], v[148:151], v[20:23], v[48:63]
ds_read_b64_tr_b16 v[16:17], v1 offset:30720
ds_read_b64_tr_b16 v[18:19], v1 offset:31232
s_waitcnt lgkmcnt(4)
v_mfma_f32_32x32x16_bf16 v[32:47], v[152:155], v[24:27], v[32:47]
s_barrier
ds_read_b64_tr_b16 v[20:21], v0 offset:32768
ds_read_b64_tr_b16 v[22:23], v0 offset:33280
ds_read_b128 v[160:163], v64 offset:0
v_mfma_f32_4x4x4_16b_bf16 v[76:79], v[152:153], v[152:153], v[76:79]
v_mfma_f32_4x4x4_16b_bf16 v[80:83], v[154:155], v[154:155], v[80:83]
v_mfma_f32_16x16x32_bf16 v[72:75], v[68:71], v[152:155], v[72:75]
v_mfma_f32_32x32x16_bf16 v[48:63], v[152:155], v[28:31], v[48:63]
ds_read_b64_tr_b16 v[24:25], v1 offset:32768
ds_read_b64_tr_b16 v[26:27], v1 offset:33280
ds_read_b128 v[164:167], v65 offset:0
s_waitcnt lgkmcnt(6)
v_mfma_f32_32x32x16_bf16 v[32:47], v[156:159], v[12:15], v[32:47]
ds_read_b64_tr_b16 v[28:29], v0 offset:34816
ds_read_b64_tr_b16 v[30:31], v0 offset:35328
ds_read_b128 v[168:171], v66 offset:0
v_mfma_f32_4x4x4_16b_bf16 v[76:79], v[156:157], v[156:157], v[76:79]
v_mfma_f32_4x4x4_16b_bf16 v[80:83], v[158:159], v[158:159], v[80:83]
v_mfma_f32_16x16x32_bf16 v[72:75], v[68:71], v[156:159], v[72:75]
v_mfma_f32_32x32x16_bf16 v[48:63], v[156:159], v[16:19], v[48:63]
ds_read_b64_tr_b16 v[12:13], v1 offset:34816
ds_read_b64_tr_b16 v[14:15], v1 offset:35328
ds_read_b128 v[172:175], v67 offset:0
s_waitcnt lgkmcnt(7)
v_mfma_f32_32x32x16_bf16 v[32:47], v[160:163], v[20:23], v[32:47]
ds_read_b64_tr_b16 v[16:17], v0 offset:36864
ds_read_b64_tr_b16 v[18:19], v0 offset:37376
v_mfma_f32_4x4x4_16b_bf16 v[76:79], v[160:161], v[160:161], v[76:79]
v_mfma_f32_4x4x4_16b_bf16 v[80:83], v[162:163], v[162:163], v[80:83]
v_mfma_f32_16x16x32_bf16 v[72:75], v[68:71], v[160:163], v[72:75]
v_mfma_f32_32x32x16_bf16 v[48:63], v[160:163], v[24:27], v[48:63]
ds_read_b64_tr_b16 v[20:21], v1 offset:36864
ds_read_b64_tr_b16 v[22:23], v1 offset:37376
s_waitcnt lgkmcnt(5)
v_mfma_f32_32x32x16_bf16 v[32:47], v[164:167], v[28:31], v[32:47]
ds_read_b64_tr_b16 v[24:25], v0 offset:38912
ds_read_b64_tr_b16 v[26:27], v0 offset:39424
v_mfma_f32_4x4x4_16b_bf16 v[76:79], v[164:165], v[164:165], v[76:79]
v_mfma_f32_4x4x4_16b_bf16 v[80:83], v[166:167], v[166:167], v[80:83]
v_mfma_f32_16x16x32_bf16 v[72:75], v[68:71], v[164:167], v[72:75]
v_mfma_f32_32x32x16_bf16 v[48:63], v[164:167], v[12:15], v[48:63]
ds_read_b64_tr_b16 v[28:29], v1 offset:38912
ds_read_b64_tr_b16 v[30:31], v1 offset:39424
s_waitcnt lgkmcnt(4)
v_mfma_f32_32x32x16_bf16 v[32:47], v[168:171], v[16:19], v[32:47]
s_barrier
ds_read_b64_tr_b16 v[12:13], v0 offset:40960
ds_read_b64_tr_b16 v[14:15], v0 offset:41472
ds_read_b128 v[176:179], v64 offset:16384
v_mfma_f32_4x4x4_16b_bf16 v[76:79], v[168:169], v[168:169], v[76:79]
v_mfma_f32_4x4x4_16b_bf16 v[80:83], v[170:171], v[170:171], v[80:83]
v_mfma_f32_16x16x32_bf16 v[72:75], v[68:71], v[168:171], v[72:75]
v_mfma_f32_32x32x16_bf16 v[48:63], v[168:171], v[20:23], v[48:63]
ds_read_b64_tr_b16 v[16:17], v1 offset:40960
ds_read_b64_tr_b16 v[18:19], v1 offset:41472
ds_read_b128 v[180:183], v65 offset:16384
s_waitcnt lgkmcnt(6)
v_mfma_f32_32x32x16_bf16 v[32:47], v[172:175], v[24:27], v[32:47]
ds_read_b64_tr_b16 v[20:21], v0 offset:43008
ds_read_b64_tr_b16 v[22:23], v0 offset:43520
ds_read_b128 v[184:187], v66 offset:16384
v_mfma_f32_4x4x4_16b_bf16 v[76:79], v[172:173], v[172:173], v[76:79]
v_mfma_f32_4x4x4_16b_bf16 v[80:83], v[174:175], v[174:175], v[80:83]
v_mfma_f32_16x16x32_bf16 v[72:75], v[68:71], v[172:175], v[72:75]
v_mfma_f32_32x32x16_bf16 v[48:63], v[172:175], v[28:31], v[48:63]
ds_read_b64_tr_b16 v[24:25], v1 offset:43008
ds_read_b64_tr_b16 v[26:27], v1 offset:43520
ds_read_b128 v[188:191], v67 offset:16384
s_waitcnt lgkmcnt(7)
v_mfma_f32_32x32x16_bf16 v[32:47], v[176:179], v[12:15], v[32:47]
ds_read_b64_tr_b16 v[28:29], v0 offset:45056
ds_read_b64_tr_b16 v[30:31], v0 offset:45568
v_mfma_f32_4x4x4_16b_bf16 v[76:79], v[176:177], v[176:177], v[76:79]
v_mfma_f32_4x4x4_16b_bf16 v[80:83], v[178:179], v[178:179], v[80:83]
v_mfma_f32_16x16x32_bf16 v[72:75], v[68:71], v[176:179], v[72:75]
v_mfma_f32_32x32x16_bf16 v[48:63], v[176:179], v[16:19], v[48:63]
ds_read_b64_tr_b16 v[12:13], v1 offset:45056
ds_read_b64_tr_b16 v[14:15], v1 offset:45568
s_waitcnt lgkmcnt(5)
v_mfma_f32_32x32x16_bf16 v[32:47], v[180:183], v[20:23], v[32:47]
ds_read_b64_tr_b16 v[16:17], v0 offset:47104
ds_read_b64_tr_b16 v[18:19], v0 offset:47616
v_mfma_f32_4x4x4_16b_bf16 v[76:79], v[180:181], v[180:181], v[76:79]
v_mfma_f32_4x4x4_16b_bf16 v[80:83], v[182:183], v[182:183], v[80:83]
v_mfma_f32_16x16x32_bf16 v[72:75], v[68:71], v[180:183], v[72:75]
v_mfma_f32_32x32x16_bf16 v[48:63], v[180:183], v[24:27], v[48:63]
ds_read_b64_tr_b16 v[20:21], v1 offset:47104
ds_read_b64_tr_b16 v[22:23], v1 offset:47616
s_waitcnt lgkmcnt(4)
v_mfma_f32_32x32x16_bf16 v[32:47], v[184:187], v[28:31], v[32:47]
s_barrier
ds_read_b64_tr_b16 v[24:25], v0 offset:49152
ds_read_b64_tr_b16 v[26:27], v0 offset:49664
ds_read_b128 v[192:195], v64 offset:32768
v_mfma_f32_4x4x4_16b_bf16 v[76:79], v[184:185], v[184:185], v[76:79]
v_mfma_f32_4x4x4_16b_bf16 v[80:83], v[186:187], v[186:187], v[80:83]
v_mfma_f32_16x16x32_bf16 v[72:75], v[68:71], v[184:187], v[72:75]
v_mfma_f32_32x32x16_bf16 v[48:63], v[184:187], v[12:15], v[48:63]
ds_read_b64_tr_b16 v[28:29], v1 offset:49152
ds_read_b64_tr_b16 v[30:31], v1 offset:49664
ds_read_b128 v[196:199], v65 offset:32768
s_waitcnt lgkmcnt(6)
v_mfma_f32_32x32x16_bf16 v[32:47], v[188:191], v[16:19], v[32:47]
ds_read_b64_tr_b16 v[12:13], v0 offset:51200
ds_read_b64_tr_b16 v[14:15], v0 offset:51712
ds_read_b128 v[200:203], v66 offset:32768
v_mfma_f32_4x4x4_16b_bf16 v[76:79], v[188:189], v[188:189], v[76:79]
v_mfma_f32_4x4x4_16b_bf16 v[80:83], v[190:191], v[190:191], v[80:83]
v_mfma_f32_16x16x32_bf16 v[72:75], v[68:71], v[188:191], v[72:75]
v_mfma_f32_32x32x16_bf16 v[48:63], v[188:191], v[20:23], v[48:63]
ds_read_b64_tr_b16 v[16:17], v1 offset:51200
ds_read_b64_tr_b16 v[18:19], v1 offset:51712
ds_read_b128 v[204:207], v67 offset:32768
s_waitcnt lgkmcnt(7)
v_mfma_f32_32x32x16_bf16 v[32:47], v[192:195], v[24:27], v[32:47]
ds_read_b64_tr_b16 v[20:21], v0 offset:53248
ds_read_b64_tr_b16 v[22:23], v0 offset:53760
v_mfma_f32_4x4x4_16b_bf16 v[76:79], v[192:193], v[192:193], v[76:79]
v_mfma_f32_4x4x4_16b_bf16 v[80:83], v[194:195], v[194:195], v[80:83]
v_mfma_f32_16x16x32_bf16 v[72:75], v[68:71], v[192:195], v[72:75]
v_mfma_f32_32x32x16_bf16 v[48:63], v[192:195], v[28:31], v[48:63]
ds_read_b64_tr_b16 v[24:25], v1 offset:53248
ds_read_b64_tr_b16 v[26:27], v1 offset:53760
s_waitcnt lgkmcnt(5)
v_mfma_f32_32x32x16_bf16 v[32:47], v[196:199], v[12:15], v[32:47]
ds_read_b64_tr_b16 v[28:29], v0 offset:55296
ds_read_b64_tr_b16 v[30:31], v0 offset:55808
v_mfma_f32_4x4x4_16b_bf16 v[76:79], v[196:197], v[196:197], v[76:79]
v_mfma_f32_4x4x4_16b_bf16 v[80:83], v[198:199], v[198:199], v[80:83]
v_mfma_f32_16x16x32_bf16 v[72:75], v[68:71], v[196:199], v[72:75]
v_mfma_f32_32x32x16_bf16 v[48:63], v[196:199], v[16:19], v[48:63]
ds_read_b64_tr_b16 v[12:13], v1 offset:55296
ds_read_b64_tr_b16 v[14:15], v1 offset:55808
s_waitcnt lgkmcnt(4)
v_mfma_f32_32x32x16_bf16 v[32:47], v[200:203], v[20:23], v[32:47]
s_barrier
ds_read_b64_tr_b16 v[16:17], v0 offset:57344
ds_read_b64_tr_b16 v[18:19], v0 offset:57856
ds_read_b128 v[208:211], v64 offset:49152
v_mfma_f32_4x4x4_16b_bf16 v[76:79], v[200:201], v[200:201], v[76:79]
v_mfma_f32_4x4x4_16b_bf16 v[80:83], v[202:203], v[202:203], v[80:83]
v_mfma_f32_16x16x32_bf16 v[72:75], v[68:71], v[200:203], v[72:75]
v_mfma_f32_32x32x16_bf16 v[48:63], v[200:203], v[24:27], v[48:63]
ds_read_b64_tr_b16 v[20:21], v1 offset:57344
ds_read_b64_tr_b16 v[22:23], v1 offset:57856
ds_read_b128 v[212:215], v65 offset:49152
s_waitcnt lgkmcnt(6)
v_mfma_f32_32x32x16_bf16 v[32:47], v[204:207], v[28:31], v[32:47]
ds_read_b64_tr_b16 v[24:25], v0 offset:59392
ds_read_b64_tr_b16 v[26:27], v0 offset:59904
ds_read_b128 v[216:219], v66 offset:49152
v_mfma_f32_4x4x4_16b_bf16 v[76:79], v[204:205], v[204:205], v[76:79]
v_mfma_f32_4x4x4_16b_bf16 v[80:83], v[206:207], v[206:207], v[80:83]
v_mfma_f32_16x16x32_bf16 v[72:75], v[68:71], v[204:207], v[72:75]
v_mfma_f32_32x32x16_bf16 v[48:63], v[204:207], v[12:15], v[48:63]
ds_read_b64_tr_b16 v[28:29], v1 offset:59392
ds_read_b64_tr_b16 v[30:31], v1 offset:59904
ds_read_b128 v[220:223], v67 offset:49152
s_waitcnt lgkmcnt(7)
v_mfma_f32_32x32x16_bf16 v[32:47], v[208:211], v[16:19], v[32:47]
ds_read_b64_tr_b16 v[12:13], v0 offset:61440
ds_read_b64_tr_b16 v[14:15], v0 offset:61952
v_mfma_f32_4x4x4_16b_bf16 v[76:79], v[208:209], v[208:209], v[76:79]
v_mfma_f32_4x4x4_16b_bf16 v[80:83], v[210:211], v[210:211], v[80:83]
v_mfma_f32_16x16x32_bf16 v[72:75], v[68:71], v[208:211], v[72:75]
v_mfma_f32_32x32x16_bf16 v[48:63], v[208:211], v[20:23], v[48:63]
ds_read_b64_tr_b16 v[16:17], v1 offset:61440
ds_read_b64_tr_b16 v[18:19], v1 offset:61952
s_waitcnt lgkmcnt(5)
v_mfma_f32_32x32x16_bf16 v[32:47], v[212:215], v[24:27], v[32:47]
ds_read_b64_tr_b16 v[20:21], v0 offset:63488
ds_read_b64_tr_b16 v[22:23], v0 offset:64000
v_mfma_f32_4x4x4_16b_bf16 v[76:79], v[212:213], v[212:213], v[76:79]
v_mfma_f32_4x4x4_16b_bf16 v[80:83], v[214:215], v[214:215], v[80:83]
v_mfma_f32_16x16x32_bf16 v[72:75], v[68:71], v[212:215], v[72:75]
v_mfma_f32_32x32x16_bf16 v[48:63], v[212:215], v[28:31], v[48:63]
ds_read_b64_tr_b16 v[24:25], v1 offset:63488
ds_read_b64_tr_b16 v[26:27], v1 offset:64000
s_waitcnt lgkmcnt(4)
v_mfma_f32_32x32x16_bf16 v[32:47], v[216:219], v[12:15], v[32:47]
s_barrier
ds_read_b64_tr_b16 v[28:29], v0 offset:0
ds_read_b64_tr_b16 v[30:31], v0 offset:512
ds_read_b128 v[224:227], v64 offset:0
v_mfma_f32_4x4x4_16b_bf16 v[76:79], v[216:217], v[216:217], v[76:79]
v_mfma_f32_4x4x4_16b_bf16 v[80:83], v[218:219], v[218:219], v[80:83]
v_mfma_f32_16x16x32_bf16 v[72:75], v[68:71], v[216:219], v[72:75]
v_mfma_f32_32x32x16_bf16 v[48:63], v[216:219], v[16:19], v[48:63]
ds_read_b64_tr_b16 v[12:13], v1 offset:0
ds_read_b64_tr_b16 v[14:15], v1 offset:512
ds_read_b128 v[228:231], v65 offset:0
s_waitcnt lgkmcnt(6)
v_mfma_f32_32x32x16_bf16 v[32:47], v[220:223], v[20:23], v[32:47]
ds_read_b64_tr_b16 v[16:17], v0 offset:2048
ds_read_b64_tr_b16 v[18:19], v0 offset:2560
ds_read_b128 v[232:235], v66 offset:0
v_mfma_f32_4x4x4_16b_bf16 v[76:79], v[220:221], v[220:221], v[76:79]
v_mfma_f32_4x4x4_16b_bf16 v[80:83], v[222:223], v[222:223], v[80:83]
v_mfma_f32_16x16x32_bf16 v[72:75], v[68:71], v[220:223], v[72:75]
v_mfma_f32_32x32x16_bf16 v[48:63], v[220:223], v[24:27], v[48:63]
ds_read_b64_tr_b16 v[20:21], v1 offset:2048
ds_read_b64_tr_b16 v[22:23], v1 offset:2560
ds_read_b128 v[236:239], v67 offset:0
s_waitcnt lgkmcnt(7)
v_mfma_f32_32x32x16_bf16 v[32:47], v[224:227], v[28:31], v[32:47]
ds_read_b64_tr_b16 v[24:25], v0 offset:4096
ds_read_b64_tr_b16 v[26:27], v0 offset:4608
v_mfma_f32_4x4x4_16b_bf16 v[76:79], v[224:225], v[224:225], v[76:79]
v_mfma_f32_4x4x4_16b_bf16 v[80:83], v[226:227], v[226:227], v[80:83]
v_mfma_f32_16x16x32_bf16 v[72:75], v[68:71], v[224:227], v[72:75]
v_mfma_f32_32x32x16_bf16 v[48:63], v[224:227], v[12:15], v[48:63]
ds_read_b64_tr_b16 v[28:29], v1 offset:4096
ds_read_b64_tr_b16 v[30:31], v1 offset:4608
s_waitcnt lgkmcnt(5)
v_mfma_f32_32x32x16_bf16 v[32:47], v[228:231], v[16:19], v[32:47]
ds_read_b64_tr_b16 v[12:13], v0 offset:6144
ds_read_b64_tr_b16 v[14:15], v0 offset:6656
v_mfma_f32_4x4x4_16b_bf16 v[76:79], v[228:229], v[228:229], v[76:79]
v_mfma_f32_4x4x4_16b_bf16 v[80:83], v[230:231], v[230:231], v[80:83]
v_mfma_f32_16x16x32_bf16 v[72:75], v[68:71], v[228:231], v[72:75]
v_mfma_f32_32x32x16_bf16 v[48:63], v[228:231], v[20:23], v[48:63]
ds_read_b64_tr_b16 v[16:17], v1 offset:6144
ds_read_b64_tr_b16 v[18:19], v1 offset:6656
s_waitcnt lgkmcnt(4)
v_mfma_f32_32x32x16_bf16 v[32:47], v[232:235], v[24:27], v[32:47]
s_waitcnt vmcnt(0)
s_barrier
ds_read_b64_tr_b16 v[20:21], v0 offset:8192
ds_read_b64_tr_b16 v[22:23], v0 offset:8704
ds_read_b128 v[240:243], v64 offset:16384
v_mfma_f32_4x4x4_16b_bf16 v[76:79], v[232:233], v[232:233], v[76:79]
v_mfma_f32_4x4x4_16b_bf16 v[80:83], v[234:235], v[234:235], v[80:83]
v_mfma_f32_16x16x32_bf16 v[72:75], v[68:71], v[232:235], v[72:75]
v_mfma_f32_32x32x16_bf16 v[48:63], v[232:235], v[28:31], v[48:63]
ds_read_b64_tr_b16 v[24:25], v1 offset:8192
ds_read_b64_tr_b16 v[26:27], v1 offset:8704
ds_read_b128 v[244:247], v65 offset:16384
s_waitcnt lgkmcnt(6)
v_mfma_f32_32x32x16_bf16 v[32:47], v[236:239], v[12:15], v[32:47]
ds_read_b64_tr_b16 v[28:29], v0 offset:10240
ds_read_b64_tr_b16 v[30:31], v0 offset:10752
ds_read_b128 v[248:251], v66 offset:16384
v_mfma_f32_4x4x4_16b_bf16 v[76:79], v[236:237], v[236:237], v[76:79]
v_mfma_f32_4x4x4_16b_bf16 v[80:83], v[238:239], v[238:239], v[80:83]
v_mfma_f32_16x16x32_bf16 v[72:75], v[68:71], v[236:239], v[72:75]
v_mfma_f32_32x32x16_bf16 v[48:63], v[236:239], v[16:19], v[48:63]
ds_read_b64_tr_b16 v[12:13], v1 offset:10240
ds_read_b64_tr_b16 v[14:15], v1 offset:10752
ds_read_b128 v[252:255], v67 offset:16384
s_waitcnt lgkmcnt(7)
v_mfma_f32_32x32x16_bf16 v[32:47], v[240:243], v[20:23], v[32:47]
ds_read_b64_tr_b16 v[16:17], v0 offset:12288
ds_read_b64_tr_b16 v[18:19], v0 offset:12800
v_mfma_f32_4x4x4_16b_bf16 v[76:79], v[240:241], v[240:241], v[76:79]
v_mfma_f32_4x4x4_16b_bf16 v[80:83], v[242:243], v[242:243], v[80:83]
v_mfma_f32_16x16x32_bf16 v[72:75], v[68:71], v[240:243], v[72:75]
v_mfma_f32_32x32x16_bf16 v[48:63], v[240:243], v[24:27], v[48:63]
ds_read_b64_tr_b16 v[20:21], v1 offset:12288
ds_read_b64_tr_b16 v[22:23], v1 offset:12800
s_waitcnt lgkmcnt(5)
v_mfma_f32_32x32x16_bf16 v[32:47], v[244:247], v[28:31], v[32:47]
ds_read_b64_tr_b16 v[24:25], v0 offset:14336
ds_read_b64_tr_b16 v[26:27], v0 offset:14848
v_mfma_f32_4x4x4_16b_bf16 v[76:79], v[244:245], v[244:245], v[76:79]
v_mfma_f32_4x4x4_16b_bf16 v[80:83], v[246:247], v[246:247], v[80:83]
v_mfma_f32_16x16x32_bf16 v[72:75], v[68:71], v[244:247], v[72:75]
v_mfma_f32_32x32x16_bf16 v[48:63], v[244:247], v[12:15], v[48:63]
ds_read_b64_tr_b16 v[28:29], v1 offset:14336
ds_read_b64_tr_b16 v[30:31], v1 offset:14848
s_waitcnt lgkmcnt(4)
v_mfma_f32_32x32x16_bf16 v[32:47], v[248:251], v[16:19], v[32:47]
s_barrier
ds_read_b64_tr_b16 v[12:13], v0 offset:16384
ds_read_b64_tr_b16 v[14:15], v0 offset:16896
v_mfma_f32_4x4x4_16b_bf16 v[76:79], v[248:249], v[248:249], v[76:79]
v_mfma_f32_4x4x4_16b_bf16 v[80:83], v[250:251], v[250:251], v[80:83]
v_mfma_f32_16x16x32_bf16 v[72:75], v[68:71], v[248:251], v[72:75]
v_mfma_f32_32x32x16_bf16 v[48:63], v[248:251], v[20:23], v[48:63]
ds_read_b64_tr_b16 v[16:17], v1 offset:16384
ds_read_b64_tr_b16 v[18:19], v1 offset:16896
s_waitcnt lgkmcnt(4)
v_mfma_f32_32x32x16_bf16 v[32:47], v[252:255], v[24:27], v[32:47]
ds_read_b64_tr_b16 v[20:21], v0 offset:18432
ds_read_b64_tr_b16 v[22:23], v0 offset:18944
v_mfma_f32_4x4x4_16b_bf16 v[76:79], v[252:253], v[252:253], v[76:79]
v_mfma_f32_4x4x4_16b_bf16 v[80:83], v[254:255], v[254:255], v[80:83]
v_mfma_f32_16x16x32_bf16 v[72:75], v[68:71], v[252:255], v[72:75]
v_mfma_f32_32x32x16_bf16 v[48:63], v[252:255], v[28:31], v[48:63]
ds_read_b64_tr_b16 v[24:25], v1 offset:18432
ds_read_b64_tr_b16 v[26:27], v1 offset:18944
s_nop 0
v_add_f32 v8, v76, v80
v_add_f32 v9, v77, v81
v_add_f32 v10, v78, v82
v_add_f32 v11, v79, v83
v_permlane16_swap_b32 v72, v73
v_mov_b32 v4, v72
v_mov_b32 v6, v72
s_waitcnt lgkmcnt(4)
v_mfma_f32_32x32x16_bf16 v[64:79], v[96:99], v[12:15], 0
ds_read_b64_tr_b16 v[28:29], v0 offset:20480
ds_read_b64_tr_b16 v[30:31], v0 offset:20992
s_mov_b32 s66, 0x22222222
s_mov_b32 s67, 0x22222222
v_cndmask_b32 v8, v8, v9, s[66:67]
s_mov_b32 s66, 0x44444444
s_mov_b32 s67, 0x44444444
v_cndmask_b32 v8, v8, v10, s[66:67]
s_mov_b32 s66, 0x88888888
s_mov_b32 s67, 0x88888888
v_cndmask_b32 v8, v8, v11, s[66:67]
v_mfma_f32_32x32x16_bf16 v[80:95], v[96:99], v[16:19], 0
ds_read_b64_tr_b16 v[12:13], v1 offset:20480
ds_read_b64_tr_b16 v[14:15], v1 offset:20992
v_permlane32_swap_b32 v6, v4
v_mov_b32 v9, v8
v_mul_f32 v6, 0x3acccccd, v6
s_waitcnt lgkmcnt(4)
v_mfma_f32_32x32x16_bf16 v[64:79], v[100:103], v[20:23], v[64:79]
ds_read_b64_tr_b16 v[16:17], v0 offset:22528
ds_read_b64_tr_b16 v[18:19], v0 offset:23040
v_permlane32_swap_b32 v9, v8
v_add_f32 v8, v8, v9
v_mul_f32 v8, 0x3acccccd, v8
v_mfma_f32_32x32x16_bf16 v[80:95], v[100:103], v[24:27], v[80:95]
ds_read_b64_tr_b16 v[20:21], v1 offset:22528
ds_read_b64_tr_b16 v[22:23], v1 offset:23040
v_fma_f32 v8, -v6, v6, v8
v_max_f32 v8, 0, v8
v_sub_f32 v6, 0, v6
s_waitcnt lgkmcnt(4)
v_mfma_f32_32x32x16_bf16 v[64:79], v[104:107], v[28:31], v[64:79]
ds_read_b64_tr_b16 v[24:25], v0 offset:24576
ds_read_b64_tr_b16 v[26:27], v0 offset:25088
v_cvt_pk_bf16_f32 v8, v8, v8
v_and_b32 v8, 0xffff0000, v8
v_add_f32 v8, 0x3727c5ac, v8
v_mfma_f32_32x32x16_bf16 v[80:95], v[104:107], v[12:15], v[80:95]
ds_read_b64_tr_b16 v[28:29], v1 offset:24576
ds_read_b64_tr_b16 v[30:31], v1 offset:25088
v_cvt_pk_bf16_f32 v4, v6, v6
v_cvt_pk_bf16_f32 v8, v8, v8
v_and_b32 v8, 0xffff0000, v8
s_waitcnt lgkmcnt(4)
v_mfma_f32_32x32x16_bf16 v[64:79], v[108:111], v[16:19], v[64:79]
ds_read_b64_tr_b16 v[12:13], v0 offset:26624
ds_read_b64_tr_b16 v[14:15], v0 offset:27136
v_sqrt_f32 v8, v8
v_mov_b32 v5, 0
v_cvt_pk_bf16_f32 v8, v8, v8
v_mfma_f32_32x32x16_bf16 v[80:95], v[108:111], v[20:23], v[80:95]
ds_read_b64_tr_b16 v[16:17], v1 offset:26624
ds_read_b64_tr_b16 v[18:19], v1 offset:27136
v_and_b32 v8, 0xffff0000, v8
v_rcp_f32 v7, v8
v_mbcnt_lo_u32_b32 v8, -1, 0
v_mbcnt_hi_u32_b32 v8, -1, v8
s_waitcnt lgkmcnt(4)
v_mfma_f32_32x32x16_bf16 v[64:79], v[112:115], v[24:27], v[64:79]
ds_read_b64_tr_b16 v[20:21], v0 offset:28672
ds_read_b64_tr_b16 v[22:23], v0 offset:29184
v_and_b32 v9, 31, v8
s_lshl_b32 s43, s37, 7
s_add_u32 s43, s43, 143360
v_lshl_add_u32 v9, v9, 2, s43
v_lshrrev_b32 v8, 5, v8
v_lshl_add_u32 v6, v8, 4, s43
ds_write_b32 v9, v7
v_mfma_f32_32x32x16_bf16 v[80:95], v[112:115], v[28:31], v[80:95]
ds_read_b64_tr_b16 v[24:25], v1 offset:28672
ds_read_b64_tr_b16 v[26:27], v1 offset:29184
s_waitcnt lgkmcnt(5)
v_mfma_f32_32x32x16_bf16 v[64:79], v[116:119], v[12:15], v[64:79]
ds_read_b64_tr_b16 v[28:29], v0 offset:30720
ds_read_b64_tr_b16 v[30:31], v0 offset:31232
v_mbcnt_lo_u32_b32 v8, -1, 0
v_mbcnt_hi_u32_b32 v8, -1, v8
v_lshlrev_b32 v9, 3, v8
v_cmp_gt_u32 s[64:65], 32, v8
v_mov_b32 v8, 142336
v_mfma_f32_32x32x16_bf16 v[80:95], v[116:119], v[16:19], v[80:95]
ds_read_b64_tr_b16 v[12:13], v1 offset:30720
ds_read_b64_tr_b16 v[14:15], v1 offset:31232
v_add_u32 v9, 141312, v9
v_cndmask_b32 v8, v8, v9, s[64:65]
s_waitcnt lgkmcnt(4)
v_mfma_f32_32x32x16_bf16 v[64:79], v[120:123], v[20:23], v[64:79]
s_barrier
ds_read_b64_tr_b16 v[16:17], v0 offset:32768
ds_read_b64_tr_b16 v[18:19], v0 offset:33280
ds_read_b64 v[10:11], v8 offset:256
ds_read_b64 v[8:9], v8 offset:0
v_mfma_f32_32x32x16_bf16 v[80:95], v[120:123], v[24:27], v[80:95]
ds_read_b64_tr_b16 v[20:21], v1 offset:32768
ds_read_b64_tr_b16 v[22:23], v1 offset:33280
s_waitcnt lgkmcnt(6)
v_mfma_f32_32x32x16_bf16 v[64:79], v[124:127], v[28:31], v[64:79]
ds_read_b64_tr_b16 v[24:25], v0 offset:34816
ds_read_b64_tr_b16 v[26:27], v0 offset:35328
s_waitcnt lgkmcnt(4)
v_mfma_f32_32x32x8_bf16 v[32:47], v[4:5], v[8:9], v[32:47]
v_mfma_f32_32x32x8_bf16 v[48:63], v[4:5], v[10:11], v[48:63]
v_mfma_f32_32x32x16_bf16 v[80:95], v[124:127], v[12:15], v[80:95]
ds_read_b64_tr_b16 v[28:29], v1 offset:34816
ds_read_b64_tr_b16 v[30:31], v1 offset:35328
s_waitcnt lgkmcnt(4)
v_mfma_f32_32x32x16_bf16 v[64:79], v[128:131], v[16:19], v[64:79]
ds_read_b64_tr_b16 v[12:13], v0 offset:36864
ds_read_b64_tr_b16 v[14:15], v0 offset:37376
v_mfma_f32_32x32x16_bf16 v[80:95], v[128:131], v[20:23], v[80:95]
ds_read_b64_tr_b16 v[16:17], v1 offset:36864
ds_read_b64_tr_b16 v[18:19], v1 offset:37376
s_waitcnt lgkmcnt(4)
v_mfma_f32_32x32x16_bf16 v[64:79], v[132:135], v[24:27], v[64:79]
ds_read_b64_tr_b16 v[20:21], v0 offset:38912
ds_read_b64_tr_b16 v[22:23], v0 offset:39424
ds_read_b128 v[8:11], v6 offset:0
s_waitcnt lgkmcnt(0)
v_mul_f32 v32, v32, v8
v_mfma_f32_32x32x16_bf16 v[80:95], v[132:135], v[28:31], v[80:95]
ds_read_b64_tr_b16 v[24:25], v1 offset:38912
ds_read_b64_tr_b16 v[26:27], v1 offset:39424
v_mul_f32 v33, v33, v9
v_mul_f32 v34, v34, v10
v_mul_f32 v35, v35, v11
v_mfma_f32_32x32x16_bf16 v[64:79], v[136:139], v[12:15], v[64:79]
ds_read_b64_tr_b16 v[28:29], v0 offset:40960
ds_read_b64_tr_b16 v[30:31], v0 offset:41472
v_mul_f32 v48, v48, v8
v_mul_f32 v49, v49, v9
v_mul_f32 v50, v50, v10
v_mfma_f32_32x32x16_bf16 v[80:95], v[136:139], v[16:19], v[80:95]
ds_read_b64_tr_b16 v[12:13], v1 offset:40960
ds_read_b64_tr_b16 v[14:15], v1 offset:41472
v_mul_f32 v51, v51, v11
ds_read_b128 v[8:11], v6 offset:32
v_cvt_pk_bf16_f32 v32, v32, v33
s_waitcnt lgkmcnt(5)
v_mfma_f32_32x32x16_bf16 v[64:79], v[140:143], v[20:23], v[64:79]
ds_read_b64_tr_b16 v[16:17], v0 offset:43008
ds_read_b64_tr_b16 v[18:19], v0 offset:43520
v_cvt_pk_bf16_f32 v33, v34, v35
v_cvt_pk_bf16_f32 v48, v48, v49
v_cvt_pk_bf16_f32 v49, v50, v51
v_mfma_f32_32x32x16_bf16 v[80:95], v[140:143], v[24:27], v[80:95]
ds_read_b64_tr_b16 v[20:21], v1 offset:43008
ds_read_b64_tr_b16 v[22:23], v1 offset:43520
s_waitcnt lgkmcnt(4)
v_mul_f32 v36, v36, v8
v_mul_f32 v37, v37, v9
v_mfma_f32_32x32x16_bf16 v[64:79], v[144:147], v[28:31], v[64:79]
ds_read_b64_tr_b16 v[24:25], v0 offset:45056
ds_read_b64_tr_b16 v[26:27], v0 offset:45568
v_mul_f32 v38, v38, v10
v_mul_f32 v39, v39, v11
v_mul_f32 v52, v52, v8
v_mfma_f32_32x32x16_bf16 v[80:95], v[144:147], v[12:15], v[80:95]
ds_read_b64_tr_b16 v[28:29], v1 offset:45056
ds_read_b64_tr_b16 v[30:31], v1 offset:45568
v_mul_f32 v53, v53, v9
v_mul_f32 v54, v54, v10
v_mul_f32 v55, v55, v11
s_waitcnt lgkmcnt(4)
v_mfma_f32_32x32x16_bf16 v[64:79], v[148:151], v[16:19], v[64:79]
ds_read_b64_tr_b16 v[12:13], v0 offset:47104
ds_read_b64_tr_b16 v[14:15], v0 offset:47616
ds_read_b128 v[8:11], v6 offset:64
v_cvt_pk_bf16_f32 v34, v36, v37
v_cvt_pk_bf16_f32 v35, v38, v39
v_mfma_f32_32x32x16_bf16 v[80:95], v[148:151], v[20:23], v[80:95]
ds_read_b64_tr_b16 v[16:17], v1 offset:47104
ds_read_b64_tr_b16 v[18:19], v1 offset:47616
v_cvt_pk_bf16_f32 v50, v52, v53
v_cvt_pk_bf16_f32 v51, v54, v55
s_waitcnt lgkmcnt(2)
v_mfma_f32_32x32x16_bf16 v[64:79], v[152:155], v[24:27], v[64:79]
s_barrier
ds_read_b64_tr_b16 v[20:21], v0 offset:49152
ds_read_b64_tr_b16 v[22:23], v0 offset:49664
v_mul_f32 v40, v40, v8
v_mul_f32 v41, v41, v9
v_mul_f32 v42, v42, v10
v_mfma_f32_32x32x16_bf16 v[80:95], v[152:155], v[28:31], v[80:95]
ds_read_b64_tr_b16 v[24:25], v1 offset:49152
ds_read_b64_tr_b16 v[26:27], v1 offset:49664
v_mul_f32 v43, v43, v11
v_mul_f32 v56, v56, v8
v_mul_f32 v57, v57, v9
s_waitcnt lgkmcnt(4)
v_mfma_f32_32x32x16_bf16 v[64:79], v[156:159], v[12:15], v[64:79]
ds_read_b64_tr_b16 v[28:29], v0 offset:51200
ds_read_b64_tr_b16 v[30:31], v0 offset:51712
v_mul_f32 v58, v58, v10
v_mul_f32 v59, v59, v11
ds_read_b128 v[8:11], v6 offset:96
v_mfma_f32_32x32x16_bf16 v[80:95], v[156:159], v[16:19], v[80:95]
ds_read_b64_tr_b16 v[12:13], v1 offset:51200
ds_read_b64_tr_b16 v[14:15], v1 offset:51712
v_cvt_pk_bf16_f32 v36, v40, v41
v_cvt_pk_bf16_f32 v37, v42, v43
v_cvt_pk_bf16_f32 v52, v56, v57
s_waitcnt lgkmcnt(5)
v_mfma_f32_32x32x16_bf16 v[64:79], v[160:163], v[20:23], v[64:79]
ds_read_b64_tr_b16 v[16:17], v0 offset:53248
ds_read_b64_tr_b16 v[18:19], v0 offset:53760
v_cvt_pk_bf16_f32 v53, v58, v59
s_waitcnt lgkmcnt(4)
v_mul_f32 v44, v44, v8
v_mfma_f32_32x32x16_bf16 v[80:95], v[160:163], v[24:27], v[80:95]
ds_read_b64_tr_b16 v[20:21], v1 offset:53248
ds_read_b64_tr_b16 v[22:23], v1 offset:53760
v_mul_f32 v45, v45, v9
v_mul_f32 v46, v46, v10
v_mul_f32 v47, v47, v11
s_waitcnt lgkmcnt(4)
v_mfma_f32_32x32x16_bf16 v[64:79], v[164:167], v[28:31], v[64:79]
ds_read_b64_tr_b16 v[24:25], v0 offset:55296
ds_read_b64_tr_b16 v[26:27], v0 offset:55808
v_mul_f32 v60, v60, v8
v_mul_f32 v61, v61, v9
v_mul_f32 v62, v62, v10
v_mfma_f32_32x32x16_bf16 v[80:95], v[164:167], v[12:15], v[80:95]
ds_read_b64_tr_b16 v[28:29], v1 offset:55296
ds_read_b64_tr_b16 v[30:31], v1 offset:55808
v_mul_f32 v63, v63, v11
v_cvt_pk_bf16_f32 v38, v44, v45
v_cvt_pk_bf16_f32 v39, v46, v47
s_waitcnt lgkmcnt(4)
v_mfma_f32_32x32x16_bf16 v[64:79], v[168:171], v[16:19], v[64:79]
ds_read_b64_tr_b16 v[12:13], v0 offset:57344
ds_read_b64_tr_b16 v[14:15], v0 offset:57856
v_cvt_pk_bf16_f32 v54, v60, v61
v_cvt_pk_bf16_f32 v55, v62, v63
v_mbcnt_lo_u32_b32 v8, -1, 0
v_mbcnt_hi_u32_b32 v8, -1, v8
v_mfma_f32_32x32x16_bf16 v[80:95], v[168:171], v[20:23], v[80:95]
ds_read_b64_tr_b16 v[16:17], v1 offset:57344
ds_read_b64_tr_b16 v[18:19], v1 offset:57856
v_lshrrev_b32 v9, 5, v8
v_lshlrev_b32 v8, 4, v8
v_mul_u32_u24 v9, 9728, v9
s_waitcnt lgkmcnt(4)
v_mfma_f32_32x32x16_bf16 v[64:79], v[172:175], v[24:27], v[64:79]
ds_read_b64_tr_b16 v[20:21], v0 offset:59392
ds_read_b64_tr_b16 v[22:23], v0 offset:59904
v_add_u32 v8, v8, v9
s_add_u32 s43, s50, 0
buffer_store_dwordx4 v[32:35], v8, s[16:19], s43 offen sc1
s_add_u32 s43, s50, 20480
buffer_store_dwordx4 v[36:39], v8, s[16:19], s43 offen sc1
s_add_u32 s43, s50, 512
buffer_store_dwordx4 v[48:51], v8, s[16:19], s43 offen sc1
s_add_u32 s43, s50, 20992
buffer_store_dwordx4 v[52:55], v8, s[16:19], s43 offen sc1
v_mfma_f32_32x32x16_bf16 v[80:95], v[172:175], v[28:31], v[80:95]
ds_read_b64_tr_b16 v[24:25], v1 offset:59392
ds_read_b64_tr_b16 v[26:27], v1 offset:59904
s_waitcnt lgkmcnt(4)
v_mfma_f32_32x32x16_bf16 v[64:79], v[176:179], v[12:15], v[64:79]
ds_read_b64_tr_b16 v[28:29], v0 offset:61440
ds_read_b64_tr_b16 v[30:31], v0 offset:61952
v_mfma_f32_32x32x16_bf16 v[80:95], v[176:179], v[16:19], v[80:95]
ds_read_b64_tr_b16 v[12:13], v1 offset:61440
ds_read_b64_tr_b16 v[14:15], v1 offset:61952
s_waitcnt lgkmcnt(4)
v_mfma_f32_32x32x16_bf16 v[64:79], v[180:183], v[20:23], v[64:79]
ds_read_b64_tr_b16 v[16:17], v0 offset:63488
ds_read_b64_tr_b16 v[18:19], v0 offset:64000
v_mfma_f32_32x32x16_bf16 v[80:95], v[180:183], v[24:27], v[80:95]
ds_read_b64_tr_b16 v[20:21], v1 offset:63488
ds_read_b64_tr_b16 v[22:23], v1 offset:64000
s_waitcnt lgkmcnt(4)
v_mfma_f32_32x32x16_bf16 v[64:79], v[184:187], v[28:31], v[64:79]
s_barrier
ds_read_b64_tr_b16 v[24:25], v2 offset:32768
ds_read_b64_tr_b16 v[26:27], v2 offset:33280
v_mfma_f32_32x32x16_bf16 v[80:95], v[184:187], v[12:15], v[80:95]
ds_read_b64_tr_b16 v[28:29], v3 offset:32768
ds_read_b64_tr_b16 v[30:31], v3 offset:33280
s_waitcnt lgkmcnt(4)
v_mfma_f32_32x32x16_bf16 v[64:79], v[188:191], v[16:19], v[64:79]
ds_read_b64_tr_b16 v[12:13], v2 offset:34816
ds_read_b64_tr_b16 v[14:15], v2 offset:35328
v_mfma_f32_32x32x16_bf16 v[80:95], v[188:191], v[20:23], v[80:95]
ds_read_b64_tr_b16 v[16:17], v3 offset:34816
ds_read_b64_tr_b16 v[18:19], v3 offset:35328
s_waitcnt lgkmcnt(4)
v_mfma_f32_32x32x16_bf16 v[64:79], v[192:195], v[24:27], v[64:79]
ds_read_b64_tr_b16 v[20:21], v2 offset:36864
ds_read_b64_tr_b16 v[22:23], v2 offset:37376
v_mfma_f32_32x32x16_bf16 v[80:95], v[192:195], v[28:31], v[80:95]
ds_read_b64_tr_b16 v[24:25], v3 offset:36864
ds_read_b64_tr_b16 v[26:27], v3 offset:37376
s_waitcnt lgkmcnt(4)
v_mfma_f32_32x32x16_bf16 v[64:79], v[196:199], v[12:15], v[64:79]
ds_read_b64_tr_b16 v[28:29], v2 offset:38912
ds_read_b64_tr_b16 v[30:31], v2 offset:39424
v_mfma_f32_32x32x16_bf16 v[80:95], v[196:199], v[16:19], v[80:95]
ds_read_b64_tr_b16 v[12:13], v3 offset:38912
ds_read_b64_tr_b16 v[14:15], v3 offset:39424
s_waitcnt lgkmcnt(4)
v_mfma_f32_32x32x16_bf16 v[64:79], v[200:203], v[20:23], v[64:79]
ds_read_b64_tr_b16 v[16:17], v2 offset:40960
ds_read_b64_tr_b16 v[18:19], v2 offset:41472
v_mfma_f32_32x32x16_bf16 v[80:95], v[200:203], v[24:27], v[80:95]
ds_read_b64_tr_b16 v[20:21], v3 offset:40960
ds_read_b64_tr_b16 v[22:23], v3 offset:41472
s_waitcnt lgkmcnt(4)
v_mfma_f32_32x32x16_bf16 v[64:79], v[204:207], v[28:31], v[64:79]
ds_read_b64_tr_b16 v[24:25], v2 offset:43008
ds_read_b64_tr_b16 v[26:27], v2 offset:43520
v_mfma_f32_32x32x16_bf16 v[80:95], v[204:207], v[12:15], v[80:95]
ds_read_b64_tr_b16 v[28:29], v3 offset:43008
ds_read_b64_tr_b16 v[30:31], v3 offset:43520
s_waitcnt lgkmcnt(4)
v_mfma_f32_32x32x16_bf16 v[64:79], v[208:211], v[16:19], v[64:79]
ds_read_b64_tr_b16 v[12:13], v2 offset:45056
ds_read_b64_tr_b16 v[14:15], v2 offset:45568
v_mfma_f32_32x32x16_bf16 v[80:95], v[208:211], v[20:23], v[80:95]
ds_read_b64_tr_b16 v[16:17], v3 offset:45056
ds_read_b64_tr_b16 v[18:19], v3 offset:45568
s_waitcnt lgkmcnt(4)
v_mfma_f32_32x32x16_bf16 v[64:79], v[212:215], v[24:27], v[64:79]
ds_read_b64_tr_b16 v[20:21], v2 offset:47104
ds_read_b64_tr_b16 v[22:23], v2 offset:47616
v_mfma_f32_32x32x16_bf16 v[80:95], v[212:215], v[28:31], v[80:95]
ds_read_b64_tr_b16 v[24:25], v3 offset:47104
ds_read_b64_tr_b16 v[26:27], v3 offset:47616
s_waitcnt lgkmcnt(4)
v_mfma_f32_32x32x16_bf16 v[64:79], v[216:219], v[12:15], v[64:79]
s_barrier
ds_read_b64_tr_b16 v[28:29], v2 offset:49152
ds_read_b64_tr_b16 v[30:31], v2 offset:49664
v_mfma_f32_32x32x16_bf16 v[80:95], v[216:219], v[16:19], v[80:95]
ds_read_b64_tr_b16 v[12:13], v3 offset:49152
ds_read_b64_tr_b16 v[14:15], v3 offset:49664
s_waitcnt lgkmcnt(4)
v_mfma_f32_32x32x16_bf16 v[64:79], v[220:223], v[20:23], v[64:79]
ds_read_b64_tr_b16 v[16:17], v2 offset:51200
ds_read_b64_tr_b16 v[18:19], v2 offset:51712
v_mfma_f32_32x32x16_bf16 v[80:95], v[220:223], v[24:27], v[80:95]
ds_read_b64_tr_b16 v[20:21], v3 offset:51200
ds_read_b64_tr_b16 v[22:23], v3 offset:51712
s_waitcnt lgkmcnt(4)
v_mfma_f32_32x32x16_bf16 v[64:79], v[224:227], v[28:31], v[64:79]
ds_read_b64_tr_b16 v[24:25], v2 offset:53248
ds_read_b64_tr_b16 v[26:27], v2 offset:53760
v_mfma_f32_32x32x16_bf16 v[80:95], v[224:227], v[12:15], v[80:95]
ds_read_b64_tr_b16 v[28:29], v3 offset:53248
ds_read_b64_tr_b16 v[30:31], v3 offset:53760
s_waitcnt lgkmcnt(4)
v_mfma_f32_32x32x16_bf16 v[64:79], v[228:231], v[16:19], v[64:79]
ds_read_b64_tr_b16 v[12:13], v2 offset:55296
ds_read_b64_tr_b16 v[14:15], v2 offset:55808
v_mfma_f32_32x32x16_bf16 v[80:95], v[228:231], v[20:23], v[80:95]
ds_read_b64_tr_b16 v[16:17], v3 offset:55296
ds_read_b64_tr_b16 v[18:19], v3 offset:55808
s_waitcnt lgkmcnt(4)
v_mfma_f32_32x32x16_bf16 v[64:79], v[232:235], v[24:27], v[64:79]
ds_read_b64_tr_b16 v[20:21], v2 offset:57344
ds_read_b64_tr_b16 v[22:23], v2 offset:57856
v_mfma_f32_32x32x16_bf16 v[80:95], v[232:235], v[28:31], v[80:95]
ds_read_b64_tr_b16 v[24:25], v3 offset:57344
ds_read_b64_tr_b16 v[26:27], v3 offset:57856
s_waitcnt lgkmcnt(4)
v_mfma_f32_32x32x16_bf16 v[64:79], v[236:239], v[12:15], v[64:79]
ds_read_b64_tr_b16 v[28:29], v2 offset:59392
ds_read_b64_tr_b16 v[30:31], v2 offset:59904
v_mfma_f32_32x32x16_bf16 v[80:95], v[236:239], v[16:19], v[80:95]
ds_read_b64_tr_b16 v[12:13], v3 offset:59392
ds_read_b64_tr_b16 v[14:15], v3 offset:59904
s_waitcnt lgkmcnt(4)
v_mfma_f32_32x32x16_bf16 v[64:79], v[240:243], v[20:23], v[64:79]
ds_read_b64_tr_b16 v[16:17], v2 offset:61440
ds_read_b64_tr_b16 v[18:19], v2 offset:61952
v_mbcnt_lo_u32_b32 v8, -1, 0
v_mbcnt_hi_u32_b32 v8, -1, v8
v_lshlrev_b32 v9, 3, v8
v_cmp_gt_u32 s[64:65], 32, v8
v_mov_b32 v8, 142336
v_mfma_f32_32x32x16_bf16 v[80:95], v[240:243], v[24:27], v[80:95]
ds_read_b64_tr_b16 v[20:21], v3 offset:61440
ds_read_b64_tr_b16 v[22:23], v3 offset:61952
v_add_u32 v9, 141312, v9
v_cndmask_b32 v8, v8, v9, s[64:65]
s_waitcnt lgkmcnt(4)
v_mfma_f32_32x32x16_bf16 v[64:79], v[244:247], v[28:31], v[64:79]
ds_read_b64_tr_b16 v[24:25], v2 offset:63488
ds_read_b64_tr_b16 v[26:27], v2 offset:64000
ds_read_b64 v[10:11], v8 offset:768
ds_read_b64 v[8:9], v8 offset:512
v_mfma_f32_32x32x16_bf16 v[80:95], v[244:247], v[12:15], v[80:95]
ds_read_b64_tr_b16 v[28:29], v3 offset:63488
ds_read_b64_tr_b16 v[30:31], v3 offset:64000
s_waitcnt lgkmcnt(6)
v_mfma_f32_32x32x16_bf16 v[64:79], v[248:251], v[16:19], v[64:79]
s_barrier
ds_read_b64_tr_b16 v[12:13], v2 offset:0
ds_read_b64_tr_b16 v[14:15], v2 offset:512
v_mfma_f32_32x32x16_bf16 v[80:95], v[248:251], v[20:23], v[80:95]
ds_read_b64_tr_b16 v[16:17], v3 offset:0
ds_read_b64_tr_b16 v[18:19], v3 offset:512
s_waitcnt lgkmcnt(4)
v_mfma_f32_32x32x16_bf16 v[64:79], v[252:255], v[24:27], v[64:79]
ds_read_b64_tr_b16 v[20:21], v2 offset:2048
ds_read_b64_tr_b16 v[22:23], v2 offset:2560
v_mfma_f32_32x32x16_bf16 v[80:95], v[252:255], v[28:31], v[80:95]
ds_read_b64_tr_b16 v[24:25], v3 offset:2048
ds_read_b64_tr_b16 v[26:27], v3 offset:2560
v_mfma_f32_32x32x8_bf16 v[64:79], v[4:5], v[8:9], v[64:79]
v_mfma_f32_32x32x8_bf16 v[80:95], v[4:5], v[10:11], v[80:95]
s_waitcnt lgkmcnt(4)
v_mfma_f32_32x32x16_bf16 v[32:47], v[12:15], v[96:99], 0
ds_read_b64_tr_b16 v[28:29], v2 offset:4096
ds_read_b64_tr_b16 v[30:31], v2 offset:4608
v_mfma_f32_32x32x16_bf16 v[48:63], v[16:19], v[96:99], 0
ds_read_b64_tr_b16 v[12:13], v3 offset:4096
ds_read_b64_tr_b16 v[14:15], v3 offset:4608
s_waitcnt lgkmcnt(4)
v_mfma_f32_32x32x16_bf16 v[32:47], v[20:23], v[100:103], v[32:47]
ds_read_b64_tr_b16 v[16:17], v2 offset:6144
ds_read_b64_tr_b16 v[18:19], v2 offset:6656
v_mfma_f32_32x32x16_bf16 v[48:63], v[24:27], v[100:103], v[48:63]
ds_read_b64_tr_b16 v[20:21], v3 offset:6144
ds_read_b64_tr_b16 v[22:23], v3 offset:6656
ds_read_b128 v[8:11], v6 offset:0
s_waitcnt lgkmcnt(0)
v_mul_f32 v64, v64, v8
v_mfma_f32_32x32x16_bf16 v[32:47], v[28:31], v[104:107], v[32:47]
ds_read_b64_tr_b16 v[24:25], v2 offset:8192
ds_read_b64_tr_b16 v[26:27], v2 offset:8704
v_mul_f32 v65, v65, v9
v_mul_f32 v66, v66, v10
v_mul_f32 v67, v67, v11
v_mfma_f32_32x32x16_bf16 v[48:63], v[12:15], v[104:107], v[48:63]
ds_read_b64_tr_b16 v[28:29], v3 offset:8192
ds_read_b64_tr_b16 v[30:31], v3 offset:8704
v_mul_f32 v80, v80, v8
v_mul_f32 v81, v81, v9
v_mul_f32 v82, v82, v10
v_mfma_f32_32x32x16_bf16 v[32:47], v[16:19], v[108:111], v[32:47]
ds_read_b64_tr_b16 v[12:13], v2 offset:10240
ds_read_b64_tr_b16 v[14:15], v2 offset:10752
v_mul_f32 v83, v83, v11
ds_read_b128 v[8:11], v6 offset:32
v_cvt_pk_bf16_f32 v64, v64, v65
v_mfma_f32_32x32x16_bf16 v[48:63], v[20:23], v[108:111], v[48:63]
ds_read_b64_tr_b16 v[16:17], v3 offset:10240
ds_read_b64_tr_b16 v[18:19], v3 offset:10752
v_cvt_pk_bf16_f32 v65, v66, v67
v_cvt_pk_bf16_f32 v80, v80, v81
v_cvt_pk_bf16_f32 v81, v82, v83
s_waitcnt lgkmcnt(5)
v_mfma_f32_32x32x16_bf16 v[32:47], v[24:27], v[112:115], v[32:47]
ds_read_b64_tr_b16 v[20:21], v2 offset:12288
ds_read_b64_tr_b16 v[22:23], v2 offset:12800
s_waitcnt lgkmcnt(4)
v_mul_f32 v68, v68, v8
v_mul_f32 v69, v69, v9
v_mfma_f32_32x32x16_bf16 v[48:63], v[28:31], v[112:115], v[48:63]
ds_read_b64_tr_b16 v[24:25], v3 offset:12288
ds_read_b64_tr_b16 v[26:27], v3 offset:12800
v_mul_f32 v70, v70, v10
v_mul_f32 v71, v71, v11
v_mul_f32 v84, v84, v8
s_waitcnt lgkmcnt(4)
v_mfma_f32_32x32x16_bf16 v[32:47], v[12:15], v[116:119], v[32:47]
ds_read_b64_tr_b16 v[28:29], v2 offset:14336
ds_read_b64_tr_b16 v[30:31], v2 offset:14848
v_mul_f32 v85, v85, v9
v_mul_f32 v86, v86, v10
v_mul_f32 v87, v87, v11
v_mfma_f32_32x32x16_bf16 v[48:63], v[16:19], v[116:119], v[48:63]
ds_read_b64_tr_b16 v[12:13], v3 offset:14336
ds_read_b64_tr_b16 v[14:15], v3 offset:14848
ds_read_b128 v[8:11], v6 offset:64
v_cvt_pk_bf16_f32 v66, v68, v69
v_cvt_pk_bf16_f32 v67, v70, v71
s_waitcnt lgkmcnt(5)
v_mfma_f32_32x32x16_bf16 v[32:47], v[20:23], v[120:123], v[32:47]
s_barrier
ds_read_b64_tr_b16 v[16:17], v2 offset:16384
ds_read_b64_tr_b16 v[18:19], v2 offset:16896
v_cvt_pk_bf16_f32 v82, v84, v85
v_cvt_pk_bf16_f32 v83, v86, v87
s_waitcnt lgkmcnt(2)
v_mfma_f32_32x32x16_bf16 v[48:63], v[24:27], v[120:123], v[48:63]
ds_read_b64_tr_b16 v[20:21], v3 offset:16384
ds_read_b64_tr_b16 v[22:23], v3 offset:16896
v_mul_f32 v72, v72, v8
v_mul_f32 v73, v73, v9
v_mul_f32 v74, v74, v10
v_mfma_f32_32x32x16_bf16 v[32:47], v[28:31], v[124:127], v[32:47]
ds_read_b64_tr_b16 v[24:25], v2 offset:18432
ds_read_b64_tr_b16 v[26:27], v2 offset:18944
v_mul_f32 v75, v75, v11
v_mul_f32 v88, v88, v8
v_mul_f32 v89, v89, v9
v_mfma_f32_32x32x16_bf16 v[48:63], v[12:15], v[124:127], v[48:63]
ds_read_b64_tr_b16 v[28:29], v3 offset:18432
ds_read_b64_tr_b16 v[30:31], v3 offset:18944
v_mul_f32 v90, v90, v10
v_mul_f32 v91, v91, v11
ds_read_b128 v[8:11], v6 offset:96
s_waitcnt lgkmcnt(5)
v_mfma_f32_32x32x16_bf16 v[32:47], v[16:19], v[128:131], v[32:47]
ds_read_b64_tr_b16 v[12:13], v2 offset:20480
ds_read_b64_tr_b16 v[14:15], v2 offset:20992
v_cvt_pk_bf16_f32 v68, v72, v73
v_cvt_pk_bf16_f32 v69, v74, v75
v_cvt_pk_bf16_f32 v84, v88, v89
v_mfma_f32_32x32x16_bf16 v[48:63], v[20:23], v[128:131], v[48:63]
ds_read_b64_tr_b16 v[16:17], v3 offset:20480
ds_read_b64_tr_b16 v[18:19], v3 offset:20992
v_cvt_pk_bf16_f32 v85, v90, v91
s_waitcnt lgkmcnt(4)
v_mul_f32 v76, v76, v8
v_mfma_f32_32x32x16_bf16 v[32:47], v[24:27], v[132:135], v[32:47]
ds_read_b64_tr_b16 v[20:21], v2 offset:22528
ds_read_b64_tr_b16 v[22:23], v2 offset:23040
v_mul_f32 v77, v77, v9
v_mul_f32 v78, v78, v10
v_mul_f32 v79, v79, v11
v_mfma_f32_32x32x16_bf16 v[48:63], v[28:31], v[132:135], v[48:63]
ds_read_b64_tr_b16 v[24:25], v3 offset:22528
ds_read_b64_tr_b16 v[26:27], v3 offset:23040
v_mul_f32 v92, v92, v8
v_mul_f32 v93, v93, v9
v_mul_f32 v94, v94, v10
s_waitcnt lgkmcnt(4)
v_mfma_f32_32x32x16_bf16 v[32:47], v[12:15], v[136:139], v[32:47]
ds_read_b64_tr_b16 v[28:29], v2 offset:24576
ds_read_b64_tr_b16 v[30:31], v2 offset:25088
v_mul_f32 v95, v95, v11
v_cvt_pk_bf16_f32 v70, v76, v77
v_cvt_pk_bf16_f32 v71, v78, v79
v_mfma_f32_32x32x16_bf16 v[48:63], v[16:19], v[136:139], v[48:63]
ds_read_b64_tr_b16 v[12:13], v3 offset:24576
ds_read_b64_tr_b16 v[14:15], v3 offset:25088
v_cvt_pk_bf16_f32 v86, v92, v93
v_cvt_pk_bf16_f32 v87, v94, v95
v_mbcnt_lo_u32_b32 v8, -1, 0
v_mbcnt_hi_u32_b32 v8, -1, v8
s_waitcnt lgkmcnt(4)
v_mfma_f32_32x32x16_bf16 v[32:47], v[20:23], v[140:143], v[32:47]
ds_read_b64_tr_b16 v[16:17], v2 offset:26624
ds_read_b64_tr_b16 v[18:19], v2 offset:27136
v_lshrrev_b32 v9, 5, v8
v_lshlrev_b32 v8, 4, v8
v_mul_u32_u24 v9, 9728, v9
v_mfma_f32_32x32x16_bf16 v[48:63], v[24:27], v[140:143], v[48:63]
ds_read_b64_tr_b16 v[20:21], v3 offset:26624
ds_read_b64_tr_b16 v[22:23], v3 offset:27136
v_add_u32 v8, v8, v9
s_add_u32 s43, s50, 1024
buffer_store_dwordx4 v[64:67], v8, s[16:19], s43 offen sc1
s_add_u32 s43, s50, 21504
buffer_store_dwordx4 v[68:71], v8, s[16:19], s43 offen sc1
s_add_u32 s43, s50, 1536
buffer_store_dwordx4 v[80:83], v8, s[16:19], s43 offen sc1
s_add_u32 s43, s50, 22016
buffer_store_dwordx4 v[84:87], v8, s[16:19], s43 offen sc1
s_waitcnt lgkmcnt(4)
v_mfma_f32_32x32x16_bf16 v[32:47], v[28:31], v[144:147], v[32:47]
ds_read_b64_tr_b16 v[24:25], v2 offset:28672
ds_read_b64_tr_b16 v[26:27], v2 offset:29184
v_mfma_f32_32x32x16_bf16 v[48:63], v[12:15], v[144:147], v[48:63]
ds_read_b64_tr_b16 v[28:29], v3 offset:28672
ds_read_b64_tr_b16 v[30:31], v3 offset:29184
s_waitcnt lgkmcnt(4)
v_mfma_f32_32x32x16_bf16 v[32:47], v[16:19], v[148:151], v[32:47]
ds_read_b64_tr_b16 v[12:13], v2 offset:30720
ds_read_b64_tr_b16 v[14:15], v2 offset:31232
v_mfma_f32_32x32x16_bf16 v[48:63], v[20:23], v[148:151], v[48:63]
ds_read_b64_tr_b16 v[16:17], v3 offset:30720
ds_read_b64_tr_b16 v[18:19], v3 offset:31232
s_waitcnt lgkmcnt(4)
v_mfma_f32_32x32x16_bf16 v[32:47], v[24:27], v[152:155], v[32:47]
s_barrier
ds_read_b64_tr_b16 v[20:21], v0 offset:0
ds_read_b64_tr_b16 v[22:23], v0 offset:512
v_mfma_f32_32x32x16_bf16 v[48:63], v[28:31], v[152:155], v[48:63]
ds_read_b64_tr_b16 v[24:25], v1 offset:0
ds_read_b64_tr_b16 v[26:27], v1 offset:512
s_waitcnt lgkmcnt(4)
v_mfma_f32_32x32x16_bf16 v[32:47], v[12:15], v[156:159], v[32:47]
ds_read_b64_tr_b16 v[28:29], v0 offset:2048
ds_read_b64_tr_b16 v[30:31], v0 offset:2560
v_mfma_f32_32x32x16_bf16 v[48:63], v[16:19], v[156:159], v[48:63]
ds_read_b64_tr_b16 v[12:13], v1 offset:2048
ds_read_b64_tr_b16 v[14:15], v1 offset:2560
s_waitcnt lgkmcnt(4)
v_mfma_f32_32x32x16_bf16 v[32:47], v[20:23], v[160:163], v[32:47]
ds_read_b64_tr_b16 v[16:17], v0 offset:4096
ds_read_b64_tr_b16 v[18:19], v0 offset:4608
v_mfma_f32_32x32x16_bf16 v[48:63], v[24:27], v[160:163], v[48:63]
ds_read_b64_tr_b16 v[20:21], v1 offset:4096
ds_read_b64_tr_b16 v[22:23], v1 offset:4608
s_waitcnt lgkmcnt(4)
v_mfma_f32_32x32x16_bf16 v[32:47], v[28:31], v[164:167], v[32:47]
ds_read_b64_tr_b16 v[24:25], v0 offset:6144
ds_read_b64_tr_b16 v[26:27], v0 offset:6656
v_mfma_f32_32x32x16_bf16 v[48:63], v[12:15], v[164:167], v[48:63]
ds_read_b64_tr_b16 v[28:29], v1 offset:6144
ds_read_b64_tr_b16 v[30:31], v1 offset:6656
s_waitcnt lgkmcnt(4)
v_mfma_f32_32x32x16_bf16 v[32:47], v[16:19], v[168:171], v[32:47]
ds_read_b64_tr_b16 v[12:13], v0 offset:8192
ds_read_b64_tr_b16 v[14:15], v0 offset:8704
v_mfma_f32_32x32x16_bf16 v[48:63], v[20:23], v[168:171], v[48:63]
ds_read_b64_tr_b16 v[16:17], v1 offset:8192
ds_read_b64_tr_b16 v[18:19], v1 offset:8704
s_waitcnt lgkmcnt(4)
v_mfma_f32_32x32x16_bf16 v[32:47], v[24:27], v[172:175], v[32:47]
ds_read_b64_tr_b16 v[20:21], v0 offset:10240
ds_read_b64_tr_b16 v[22:23], v0 offset:10752
v_mfma_f32_32x32x16_bf16 v[48:63], v[28:31], v[172:175], v[48:63]
ds_read_b64_tr_b16 v[24:25], v1 offset:10240
ds_read_b64_tr_b16 v[26:27], v1 offset:10752
s_waitcnt lgkmcnt(4)
v_mfma_f32_32x32x16_bf16 v[32:47], v[12:15], v[176:179], v[32:47]
ds_read_b64_tr_b16 v[28:29], v0 offset:12288
ds_read_b64_tr_b16 v[30:31], v0 offset:12800
v_mfma_f32_32x32x16_bf16 v[48:63], v[16:19], v[176:179], v[48:63]
ds_read_b64_tr_b16 v[12:13], v1 offset:12288
ds_read_b64_tr_b16 v[14:15], v1 offset:12800
s_waitcnt lgkmcnt(4)
v_mfma_f32_32x32x16_bf16 v[32:47], v[20:23], v[180:183], v[32:47]
ds_read_b64_tr_b16 v[16:17], v0 offset:14336
ds_read_b64_tr_b16 v[18:19], v0 offset:14848
v_mfma_f32_32x32x16_bf16 v[48:63], v[24:27], v[180:183], v[48:63]
ds_read_b64_tr_b16 v[20:21], v1 offset:14336
ds_read_b64_tr_b16 v[22:23], v1 offset:14848
s_waitcnt lgkmcnt(4)
v_mfma_f32_32x32x16_bf16 v[32:47], v[28:31], v[184:187], v[32:47]
s_waitcnt vmcnt(0)
s_barrier
s_cmp_lg_u32 s36, 4
s_cbranch_scc1 Lk_110
s_lshl_b32 s43, s39, 4
s_add_u32 s43, s43, s40
s_lshl_b32 s43, s43, 6
s_add_u32 s43, s43, 23068672
v_mov_b32 v10, s54
v_mov_b32 v11, s55
s_mov_b64 exec, 1
buffer_store_dwordx2 v[10:11], off, s[16:19], s43 sc1
s_mov_b64 exec, -1
Lk_110:
ds_read_b64_tr_b16 v[24:25], v0 offset:16384
ds_read_b64_tr_b16 v[26:27], v0 offset:16896
v_mfma_f32_32x32x16_bf16 v[48:63], v[12:15], v[184:187], v[48:63]
ds_read_b64_tr_b16 v[28:29], v1 offset:16384
ds_read_b64_tr_b16 v[30:31], v1 offset:16896
s_waitcnt lgkmcnt(4)
v_mfma_f32_32x32x16_bf16 v[32:47], v[16:19], v[188:191], v[32:47]
ds_read_b64_tr_b16 v[12:13], v0 offset:18432
ds_read_b64_tr_b16 v[14:15], v0 offset:18944
v_mfma_f32_32x32x16_bf16 v[48:63], v[20:23], v[188:191], v[48:63]
ds_read_b64_tr_b16 v[16:17], v1 offset:18432
ds_read_b64_tr_b16 v[18:19], v1 offset:18944
s_branch L_join
L_service:
s_setprio 0
s_and_b32 s43, s2, 3
s_lshl_b32 s53, s43, 2
s_lshr_b32 s43, s39, 2
s_and_b32 s43, s43, 2
s_add_u32 s53, s53, s43
s_and_b32 s43, s39, 1
s_add_u32 s53, s53, s43
s_lshr_b32 s48, s2, 4
s_lshr_b32 s49, s2, 3
s_and_b32 s49, s49, 1
s_and_b32 s43, s2, 7
s_lshl_b32 s43, s43, 1
s_add_u32 s49, s49, s43
s_lshr_b32 s38, s36, 2
s_add_u32 s61, s60, 128
s_cmp_lt_u32 s40, 14
s_cselect_b32 s62, s60, 1073741824
s_cmp_lt_u32 s40, 13
s_cselect_b32 s63, s61, 1073741824
s_mov_b32 s14, 2211840
s_mov_b32 s15, 0x20000
s_mov_b32 s18, 33554432
s_mov_b32 s19, 0x20000
s_mov_b32 s22, 2621440
s_mov_b32 s23, 0x20000
s_mov_b32 s30, 2211840
s_mov_b32 s31, 0x20000
s_mov_b32 s34, 819200
s_mov_b32 s35, 0x20000
s_waitcnt lgkmcnt(0)
s_add_u32 s70, s16, 23265280
s_addc_u32 s71, s17, 0
s_load_dwordx2 s[54:55], s[70:71], 0
s_cbranch_vccnz Lr_111
Lr_111:
v_lshrrev_b32 v1, 3, v0
s_lshl_b32 s43, s36, 3
v_add_u32 v1, s43, v1
v_and_b32 v2, 7, v0
v_bfe_u32 v3, v0, 4, 1
v_lshlrev_b32 v3, 2, v3
v_xor_b32 v3, v3, v2
v_lshlrev_b32 v3, 4, v3
s_movk_i32 s43, 3840
v_mad_u32_u24 v4, v1, s43, v3
s_movk_i32 s43, 3456
v_mad_u32_u24 v5, v1, s43, v3
s_lshl_b32 s3, s36, 14
s_lshl_b32 s61, s53, 8
s_add_u32 s61, s61, 128
s_cmp_lt_u32 s53, 15
s_cselect_b32 s61, s61, 1073741824
s_lshl_b32 s62, s53, 8
s_add_u32 s62, s62, 0
s_cmp_lt_u32 s53, 14
s_cselect_b32 s62, s62, 1073741824
s_lshl_b32 s63, s53, 8
s_add_u32 s63, s63, 128
s_cmp_lt_u32 s53, 13
s_cselect_b32 s63, s63, 1073741824
s_add_u32 m0, s3, 10240
s_add_u32 s43, s61, 0
buffer_load_dwordx4 v4, s[8:11], s43 offen lds
s_add_u32 m0, s3, 11264
s_add_u32 s43, s61, 245760
buffer_load_dwordx4 v4, s[8:11], s43 offen lds
s_add_u32 m0, s3, 12288
s_add_u32 s43, s61, 491520
buffer_load_dwordx4 v4, s[8:11], s43 offen lds
s_add_u32 m0, s3, 13312
s_add_u32 s43, s61, 737280
buffer_load_dwordx4 v4, s[8:11], s43 offen lds
s_add_u32 m0, s3, 14336
s_add_u32 s43, s61, 983040
buffer_load_dwordx4 v4, s[8:11], s43 offen lds
s_add_u32 m0, s3, 15360
s_add_u32 s43, s61, 1228800
buffer_load_dwordx4 v4, s[8:11], s43 offen lds
v_bfe_u32 v1, v0, 2, 2
v_lshrrev_b32 v2, 5, v0
v_lshrrev_b32 v3, 1, v1
v_xor_b32 v2, v2, v3
v_lshlrev_b32 v1, 7, v1
v_lshl_add_u32 v1, v2, 6, v1
v_bfe_u32 v2, v0, 4, 1
v_lshl_add_u32 v1, v2, 5, v1
v_and_b32 v2, 3, v0
v_lshl_add_u32 v1, v2, 3, v1
v_add_u32 v6, s3, v1
v_lshrrev_b32 v1, 4, v0
v_and_b32 v2, 15, v0
v_cmp_eq_u32 s[64:65], v1, v2
v_mov_b32 v12, 0x3f803f80
s_lshl_b32 s43, s36, 2
s_add_u32 s43, s43, 139264
v_lshl_add_u32 v7, v0, 5, s43
v_cndmask_b32 v12, 0, v12, s[64:65]
v_lshlrev_b32 v8, 5, v0
v_add_u32 v8, 139264, v8
v_lshlrev_b32 v9, 3, v0
v_mov_b32 v13, v12
v_mov_b32 v14, v12
v_mov_b32 v15, v12
s_waitcnt lgkmcnt(0)
s_mul_i32 s54, s54, 0x9e3779b1
s_add_u32 s54, s54, 0x7f4a7c15
s_mul_i32 s55, s55, 0x85ebca6b
s_add_u32 s55, s55, 0xc2b2ae35
s_waitcnt vmcnt(5)
ds_read_b64_tr_b16 v[16:17], v6 offset:10240
ds_read_b64_tr_b16 v[18:19], v6 offset:10752
s_waitcnt vmcnt(4)
ds_read_b64_tr_b16 v[20:21], v6 offset:11264
ds_read_b64_tr_b16 v[22:23], v6 offset:11776
s_waitcnt lgkmcnt(2)
v_mfma_f32_16x16x32_bf16 v[28:31], v[12:15], v[16:19], 0
s_add_u32 m0, s3, 0
s_add_u32 s43, s61, 1474560
buffer_load_dwordx4 v4, s[8:11], s43 offen lds
s_waitcnt vmcnt(4)
ds_read_b64_tr_b16 v[16:17], v6 offset:12288
ds_read_b64_tr_b16 v[18:19], v6 offset:12800
s_waitcnt lgkmcnt(2)
v_mfma_f32_16x16x32_bf16 v[28:31], v[12:15], v[20:23], v[28:31]
s_add_u32 m0, s3, 1024
s_add_u32 s43, s61, 1720320
buffer_load_dwordx4 v4, s[8:11], s43 offen lds
s_waitcnt vmcnt(4)
ds_read_b64_tr_b16 v[20:21], v6 offset:13312
ds_read_b64_tr_b16 v[22:23], v6 offset:13824
s_waitcnt lgkmcnt(2)
v_mfma_f32_16x16x32_bf16 v[28:31], v[12:15], v[16:19], v[28:31]
s_add_u32 m0, s3, 2048
s_add_u32 s43, s61, 1966080
buffer_load_dwordx4 v4, s[8:11], s43 offen lds
s_waitcnt vmcnt(4)
ds_read_b64_tr_b16 v[16:17], v6 offset:14336
ds_read_b64_tr_b16 v[18:19], v6 offset:14848
s_waitcnt lgkmcnt(2)
v_mfma_f32_16x16x32_bf16 v[28:31], v[12:15], v[20:23], v[28:31]
s_add_u32 m0, s3, 3072
s_add_u32 s43, s61, 2211840
buffer_load_dwordx4 v4, s[8:11], s43 offen lds
s_waitcnt vmcnt(4)
ds_read_b64_tr_b16 v[20:21], v6 offset:15360
ds_read_b64_tr_b16 v[22:23], v6 offset:15872
s_waitcnt lgkmcnt(2)
v_mfma_f32_16x16x32_bf16 v[28:31], v[12:15], v[16:19], v[28:31]
s_add_u32 m0, s3, 4096
s_add_u32 s43, s62, 0
buffer_load_dwordx4 v5, s[12:15], s43 offen lds
s_waitcnt vmcnt(4)
ds_read_b64_tr_b16 v[16:17], v6 offset:0
ds_read_b64_tr_b16 v[18:19], v6 offset:512
s_waitcnt lgkmcnt(2)
v_mfma_f32_16x16x32_bf16 v[28:31], v[12:15], v[20:23], v[28:31]
s_add_u32 m0, s3, 5120
s_add_u32 s43, s62, 221184
buffer_load_dwordx4 v5, s[12:15], s43 offen lds
s_waitcnt vmcnt(4)
ds_read_b64_tr_b16 v[20:21], v6 offset:1024
ds_read_b64_tr_b16 v[22:23], v6 offset:1536
s_waitcnt lgkmcnt(2)
v_mfma_f32_16x16x32_bf16 v[28:31], v[12:15], v[16:19], v[28:31]
s_add_u32 m0, s3, 6144
s_add_u32 s43, s62, 442368
buffer_load_dwordx4 v5, s[12:15], s43 offen lds
s_waitcnt vmcnt(4)
ds_read_b64_tr_b16 v[16:17], v6 offset:2048
ds_read_b64_tr_b16 v[18:19], v6 offset:2560
s_waitcnt lgkmcnt(2)
v_mfma_f32_16x16x32_bf16 v[28:31], v[12:15], v[20:23], v[28:31]
s_add_u32 m0, s3, 7168
s_add_u32 s43, s62, 663552
buffer_load_dwordx4 v5, s[12:15], s43 offen lds
s_waitcnt vmcnt(4)
ds_read_b64_tr_b16 v[20:21], v6 offset:3072
ds_read_b64_tr_b16 v[22:23], v6 offset:3584
s_waitcnt lgkmcnt(2)
v_mfma_f32_16x16x32_bf16 v[28:31], v[12:15], v[16:19], v[28:31]
s_add_u32 m0, s3, 8192
s_add_u32 s43, s62, 884736
buffer_load_dwordx4 v5, s[12:15], s43 offen lds
s_waitcnt vmcnt(4)
ds_read_b64_tr_b16 v[16:17], v6 offset:4096
ds_read_b64_tr_b16 v[18:19], v6 offset:4608
s_waitcnt lgkmcnt(2)
v_mfma_f32_16x16x32_bf16 v[28:31], v[12:15], v[20:23], v[28:31]
s_add_u32 m0, s3, 9216
s_add_u32 s43, s62, 1105920
buffer_load_dwordx4 v5, s[12:15], s43 offen lds
s_mov_b64 exec, 0xffff
s_nop 3
ds_write_b32 v7, v28 offset:2048
ds_write_b32 v7, v29 offset:2560
ds_write_b32 v7, v30 offset:3072
ds_write_b32 v7, v31 offset:3584
s_mov_b64 exec, -1
s_waitcnt lgkmcnt(0)
s_barrier
s_cmp_lg_u32 s36, 1
s_cbranch_scc1 Lk_112
ds_read_b128 v[48:51], v8 offset:2048
ds_read_b128 v[52:55], v8 offset:2064
s_waitcnt lgkmcnt(0)
v_add_f32 v48, v48, v52
v_add_f32 v49, v49, v53
v_add_f32 v50, v50, v54
v_add_f32 v51, v51, v55
v_add_f32 v48, v48, v49
v_add_f32 v50, v50, v51
v_add_f32 v48, v48, v50
v_cvt_pk_bf16_f32 v49, v48, v48
v_and_b32 v49, 0xffff0000, v49
v_sub_f32 v48, v48, v49
v_cvt_pk_bf16_f32 v50, v49, v48
s_and_b32 s43, s54, 0xbfffbfff
v_mov_b32 v51, s43
s_lshl_b32 s43, s53, 11
s_add_u32 s43, s43, 23200256
buffer_store_dwordx2 v[50:51], v9, s[16:19], s43 offen sc1
Lk_112:
s_waitcnt vmcnt(4)
ds_read_b64_tr_b16 v[20:21], v6 offset:5120
ds_read_b64_tr_b16 v[22:23], v6 offset:5632
v_mfma_f32_16x16x32_bf16 v[24:27], v[12:15], v[16:19], 0
s_add_u32 m0, s3, 10240
s_add_u32 s43, s62, 1327104
buffer_load_dwordx4 v5, s[12:15], s43 offen lds
s_waitcnt vmcnt(4)
ds_read_b64_tr_b16 v[16:17], v6 offset:6144
ds_read_b64_tr_b16 v[18:19], v6 offset:6656
s_waitcnt lgkmcnt(2)
v_mfma_f32_16x16x32_bf16 v[24:27], v[12:15], v[20:23], v[24:27]
s_add_u32 m0, s3, 11264
s_add_u32 s43, s62, 1548288
buffer_load_dwordx4 v5, s[12:15], s43 offen lds
s_waitcnt vmcnt(4)
ds_read_b64_tr_b16 v[20:21], v6 offset:7168
ds_read_b64_tr_b16 v[22:23], v6 offset:7680
s_waitcnt lgkmcnt(2)
v_mfma_f32_16x16x32_bf16 v[24:27], v[12:15], v[16:19], v[24:27]
s_add_u32 m0, s3, 12288
s_add_u32 s43, s62, 1769472
buffer_load_dwordx4 v5, s[12:15], s43 offen lds
s_waitcnt vmcnt(4)
ds_read_b64_tr_b16 v[16:17], v6 offset:8192
ds_read_b64_tr_b16 v[18:19], v6 offset:8704
s_waitcnt lgkmcnt(2)
v_mfma_f32_16x16x32_bf16 v[24:27], v[12:15], v[20:23], v[24:27]
s_add_u32 m0, s3, 13312
s_add_u32 s43, s62, 1990656
buffer_load_dwordx4 v5, s[12:15], s43 offen lds
s_waitcnt vmcnt(4)
ds_read_b64_tr_b16 v[20:21], v6 offset:9216
ds_read_b64_tr_b16 v[22:23], v6 offset:9728
s_waitcnt lgkmcnt(2)
v_mfma_f32_16x16x32_bf16 v[24:27], v[12:15], v[16:19], v[24:27]
s_add_u32 m0, s3, 14336
s_add_u32 s43, s63, 0
buffer_load_dwordx4 v5, s[12:15], s43 offen lds
s_waitcnt vmcnt(4)
ds_read_b64_tr_b16 v[16:17], v6 offset:10240
ds_read_b64_tr_b16 v[18:19], v6 offset:10752
s_waitcnt lgkmcnt(2)
v_mfma_f32_16x16x32_bf16 v[24:27], v[12:15], v[20:23], v[24:27]
s_add_u32 m0, s3, 15360
s_add_u32 s43, s63, 221184
buffer_load_dwordx4 v5, s[12:15], s43 offen lds
s_waitcnt vmcnt(4)
ds_read_b64_tr_b16 v[20:21], v6 offset:11264
ds_read_b64_tr_b16 v[22:23], v6 offset:11776
s_waitcnt lgkmcnt(2)
v_mfma_f32_16x16x32_bf16 v[24:27], v[12:15], v[16:19], v[24:27]
s_add_u32 m0, s3, 0
s_add_u32 s43, s63, 442368
buffer_load_dwordx4 v5, s[12:15], s43 offen lds
s_waitcnt vmcnt(4)
ds_read_b64_tr_b16 v[16:17], v6 offset:12288
ds_read_b64_tr_b16 v[18:19], v6 offset:12800
s_waitcnt lgkmcnt(2)
v_mfma_f32_16x16x32_bf16 v[24:27], v[12:15], v[20:23], v[24:27]
s_add_u32 m0, s3, 1024
s_add_u32 s43, s63, 663552
buffer_load_dwordx4 v5, s[12:15], s43 offen lds
s_waitcnt vmcnt(4)
ds_read_b64_tr_b16 v[20:21], v6 offset:13312
ds_read_b64_tr_b16 v[22:23], v6 offset:13824
s_waitcnt lgkmcnt(2)
v_mfma_f32_16x16x32_bf16 v[24:27], v[12:15], v[16:19], v[24:27]
s_add_u32 m0, s3, 2048
s_add_u32 s43, s63, 884736
buffer_load_dwordx4 v5, s[12:15], s43 offen lds
s_waitcnt vmcnt(4)
ds_read_b64_tr_b16 v[16:17], v6 offset:14336
ds_read_b64_tr_b16 v[18:19], v6 offset:14848
s_waitcnt lgkmcnt(2)
v_mfma_f32_16x16x32_bf16 v[24:27], v[12:15], v[20:23], v[24:27]
s_add_u32 m0, s3, 3072
s_add_u32 s43, s63, 1105920
buffer_load_dwordx4 v5, s[12:15], s43 offen lds
s_mov_b64 exec, 0xffff
s_nop 3
ds_write_b32 v7, v24 offset:0
ds_write_b32 v7, v25 offset:512
ds_write_b32 v7, v26 offset:1024
ds_write_b32 v7, v27 offset:1536
s_mov_b64 exec, -1
s_waitcnt lgkmcnt(0)
s_barrier
s_cmp_lg_u32 s36, 2
s_cbranch_scc1 Lk_113
ds_read_b128 v[48:51], v8 offset:0
ds_read_b128 v[52:55], v8 offset:16
s_waitcnt lgkmcnt(0)
v_add_f32 v48, v48, v52
v_add_f32 v49, v49, v53
v_add_f32 v50, v50, v54
v_add_f32 v51, v51, v55
v_add_f32 v48, v48, v49
v_add_f32 v50, v50, v51
v_add_f32 v48, v48, v50
v_cvt_pk_bf16_f32 v49, v48, v48
v_and_b32 v49, 0xffff0000, v49
v_sub_f32 v48, v48, v49
v_cvt_pk_bf16_f32 v50, v49, v48
s_and_b32 s43, s54, 0xbfffbfff
v_mov_b32 v51, s43
s_lshl_b32 s43, s53, 11
s_add_u32 s43, s43, 23200768
buffer_store_dwordx2 v[50:51], v9, s[16:19], s43 offen sc1
Lk_113:
s_waitcnt vmcnt(4)
ds_read_b64_tr_b16 v[20:21], v6 offset:15360
ds_read_b64_tr_b16 v[22:23], v6 offset:15872
v_mfma_f32_16x16x32_bf16 v[28:31], v[12:15], v[16:19], 0
s_add_u32 m0, s3, 4096
s_add_u32 s43, s63, 1327104
buffer_load_dwordx4 v5, s[12:15], s43 offen lds
s_waitcnt vmcnt(4)
ds_read_b64_tr_b16 v[16:17], v6 offset:0
ds_read_b64_tr_b16 v[18:19], v6 offset:512
s_waitcnt lgkmcnt(2)
v_mfma_f32_16x16x32_bf16 v[28:31], v[12:15], v[20:23], v[28:31]
s_add_u32 m0, s3, 5120
s_add_u32 s43, s63, 1548288
buffer_load_dwordx4 v5, s[12:15], s43 offen lds
s_waitcnt vmcnt(4)
ds_read_b64_tr_b16 v[20:21], v6 offset:1024
ds_read_b64_tr_b16 v[22:23], v6 offset:1536
s_waitcnt lgkmcnt(2)
v_mfma_f32_16x16x32_bf16 v[28:31], v[12:15], v[16:19], v[28:31]
s_add_u32 m0, s3, 6144
s_add_u32 s43, s63, 1769472
buffer_load_dwordx4 v5, s[12:15], s43 offen lds
s_waitcnt vmcnt(4)
ds_read_b64_tr_b16 v[16:17], v6 offset:2048
ds_read_b64_tr_b16 v[18:19], v6 offset:2560
s_waitcnt lgkmcnt(2)
v_mfma_f32_16x16x32_bf16 v[28:31], v[12:15], v[20:23], v[28:31]
s_add_u32 m0, s3, 7168
s_add_u32 s43, s63, 1990656
buffer_load_dwordx4 v5, s[12:15], s43 offen lds
s_waitcnt vmcnt(4)
ds_read_b64_tr_b16 v[20:21], v6 offset:3072
ds_read_b64_tr_b16 v[22:23], v6 offset:3584
s_waitcnt lgkmcnt(2)
v_mfma_f32_16x16x32_bf16 v[28:31], v[12:15], v[16:19], v[28:31]
s_waitcnt vmcnt(3)
ds_read_b64_tr_b16 v[16:17], v6 offset:4096
ds_read_b64_tr_b16 v[18:19], v6 offset:4608
s_waitcnt lgkmcnt(2)
v_mfma_f32_16x16x32_bf16 v[28:31], v[12:15], v[20:23], v[28:31]
s_waitcnt vmcnt(2)
ds_read_b64_tr_b16 v[20:21], v6 offset:5120
ds_read_b64_tr_b16 v[22:23], v6 offset:5632
s_waitcnt lgkmcnt(2)
v_mfma_f32_16x16x32_bf16 v[28:31], v[12:15], v[16:19], v[28:31]
s_waitcnt vmcnt(1)
ds_read_b64_tr_b16 v[16:17], v6 offset:6144
ds_read_b64_tr_b16 v[18:19], v6 offset:6656
s_waitcnt lgkmcnt(2)
v_mfma_f32_16x16x32_bf16 v[28:31], v[12:15], v[20:23], v[28:31]
s_waitcnt vmcnt(0)
ds_read_b64_tr_b16 v[20:21], v6 offset:7168
ds_read_b64_tr_b16 v[22:23], v6 offset:7680
s_waitcnt lgkmcnt(2)
v_mfma_f32_16x16x32_bf16 v[28:31], v[12:15], v[16:19], v[28:31]
s_waitcnt lgkmcnt(0)
v_mfma_f32_16x16x32_bf16 v[28:31], v[12:15], v[20:23], v[28:31]
s_mov_b64 exec, 0xffff
s_nop 6
ds_write_b32 v7, v28 offset:2048
ds_write_b32 v7, v29 offset:2560
ds_write_b32 v7, v30 offset:3072
ds_write_b32 v7, v31 offset:3584
s_mov_b64 exec, -1
s_waitcnt lgkmcnt(0)
s_barrier
s_cmp_lg_u32 s36, 3
s_cbranch_scc1 Lk_114
ds_read_b128 v[48:51], v8 offset:2048
ds_read_b128 v[52:55], v8 offset:2064
s_waitcnt lgkmcnt(0)
v_add_f32 v48, v48, v52
v_add_f32 v49, v49, v53
v_add_f32 v50, v50, v54
v_add_f32 v51, v51, v55
v_add_f32 v48, v48, v49
v_add_f32 v50, v50, v51
v_add_f32 v48, v48, v50
v_cvt_pk_bf16_f32 v49, v48, v48
v_and_b32 v49, 0xffff0000, v49
v_sub_f32 v48, v48, v49
v_cvt_pk_bf16_f32 v50, v49, v48
s_and_b32 s43, s54, 0xbfffbfff
v_mov_b32 v51, s43
s_lshl_b32 s43, s53, 11
s_add_u32 s43, s43, 23201280
buffer_store_dwordx2 v[50:51], v9, s[16:19], s43 offen sc1
Lk_114:
s_barrier
s_cmp_lg_u32 s36, 4
s_cbranch_scc1 Lk_115
s_lshl_b32 s43, s53, 8
s_add_u32 s43, s43, 23171264
v_mov_b32 v48, s54
v_mov_b32 v49, s55
s_mov_b64 exec, 1
buffer_store_dwordx2 v[48:49], off, s[16:19], s43 sc1
s_mov_b64 exec, -1
Lk_115:
v_mov_b32 v1, 143876
v_mov_b32 v2, 0
ds_write_b32 v1, v2
v_mov_b32 v2, 1
v_mov_b32 v3, 1
ds_write_b64 v1, v[2:3] offset:12
ds_write_b64 v1, v[2:3] offset:20
s_waitcnt lgkmcnt(0)
s_barrier
v_mov_b32 v32, 0
s_cbranch_vccz L_att
s_lshl_b32 s45, s48, 4
s_sub_i32 s45, 32, s45
s_lshl_b32 s43, s37, 6
v_add_u32 v48, s43, v0
v_mov_b32 v49, 1073741824
s_movk_i32 s46, 9600
v_mul_u32_u24 v50, 1639, v48
v_lshlrev_b32 v36, 4, v48
v_lshrrev_b32 v50, 16, v50
v_cmp_gt_i32 s[66:67], s45, v50
v_add_u32 v48, 256, v48
v_mad_u32_u24 v36, v50, s46, v36
v_cndmask_b32 v36, v36, v49, s[66:67]
v_mul_u32_u24 v50, 1639, v48
v_lshlrev_b32 v37, 4, v48
v_lshrrev_b32 v50, 16, v50
v_cmp_gt_i32 s[66:67], s45, v50
v_add_u32 v48, 256, v48
v_mad_u32_u24 v37, v50, s46, v37
v_cndmask_b32 v37, v37, v49, s[66:67]
v_mul_u32_u24 v50, 1639, v48
v_lshlrev_b32 v38, 4, v48
v_lshrrev_b32 v50, 16, v50
v_cmp_gt_i32 s[66:67], s45, v50
v_add_u32 v48, 256, v48
v_mad_u32_u24 v38, v50, s46, v38
v_cndmask_b32 v38, v38, v49, s[66:67]
v_mul_u32_u24 v50, 1639, v48
v_lshlrev_b32 v39, 4, v48
v_lshrrev_b32 v50, 16, v50
v_cmp_gt_i32 s[66:67], s45, v50
v_add_u32 v48, 256, v48
v_mad_u32_u24 v39, v50, s46, v39
v_cndmask_b32 v39, v39, v49, s[66:67]
v_mul_u32_u24 v50, 1639, v48
v_lshlrev_b32 v40, 4, v48
v_lshrrev_b32 v50, 16, v50
v_cmp_gt_i32 s[66:67], s45, v50
v_add_u32 v48, 256, v48
v_mad_u32_u24 v40, v50, s46, v40
v_cndmask_b32 v40, v40, v49, s[66:67]
v_mul_u32_u24 v50, 1639, v48
v_lshlrev_b32 v41, 4, v48
v_lshrrev_b32 v50, 16, v50
v_cmp_gt_i32 s[66:67], s45, v50
v_add_u32 v48, 256, v48
v_mad_u32_u24 v41, v50, s46, v41
v_cndmask_b32 v41, v41, v49, s[66:67]
v_mul_u32_u24 v50, 1639, v48
v_lshlrev_b32 v42, 4, v48
v_lshrrev_b32 v50, 16, v50
v_cmp_gt_i32 s[66:67], s45, v50
v_add_u32 v48, 256, v48
v_mad_u32_u24 v42, v50, s46, v42
v_cndmask_b32 v42, v42, v49, s[66:67]
v_mul_u32_u24 v50, 1639, v48
v_lshlrev_b32 v43, 4, v48
v_lshrrev_b32 v50, 16, v50
v_cmp_gt_i32 s[66:67], s45, v50
v_add_u32 v48, 256, v48
v_mad_u32_u24 v43, v50, s46, v43
v_cndmask_b32 v43, v43, v49, s[66:67]
v_lshlrev_b32 v46, 4, v0
v_and_b32 v50, 31, v0
v_lshrrev_b32 v51, 5, v0
v_lshlrev_b32 v50, 4, v50
v_lshl_add_u32 v47, v51, 15, v50
v_lshlrev_b32 v44, 6, v0
v_mov_b32 v50, 143876
s_branch L_hjoin
L_end:
s_endpgm
.section .rodata,"a"
.p2align 6
.amdhsa_kernel recurrent_scan__sliding_block__dense_activation_relu__prompt_kernel
  .amdhsa_next_free_vgpr 256
  .amdhsa_next_free_sgpr 102
  .amdhsa_accum_offset 256
  .amdhsa_group_segment_fixed_size 0
  .amdhsa_kernarg_size 72
  .amdhsa_user_sgpr_count 2
  .amdhsa_user_sgpr_kernarg_segment_ptr 1
  .amdhsa_system_sgpr_workgroup_id_x 1
.end_amdhsa_kernel
```
